```python
import torch

def _softmax(x, axis=-1):
    return torch.softmax(x, dim=axis)

def _gelu(x):
    return torch.nn.functional.gelu(x, approximate='tanh')

def _silu(x):
    return torch.nn.functional.silu(x)

def _sigmoid(x):
    return torch.sigmoid(x)

def _layernorm(x, axis=-1, eps=1e-05):
    m = x.mean(dim=axis, keepdim=True)
    v = x.var(dim=axis, keepdim=True, unbiased=False)
    return (x - m) / torch.sqrt(v + eps)

def _scatter_add(tgt, idx, src, axis=0):
    return tgt.clone().index_add_(axis, idx, src)

def _segment_sum(src, seg, n):
    out = torch.zeros((n,) + src.shape[1:], dtype=src.dtype)
    return out.index_add_(0, seg, src)

def _pad(x, pw):
    flat = tuple((v for pair in reversed(pw) for v in pair))
    return torch.nn.functional.pad(x, flat)
kernel_name = 'adaLN_cond__compressed_kv_cla__glu_gated_bilinear__prompt'

def setup_inputs():

    _w = lambda a: (lambda t: t.to(torch.bfloat16) if t.is_floating_point() else t)(torch.as_tensor(a))

    def _A_setup():
        B, H, Sq, Sk, D, M = (1, 32, 2048, 2048, 128, 512)
        Dc = 4 * D
        return {'x': _w((lambda *s: torch.randn(*s, dtype=torch.bfloat16) * 0.05)(B, Sq, M)), 'c_kv': _w((lambda *s: torch.randn(*s, dtype=torch.bfloat16) * 0.8)(B, Sk, Dc)), 'w_q': _w((lambda *s: torch.randn(*s, dtype=torch.bfloat16) * 1.6)(M, H, D) * M ** (-0.5)), 'w_uk': _w((lambda *s: torch.randn(*s, dtype=torch.bfloat16) * 1.6)(Dc, H, D) * Dc ** (-0.5)), 'w_uv': _w((lambda *s: torch.randn(*s, dtype=torch.bfloat16) * 0.8)(Dc, H, D) * Dc ** (-0.5)), 'w_o': _w((lambda *s: torch.randn(*s, dtype=torch.bfloat16) * 0.8)(H, D, M) * (H * D) ** (-0.5))}
    _A_in = _A_setup()

    def _B_setup():
        B, S, D, F = (1, 2048, 512, 1792)
        return {'x': _w((lambda *s: torch.randn(*s, dtype=torch.bfloat16) * 0.05)(B, S, D)), 'w_gate': _w((lambda *s: torch.randn(*s, dtype=torch.bfloat16) * 0.4)(D, F) * D ** (-0.5)), 'w_up': _w((lambda *s: torch.randn(*s, dtype=torch.bfloat16) * 0.4)(D, F) * D ** (-0.5)), 'w_down': _w((lambda *s: torch.randn(*s, dtype=torch.bfloat16) * 0.4)(F, D) * F ** (-0.5))}
    _B_in = _B_setup()
    return {'A_x': _A_in['x'], 'A_c_kv': _A_in['c_kv'], 'A_w_q': _A_in['w_q'], 'A_w_uk': _A_in['w_uk'], 'A_w_uv': _A_in['w_uv'], 'A_w_o': _A_in['w_o'], 'B_x': _B_in['x'], 'B_w_gate': _B_in['w_gate'], 'B_w_up': _B_in['w_up'], 'B_w_down': _B_in['w_down'], 'c': _w((lambda *s: torch.randn(*s, dtype=torch.bfloat16) * 0.2)(1, 512) * 8.0), 'w_mod': _w((lambda *s: torch.randn(*s, dtype=torch.bfloat16) * 0.2)(512, 6 * 512) * 512 ** (-0.5) * 8.0)}

def reference(A_x, A_c_kv, A_w_q, A_w_uk, A_w_uv, A_w_o, B_x, B_w_gate, B_w_up, B_w_down, c, w_mod):

    def _A_ref(x, c_kv, w_q, w_uk, w_uv, w_o):
        B, Sq, M = (x.shape[0], x.shape[1], x.shape[2])
        Sk = c_kv.shape[1]
        H, D = (w_q.shape[1], w_q.shape[2])
        q = torch.einsum('bqm,mhd->bhqd', x, w_q)
        k = torch.einsum('bkc,chd->bhkd', c_kv, w_uk)
        v = torch.einsum('bkc,chd->bhkd', c_kv, w_uv)
        scores = torch.einsum('bhqd,bhkd->bhqk', q, k) * D ** (-0.5)
        off = Sk - Sq
        qi = torch.arange(Sq)[:, None]
        kj = torch.arange(Sk)[None, :]
        cmask = kj <= qi + off
        scores = torch.where(cmask[None, None], scores, -1000000000.0)
        p = _softmax(scores, axis=-1)
        ctx = torch.einsum('bhqk,bhkd->bhqd', p, v)
        return torch.einsum('bhqd,hdm->bqm', ctx, w_o)

    def _B_ref(x, w_gate, w_up, w_down):
        g = torch.einsum('bsd,df->bsf', x, w_gate)
        u = torch.einsum('bsd,df->bsf', x, w_up)
        h = g * u
        return torch.einsum('bsf,fd->bsd', h, w_down)
    x = A_x
    mod = (_silu(c) @ w_mod).reshape(c.shape[0], 6, 1, -1)
    sa, ca, ga, sb, cb, gb = (mod[:, 0].clone(), mod[:, 1].clone(), mod[:, 2].clone(), mod[:, 3].clone(), mod[:, 4].clone(), mod[:, 5].clone())
    h = _layernorm(x, axis=-1) * (1 + ca) + sa
    x = x + ga * _A_ref(h, A_c_kv, A_w_q, A_w_uk, A_w_uv, A_w_o)
    h = _layernorm(x, axis=-1) * (1 + cb) + sb
    x = x + gb * _B_ref(h, B_w_gate, B_w_up, B_w_down)
    return x
```

```asm
; @launch kernel=mod_kernel grid=(256,1,1) block=(256,1,1) lds=9216
; @launch kernel=kv_kernel grid=(256,1,1) block=(512,1,1) lds=131072
; @launch kernel=attn_kernel grid=(256,1,1) block=(512,1,1) lds=163840
; @launch kernel=op_kernel grid=(256,1,1) block=(256,1,1) lds=98304
; @launch kernel=ln2_kernel grid=(512,1,1) block=(256,1,1) lds=0
; @launch kernel=gu_kernel grid=(224,1,1) block=(512,1,1) lds=147456
; @launch kernel=dn_kernel grid=(256,1,1) block=(256,1,1) lds=65536
.amdgcn_target "amdgcn-amd-amdhsa--gfx950"
.text
.globl mod_kernel
.p2align 8
.type mod_kernel,@function
mod_kernel:
    s_cmp_lt_u32 s2, 256
    s_cbranch_scc1 mod_kernel_L1
    s_endpgm
mod_kernel_L1:
    s_cmp_lt_u32 s2, 96
    s_cbranch_scc1 mod_kernel_L2
    s_load_dwordx2 s[4:5], s[0:1], 8
    s_load_dwordx2 s[8:9], s[0:1], 24
    s_load_dwordx2 s[12:13], s[0:1], 32
    s_load_dwordx2 s[16:17], s[0:1], 0
    s_waitcnt lgkmcnt(0)
    s_and_b32 s5, s5, 0xffff
    s_mov_b32 s6, 0x200000
    s_mov_b32 s7, 0x20000
    s_and_b32 s9, s9, 0xffff
    s_mov_b32 s10, 0x400000
    s_mov_b32 s11, 0x20000
    s_and_b32 s13, s13, 0xffff
    s_mov_b32 s14, 0x400000
    s_mov_b32 s15, 0x20000
    s_and_b32 s17, s17, 0xffff
    s_mov_b32 s18, 0x200000
    s_mov_b32 s19, 0x20000
    s_sub_u32 s3, s2, 96
    s_lshl_b32 s3, s3, 12
    v_lshlrev_b32 v1, 4, v0
    v_add_u32 v1, s3, v1
    s_mov_b32 s3, 0
    buffer_load_dwordx4 v[4:7], v1, s[4:7], s3 offen
    buffer_load_dwordx4 v[4:7], v1, s[8:11], s3 offen
    buffer_load_dwordx4 v[4:7], v1, s[12:15], s3 offen
    buffer_load_dwordx4 v[4:7], v1, s[16:19], s3 offen
    s_mov_b32 s3, 655360
    buffer_load_dwordx4 v[4:7], v1, s[4:7], s3 offen
    buffer_load_dwordx4 v[4:7], v1, s[8:11], s3 offen
    buffer_load_dwordx4 v[4:7], v1, s[12:15], s3 offen
    buffer_load_dwordx4 v[4:7], v1, s[16:19], s3 offen
    s_mov_b32 s3, 1310720
    buffer_load_dwordx4 v[4:7], v1, s[4:7], s3 offen
    buffer_load_dwordx4 v[4:7], v1, s[8:11], s3 offen
    buffer_load_dwordx4 v[4:7], v1, s[12:15], s3 offen
    buffer_load_dwordx4 v[4:7], v1, s[16:19], s3 offen
    s_mov_b32 s3, 1966080
    buffer_load_dwordx4 v[4:7], v1, s[4:7], s3 offen
    buffer_load_dwordx4 v[4:7], v1, s[8:11], s3 offen
    buffer_load_dwordx4 v[4:7], v1, s[12:15], s3 offen
    buffer_load_dwordx4 v[4:7], v1, s[16:19], s3 offen
    s_mov_b32 s3, 2621440
    buffer_load_dwordx4 v[4:7], v1, s[8:11], s3 offen
    buffer_load_dwordx4 v[4:7], v1, s[12:15], s3 offen
    s_mov_b32 s3, 3276800
    buffer_load_dwordx4 v[4:7], v1, s[8:11], s3 offen
    buffer_load_dwordx4 v[4:7], v1, s[12:15], s3 offen
    s_mov_b32 s3, 3932160
    buffer_load_dwordx4 v[4:7], v1, s[8:11], s3 offen
    buffer_load_dwordx4 v[4:7], v1, s[12:15], s3 offen
    s_waitcnt vmcnt(0)
    s_endpgm
mod_kernel_L2:
    s_load_dwordx2 s[20:21], s[0:1], 80
    s_load_dwordx2 s[24:25], s[0:1], 88
    s_load_dwordx2 s[28:29], s[0:1], 112
    s_waitcnt lgkmcnt(0)
    s_and_b32 s21, s21, 0xffff
    s_mov_b32 s22, 0x400
    s_mov_b32 s23, 0x20000
    s_and_b32 s25, s25, 0xffff
    s_mov_b32 s26, 0x300000
    s_mov_b32 s27, 0x20000
    s_and_b32 s29, s29, 0xffff
    s_mov_b32 s30, 0x3000
    s_mov_b32 s31, 0x20000
    v_lshrrev_b32 v1, 2, v0
    v_lshlrev_b32 v3, 1, v1
    buffer_load_ushort v4, v3, s[20:23], 0 offen offset:0
    buffer_load_ushort v5, v3, s[20:23], 0 offen offset:128
    buffer_load_ushort v6, v3, s[20:23], 0 offen offset:256
    buffer_load_ushort v7, v3, s[20:23], 0 offen offset:384
    buffer_load_ushort v8, v3, s[20:23], 0 offen offset:512
    buffer_load_ushort v9, v3, s[20:23], 0 offen offset:640
    buffer_load_ushort v10, v3, s[20:23], 0 offen offset:768
    buffer_load_ushort v11, v3, s[20:23], 0 offen offset:896
    v_mul_u32_u24 v2, 6144, v1
    v_and_b32 v3, 3, v0
    v_lshl_add_u32 v2, v3, 4, v2
    s_lshl_b32 s32, s2, 6
    buffer_load_dwordx4 v[12:15], v2, s[24:27], s32 offen
    s_add_u32 s32, s32, 393216
    buffer_load_dwordx4 v[16:19], v2, s[24:27], s32 offen
    s_add_u32 s32, s32, 393216
    buffer_load_dwordx4 v[20:23], v2, s[24:27], s32 offen
    s_add_u32 s32, s32, 393216
    buffer_load_dwordx4 v[24:27], v2, s[24:27], s32 offen
    s_add_u32 s32, s32, 393216
    buffer_load_dwordx4 v[28:31], v2, s[24:27], s32 offen
    s_add_u32 s32, s32, 393216
    buffer_load_dwordx4 v[32:35], v2, s[24:27], s32 offen
    s_add_u32 s32, s32, 393216
    buffer_load_dwordx4 v[36:39], v2, s[24:27], s32 offen
    s_add_u32 s32, s32, 393216
    buffer_load_dwordx4 v[40:43], v2, s[24:27], s32 offen
    s_add_u32 s32, s32, 393216
    s_waitcnt vmcnt(8)
    v_lshlrev_b32 v4, 16, v4
    v_mul_f32 v52, 0xbfb8aa3b, v4
    v_exp_f32 v52, v52
    s_nop 0
    v_add_f32 v52, 1.0, v52
    v_rcp_f32 v52, v52
    s_nop 0
    v_mul_f32 v4, v4, v52
    v_cvt_pk_bf16_f32 v4, v4, v4
    v_and_b32 v4, 0xffff0000, v4
    v_lshlrev_b32 v5, 16, v5
    v_mul_f32 v52, 0xbfb8aa3b, v5
    v_exp_f32 v52, v52
    s_nop 0
    v_add_f32 v52, 1.0, v52
    v_rcp_f32 v52, v52
    s_nop 0
    v_mul_f32 v5, v5, v52
    v_cvt_pk_bf16_f32 v5, v5, v5
    v_and_b32 v5, 0xffff0000, v5
    v_lshlrev_b32 v6, 16, v6
    v_mul_f32 v52, 0xbfb8aa3b, v6
    v_exp_f32 v52, v52
    s_nop 0
    v_add_f32 v52, 1.0, v52
    v_rcp_f32 v52, v52
    s_nop 0
    v_mul_f32 v6, v6, v52
    v_cvt_pk_bf16_f32 v6, v6, v6
    v_and_b32 v6, 0xffff0000, v6
    v_lshlrev_b32 v7, 16, v7
    v_mul_f32 v52, 0xbfb8aa3b, v7
    v_exp_f32 v52, v52
    s_nop 0
    v_add_f32 v52, 1.0, v52
    v_rcp_f32 v52, v52
    s_nop 0
    v_mul_f32 v7, v7, v52
    v_cvt_pk_bf16_f32 v7, v7, v7
    v_and_b32 v7, 0xffff0000, v7
    v_lshlrev_b32 v8, 16, v8
    v_mul_f32 v52, 0xbfb8aa3b, v8
    v_exp_f32 v52, v52
    s_nop 0
    v_add_f32 v52, 1.0, v52
    v_rcp_f32 v52, v52
    s_nop 0
    v_mul_f32 v8, v8, v52
    v_cvt_pk_bf16_f32 v8, v8, v8
    v_and_b32 v8, 0xffff0000, v8
    v_lshlrev_b32 v9, 16, v9
    v_mul_f32 v52, 0xbfb8aa3b, v9
    v_exp_f32 v52, v52
    s_nop 0
    v_add_f32 v52, 1.0, v52
    v_rcp_f32 v52, v52
    s_nop 0
    v_mul_f32 v9, v9, v52
    v_cvt_pk_bf16_f32 v9, v9, v9
    v_and_b32 v9, 0xffff0000, v9
    v_lshlrev_b32 v10, 16, v10
    v_mul_f32 v52, 0xbfb8aa3b, v10
    v_exp_f32 v52, v52
    s_nop 0
    v_add_f32 v52, 1.0, v52
    v_rcp_f32 v52, v52
    s_nop 0
    v_mul_f32 v10, v10, v52
    v_cvt_pk_bf16_f32 v10, v10, v10
    v_and_b32 v10, 0xffff0000, v10
    v_lshlrev_b32 v11, 16, v11
    v_mul_f32 v52, 0xbfb8aa3b, v11
    v_exp_f32 v52, v52
    s_nop 0
    v_add_f32 v52, 1.0, v52
    v_rcp_f32 v52, v52
    s_nop 0
    v_mul_f32 v11, v11, v52
    v_cvt_pk_bf16_f32 v11, v11, v11
    v_and_b32 v11, 0xffff0000, v11
    v_mov_b32 v44, 0
    v_mov_b32 v45, 0
    v_mov_b32 v46, 0
    v_mov_b32 v47, 0
    v_mov_b32 v48, 0
    v_mov_b32 v49, 0
    v_mov_b32 v50, 0
    v_mov_b32 v51, 0
    s_waitcnt vmcnt(7)
    v_lshlrev_b32 v52, 16, v12
    v_and_b32 v53, 0xffff0000, v12
    v_fmac_f32 v44, v52, v4
    v_fmac_f32 v45, v53, v4
    v_lshlrev_b32 v52, 16, v13
    v_and_b32 v53, 0xffff0000, v13
    v_fmac_f32 v46, v52, v4
    v_fmac_f32 v47, v53, v4
    v_lshlrev_b32 v52, 16, v14
    v_and_b32 v53, 0xffff0000, v14
    v_fmac_f32 v48, v52, v4
    v_fmac_f32 v49, v53, v4
    v_lshlrev_b32 v52, 16, v15
    v_and_b32 v53, 0xffff0000, v15
    v_fmac_f32 v50, v52, v4
    v_fmac_f32 v51, v53, v4
    s_waitcnt vmcnt(6)
    v_lshlrev_b32 v52, 16, v16
    v_and_b32 v53, 0xffff0000, v16
    v_fmac_f32 v44, v52, v5
    v_fmac_f32 v45, v53, v5
    v_lshlrev_b32 v52, 16, v17
    v_and_b32 v53, 0xffff0000, v17
    v_fmac_f32 v46, v52, v5
    v_fmac_f32 v47, v53, v5
    v_lshlrev_b32 v52, 16, v18
    v_and_b32 v53, 0xffff0000, v18
    v_fmac_f32 v48, v52, v5
    v_fmac_f32 v49, v53, v5
    v_lshlrev_b32 v52, 16, v19
    v_and_b32 v53, 0xffff0000, v19
    v_fmac_f32 v50, v52, v5
    v_fmac_f32 v51, v53, v5
    s_waitcnt vmcnt(5)
    v_lshlrev_b32 v52, 16, v20
    v_and_b32 v53, 0xffff0000, v20
    v_fmac_f32 v44, v52, v6
    v_fmac_f32 v45, v53, v6
    v_lshlrev_b32 v52, 16, v21
    v_and_b32 v53, 0xffff0000, v21
    v_fmac_f32 v46, v52, v6
    v_fmac_f32 v47, v53, v6
    v_lshlrev_b32 v52, 16, v22
    v_and_b32 v53, 0xffff0000, v22
    v_fmac_f32 v48, v52, v6
    v_fmac_f32 v49, v53, v6
    v_lshlrev_b32 v52, 16, v23
    v_and_b32 v53, 0xffff0000, v23
    v_fmac_f32 v50, v52, v6
    v_fmac_f32 v51, v53, v6
    s_waitcnt vmcnt(4)
    v_lshlrev_b32 v52, 16, v24
    v_and_b32 v53, 0xffff0000, v24
    v_fmac_f32 v44, v52, v7
    v_fmac_f32 v45, v53, v7
    v_lshlrev_b32 v52, 16, v25
    v_and_b32 v53, 0xffff0000, v25
    v_fmac_f32 v46, v52, v7
    v_fmac_f32 v47, v53, v7
    v_lshlrev_b32 v52, 16, v26
    v_and_b32 v53, 0xffff0000, v26
    v_fmac_f32 v48, v52, v7
    v_fmac_f32 v49, v53, v7
    v_lshlrev_b32 v52, 16, v27
    v_and_b32 v53, 0xffff0000, v27
    v_fmac_f32 v50, v52, v7
    v_fmac_f32 v51, v53, v7
    s_waitcnt vmcnt(3)
    v_lshlrev_b32 v52, 16, v28
    v_and_b32 v53, 0xffff0000, v28
    v_fmac_f32 v44, v52, v8
    v_fmac_f32 v45, v53, v8
    v_lshlrev_b32 v52, 16, v29
    v_and_b32 v53, 0xffff0000, v29
    v_fmac_f32 v46, v52, v8
    v_fmac_f32 v47, v53, v8
    v_lshlrev_b32 v52, 16, v30
    v_and_b32 v53, 0xffff0000, v30
    v_fmac_f32 v48, v52, v8
    v_fmac_f32 v49, v53, v8
    v_lshlrev_b32 v52, 16, v31
    v_and_b32 v53, 0xffff0000, v31
    v_fmac_f32 v50, v52, v8
    v_fmac_f32 v51, v53, v8
    s_waitcnt vmcnt(2)
    v_lshlrev_b32 v52, 16, v32
    v_and_b32 v53, 0xffff0000, v32
    v_fmac_f32 v44, v52, v9
    v_fmac_f32 v45, v53, v9
    v_lshlrev_b32 v52, 16, v33
    v_and_b32 v53, 0xffff0000, v33
    v_fmac_f32 v46, v52, v9
    v_fmac_f32 v47, v53, v9
    v_lshlrev_b32 v52, 16, v34
    v_and_b32 v53, 0xffff0000, v34
    v_fmac_f32 v48, v52, v9
    v_fmac_f32 v49, v53, v9
    v_lshlrev_b32 v52, 16, v35
    v_and_b32 v53, 0xffff0000, v35
    v_fmac_f32 v50, v52, v9
    v_fmac_f32 v51, v53, v9
    s_waitcnt vmcnt(1)
    v_lshlrev_b32 v52, 16, v36
    v_and_b32 v53, 0xffff0000, v36
    v_fmac_f32 v44, v52, v10
    v_fmac_f32 v45, v53, v10
    v_lshlrev_b32 v52, 16, v37
    v_and_b32 v53, 0xffff0000, v37
    v_fmac_f32 v46, v52, v10
    v_fmac_f32 v47, v53, v10
    v_lshlrev_b32 v52, 16, v38
    v_and_b32 v53, 0xffff0000, v38
    v_fmac_f32 v48, v52, v10
    v_fmac_f32 v49, v53, v10
    v_lshlrev_b32 v52, 16, v39
    v_and_b32 v53, 0xffff0000, v39
    v_fmac_f32 v50, v52, v10
    v_fmac_f32 v51, v53, v10
    s_waitcnt vmcnt(0)
    v_lshlrev_b32 v52, 16, v40
    v_and_b32 v53, 0xffff0000, v40
    v_fmac_f32 v44, v52, v11
    v_fmac_f32 v45, v53, v11
    v_lshlrev_b32 v52, 16, v41
    v_and_b32 v53, 0xffff0000, v41
    v_fmac_f32 v46, v52, v11
    v_fmac_f32 v47, v53, v11
    v_lshlrev_b32 v52, 16, v42
    v_and_b32 v53, 0xffff0000, v42
    v_fmac_f32 v48, v52, v11
    v_fmac_f32 v49, v53, v11
    v_lshlrev_b32 v52, 16, v43
    v_and_b32 v53, 0xffff0000, v43
    v_fmac_f32 v50, v52, v11
    v_fmac_f32 v51, v53, v11
    v_lshlrev_b32 v3, 5, v0
    ds_write_b128 v3, v[44:47]
    ds_write_b128 v3, v[48:51] offset:16
    s_waitcnt lgkmcnt(0)
    s_barrier
    v_lshrrev_b32 v3, 5, v0
    v_lshlrev_b32 v3, 10, v3
    v_and_b32 v2, 31, v0
    v_lshlrev_b32 v2, 2, v2
    v_add_u32 v3, v3, v2
    ds_read_b32 v44, v3 offset:0
    ds_read_b32 v45, v3 offset:128
    ds_read_b32 v46, v3 offset:256
    ds_read_b32 v47, v3 offset:384
    ds_read_b32 v48, v3 offset:512
    ds_read_b32 v49, v3 offset:640
    ds_read_b32 v50, v3 offset:768
    ds_read_b32 v51, v3 offset:896
    s_waitcnt lgkmcnt(0)
    v_add_f32 v44, v44, v45
    v_add_f32 v44, v44, v46
    v_add_f32 v44, v44, v47
    v_add_f32 v44, v44, v48
    v_add_f32 v44, v44, v49
    v_add_f32 v44, v44, v50
    v_add_f32 v44, v44, v51
    v_lshlrev_b32 v3, 2, v0
    ds_write_b32 v3, v44 offset:8192
    s_waitcnt lgkmcnt(0)
    s_barrier
    ds_read_b32 v44, v2 offset:8192
    ds_read_b32 v45, v2 offset:8320
    ds_read_b32 v46, v2 offset:8448
    ds_read_b32 v47, v2 offset:8576
    ds_read_b32 v48, v2 offset:8704
    ds_read_b32 v49, v2 offset:8832
    ds_read_b32 v50, v2 offset:8960
    ds_read_b32 v51, v2 offset:9088
    s_waitcnt lgkmcnt(0)
    v_add_f32 v44, v44, v45
    v_add_f32 v44, v44, v46
    v_add_f32 v44, v44, v47
    v_add_f32 v44, v44, v48
    v_add_f32 v44, v44, v49
    v_add_f32 v44, v44, v50
    v_add_f32 v44, v44, v51
    v_cvt_pk_bf16_f32 v44, v44, v44
    v_and_b32 v44, 0xffff0000, v44
    s_lshl_b32 s32, s2, 7
    buffer_store_dword v44, v2, s[28:31], s32 offen
    s_endpgm
.globl kv_kernel
.p2align 8
.type kv_kernel,@function
kv_kernel:
    s_cmp_lt_u32 s2, 256
    s_cbranch_scc1 kv_kernel_L1
    s_endpgm
kv_kernel_L1:
    s_load_dwordx2 s[4:5], s[0:1], 0
    s_load_dwordx2 s[8:9], s[0:1], 8
    s_load_dwordx2 s[12:13], s[0:1], 24
    s_load_dwordx2 s[16:17], s[0:1], 32
    s_load_dwordx2 s[20:21], s[0:1], 112
    s_load_dwordx2 s[24:25], s[0:1], 112
    s_load_dwordx2 s[28:29], s[0:1], 112
    s_load_dwordx2 s[32:33], s[0:1], 112
    s_load_dwordx2 s[36:37], s[0:1], 16
    v_lshrrev_b32 v1, 6, v0
    s_nop 0
    v_readfirstlane_b32 s40, v1
    v_and_b32 v1, 63, v0
    s_waitcnt lgkmcnt(0)
    s_and_b32 s5, s5, 0xffff
    s_mov_b32 s6, 0x200000
    s_mov_b32 s7, 0x20000
    s_and_b32 s9, s9, 0xffff
    s_mov_b32 s10, 0x200000
    s_mov_b32 s11, 0x20000
    s_and_b32 s13, s13, 0xffff
    s_mov_b32 s14, 0x400000
    s_mov_b32 s15, 0x20000
    s_and_b32 s17, s17, 0xffff
    s_mov_b32 s18, 0x400000
    s_mov_b32 s19, 0x20000
    s_and_b32 s21, s21, 0xffff
    s_mov_b32 s22, 0x3000
    s_mov_b32 s23, 0x20000
    s_add_u32 s24, s24, 0x10000
    s_addc_u32 s25, s25, 0
    s_and_b32 s25, s25, 0xffff
    s_mov_b32 s26, 0x200000
    s_mov_b32 s27, 0x20000
    s_add_u32 s28, s28, 0x400000
    s_addc_u32 s29, s29, 0
    s_and_b32 s29, s29, 0xffff
    s_mov_b32 s30, 0x1000000
    s_mov_b32 s31, 0x20000
    s_add_u32 s32, s32, 0x1400000
    s_addc_u32 s33, s33, 0
    s_and_b32 s33, s33, 0xffff
    s_mov_b32 s34, 0x1000000
    s_mov_b32 s35, 0x20000
    s_and_b32 s37, s37, 0xffff
    s_mov_b32 s38, 0x400000
    s_mov_b32 s39, 0x20000
    s_mov_b32 s41, 0x200000
    s_lshl_b32 s3, s2, 13
    v_lshlrev_b32 v8, 4, v0
    v_add_u32 v8, s3, v8
    v_lshlrev_b32 v32, 4, v1
    v_lshlrev_b32 v33, 5, v1
    s_lshl_b32 s42, s2, 3
    s_add_u32 s42, s42, s40
    s_lshl_b32 s42, s42, 10
    buffer_load_dwordx4 v[12:15], v32, s[4:7], s42 offen
    buffer_load_dwordx4 v[16:19], v33, s[20:23], 0 offen offset:0
    buffer_load_dwordx4 v[20:23], v33, s[20:23], 0 offen offset:16
    buffer_load_dwordx4 v[24:27], v33, s[20:23], 0 offen offset:2048
    buffer_load_dwordx4 v[28:31], v33, s[20:23], 0 offen offset:2064
    s_lshl_b32 s43, s40, 10
    s_lshr_b32 s44, s40, 2
    s_and_b32 s45, s40, 3
    s_lshl_b32 s46, s40, 2
    v_lshrrev_b32 v34, 4, v1
    v_add_u32 v34, s46, v34
    v_xor_b32 v34, v34, v1
    v_and_b32 v34, 7, v34
    v_lshlrev_b32 v34, 4, v34
    s_lshl_b32 s46, s40, 3
    v_lshrrev_b32 v35, 3, v1
    v_add_u32 v35, s46, v35
    s_mov_b32 s46, 1024
    v_mul_lo_u32 v35, v35, s46
    v_add_u32 v37, v34, v35
    v_add_u32 v40, 196608, v37
    v_add_u32 v39, 131072, v37
    v_add_u32 v38, 65536, v37
    v_lshrrev_b32 v35, 4, v1
    v_lshlrev_b32 v34, 2, v35
    v_xor_b32 v34, v34, v1
    v_and_b32 v34, 15, v34
    v_lshlrev_b32 v34, 4, v34
    s_mul_i32 s46, s40, 4
    v_add_u32 v35, s46, v35
    s_mov_b32 s46, 8192
    v_mul_lo_u32 v35, v35, s46
    v_add_u32 v41, v34, v35
    v_add_u32 v44, 262400, v41
    v_add_u32 v43, 256, v41
    v_add_u32 v42, 262144, v41
    v_lshrrev_b32 v34, 5, v1
    v_bfe_u32 v35, v1, 1, 3
    v_xor_b32 v34, v34, v35
    v_lshlrev_b32 v34, 4, v34
    v_and_b32 v35, 31, v1
    v_lshl_add_u32 v34, v35, 7, v34
    s_mul_i32 s46, s44, 16384
    v_add_u32 v34, s46, v34
    v_xor_b32 v45, 0, v34
    v_xor_b32 v46, 32, v34
    v_xor_b32 v47, 64, v34
    v_xor_b32 v48, 96, v34
    v_xor_b32 v49, 0, v34
    v_add_u32 v49, 65536, v49
    v_xor_b32 v50, 32, v34
    v_add_u32 v50, 65536, v50
    v_xor_b32 v51, 64, v34
    v_add_u32 v51, 65536, v51
    v_xor_b32 v52, 96, v34
    v_add_u32 v52, 65536, v52
    v_lshrrev_b32 v34, 5, v1
    v_lshlrev_b32 v34, 3, v34
    v_bfe_u32 v35, v1, 2, 2
    v_add_u32 v34, v34, v35
    v_mul_u32_u24 v34, 256, v34
    v_bfe_u32 v36, v1, 4, 1
    v_lshl_add_u32 v34, v36, 5, v34
    v_and_b32 v36, 3, v1
    v_lshl_add_u32 v34, v36, 3, v34
    s_mul_i32 s46, s45, 2
    s_add_u32 s46, s46, 0
    s_and_b32 s47, s46, 3
    v_xor_b32 v36, s47, v35
    v_lshl_add_u32 v36, v36, 6, v34
    s_lshr_b32 s46, s46, 2
    s_mul_i32 s46, s46, 16384
    v_add_u32 v53, s46, v36
    v_add_u32 v55, s46, v36
    v_add_u32 v55, 65536, v55
    s_mul_i32 s46, s45, 2
    s_add_u32 s46, s46, 1
    s_and_b32 s47, s46, 3
    v_xor_b32 v36, s47, v35
    v_lshl_add_u32 v36, v36, 6, v34
    s_lshr_b32 s46, s46, 2
    s_mul_i32 s46, s46, 16384
    v_add_u32 v54, s46, v36
    v_add_u32 v56, s46, v36
    v_add_u32 v56, 65536, v56
    s_lshr_b32 s50, s2, 3
    s_mov_b32 s50, 0
    s_and_b32 s50, s50, 7
    s_bfe_u32 s51, s2, 0x30003
    s_and_b32 s52, s2, 7
    s_lshl_b32 s52, s52, 1
    s_bfe_u32 s56, s2, 0x10006
    s_add_u32 s52, s52, s56
    s_lshl_b32 s53, s51, 18
    s_lshl_b32 s54, s52, 9
    s_lshr_b32 s56, s45, 1
    s_lshl_b32 s55, s52, 1
    s_add_u32 s55, s55, s56
    s_lshl_b32 s55, s55, 19
    s_lshl_b32 s56, s51, 16
    s_add_u32 s55, s55, s56
    s_lshl_b32 s56, s44, 15
    s_add_u32 s55, s55, s56
    s_bitcmp1_b32 s2, 7
    s_cbranch_scc1 kv_kernel_L2
    s_lshl_b32 s48, s50, 7
    s_add_u32 s48, s48, s53
    s_add_u32 m0, s43, 0
    s_nop 0
    buffer_load_dwordx4 v37, s[8:11], s48 offen lds
    s_add_u32 m0, s43, 8192
    s_nop 0
    buffer_load_dwordx4 v38, s[8:11], s48 offen lds
    s_add_u32 m0, s43, 16384
    s_nop 0
    buffer_load_dwordx4 v39, s[8:11], s48 offen lds
    s_add_u32 m0, s43, 24576
    s_nop 0
    buffer_load_dwordx4 v40, s[8:11], s48 offen lds
    s_mul_i32 s49, s50, 524288
    s_add_u32 s49, s49, s54
    s_add_u32 s50, s50, 1
    s_cmp_eq_u32 s50, 8
    s_cselect_b32 s50, 0, s50
    s_add_u32 m0, s43, 32768
    s_nop 0
    buffer_load_dwordx4 v41, s[12:15], s49 offen lds
    s_add_u32 m0, s43, 40960
    s_nop 0
    buffer_load_dwordx4 v42, s[12:15], s49 offen lds
    s_add_u32 m0, s43, 49152
    s_nop 0
    buffer_load_dwordx4 v43, s[12:15], s49 offen lds
    s_add_u32 m0, s43, 57344
    s_nop 0
    buffer_load_dwordx4 v44, s[12:15], s49 offen lds
    s_lshl_b32 s48, s50, 7
    s_add_u32 s48, s48, s53
    s_add_u32 m0, s43, 65536
    s_nop 0
    buffer_load_dwordx4 v37, s[8:11], s48 offen lds
    s_add_u32 m0, s43, 73728
    s_nop 0
    buffer_load_dwordx4 v38, s[8:11], s48 offen lds
    s_add_u32 m0, s43, 81920
    s_nop 0
    buffer_load_dwordx4 v39, s[8:11], s48 offen lds
    s_add_u32 m0, s43, 90112
    s_nop 0
    buffer_load_dwordx4 v40, s[8:11], s48 offen lds
    s_mul_i32 s49, s50, 524288
    s_add_u32 s49, s49, s54
    s_add_u32 s50, s50, 1
    s_cmp_eq_u32 s50, 8
    s_cselect_b32 s50, 0, s50
    s_add_u32 m0, s43, 98304
    s_nop 0
    buffer_load_dwordx4 v41, s[12:15], s49 offen lds
    s_add_u32 m0, s43, 106496
    s_nop 0
    buffer_load_dwordx4 v42, s[12:15], s49 offen lds
    s_add_u32 m0, s43, 114688
    s_nop 0
    buffer_load_dwordx4 v43, s[12:15], s49 offen lds
    s_add_u32 m0, s43, 122880
    s_nop 0
    buffer_load_dwordx4 v44, s[12:15], s49 offen lds
    s_waitcnt vmcnt(8)
    s_barrier
    ds_read_b128 v[58:61], v45 offset:0
    ds_read_b64_tr_b16 v[74:75], v53 offset:32768
    ds_read_b64_tr_b16 v[76:77], v53 offset:33792
    ds_read_b128 v[62:65], v45 offset:4096
    ds_read_b64_tr_b16 v[78:79], v54 offset:32768
    ds_read_b64_tr_b16 v[80:81], v54 offset:33792
    ds_read_b128 v[66:69], v45 offset:8192
    ds_read_b128 v[70:73], v45 offset:12288
    s_waitcnt lgkmcnt(5)
    v_mfma_f32_32x32x16_bf16 v[108:123], v[74:77], v[58:61], 0
    ds_read_b128 v[82:85], v46 offset:0
    ds_read_b64_tr_b16 v[98:99], v53 offset:36864
    s_waitcnt lgkmcnt(4)
    v_mfma_f32_32x32x16_bf16 v[124:139], v[78:81], v[58:61], 0
    ds_read_b64_tr_b16 v[100:101], v53 offset:37888
    ds_read_b128 v[86:89], v46 offset:4096
    v_mfma_f32_32x32x16_bf16 v[140:155], v[74:77], v[62:65], 0
    ds_read_b64_tr_b16 v[102:103], v54 offset:36864
    ds_read_b64_tr_b16 v[104:105], v54 offset:37888
    v_mfma_f32_32x32x16_bf16 v[156:171], v[78:81], v[62:65], 0
    ds_read_b128 v[90:93], v46 offset:8192
    ds_read_b128 v[94:97], v46 offset:12288
    s_waitcnt lgkmcnt(9)
    v_mfma_f32_32x32x16_bf16 v[172:187], v[74:77], v[66:69], 0
    v_mfma_f32_32x32x16_bf16 v[188:203], v[78:81], v[66:69], 0
    s_waitcnt lgkmcnt(8)
    v_mfma_f32_32x32x16_bf16 v[204:219], v[74:77], v[70:73], 0
    v_mfma_f32_32x32x16_bf16 v[220:235], v[78:81], v[70:73], 0
    s_waitcnt lgkmcnt(5)
    v_mfma_f32_32x32x16_bf16 v[108:123], v[98:101], v[82:85], v[108:123]
    ds_read_b128 v[58:61], v47 offset:0
    ds_read_b64_tr_b16 v[74:75], v53 offset:40960
    s_waitcnt lgkmcnt(4)
    v_mfma_f32_32x32x16_bf16 v[124:139], v[102:105], v[82:85], v[124:139]
    ds_read_b64_tr_b16 v[76:77], v53 offset:41984
    ds_read_b128 v[62:65], v47 offset:4096
    v_mfma_f32_32x32x16_bf16 v[140:155], v[98:101], v[86:89], v[140:155]
    ds_read_b64_tr_b16 v[78:79], v54 offset:40960
    ds_read_b64_tr_b16 v[80:81], v54 offset:41984
    v_mfma_f32_32x32x16_bf16 v[156:171], v[102:105], v[86:89], v[156:171]
    ds_read_b128 v[66:69], v47 offset:8192
    ds_read_b128 v[70:73], v47 offset:12288
    s_waitcnt lgkmcnt(9)
    v_mfma_f32_32x32x16_bf16 v[172:187], v[98:101], v[90:93], v[172:187]
    v_mfma_f32_32x32x16_bf16 v[188:203], v[102:105], v[90:93], v[188:203]
    s_waitcnt lgkmcnt(8)
    v_mfma_f32_32x32x16_bf16 v[204:219], v[98:101], v[94:97], v[204:219]
    v_mfma_f32_32x32x16_bf16 v[220:235], v[102:105], v[94:97], v[220:235]
    s_waitcnt lgkmcnt(5)
    v_mfma_f32_32x32x16_bf16 v[108:123], v[74:77], v[58:61], v[108:123]
    ds_read_b128 v[82:85], v48 offset:0
    ds_read_b64_tr_b16 v[98:99], v53 offset:45056
    s_waitcnt lgkmcnt(4)
    v_mfma_f32_32x32x16_bf16 v[124:139], v[78:81], v[58:61], v[124:139]
    ds_read_b64_tr_b16 v[100:101], v53 offset:46080
    ds_read_b128 v[86:89], v48 offset:4096
    v_mfma_f32_32x32x16_bf16 v[140:155], v[74:77], v[62:65], v[140:155]
    ds_read_b64_tr_b16 v[102:103], v54 offset:45056
    ds_read_b64_tr_b16 v[104:105], v54 offset:46080
    v_mfma_f32_32x32x16_bf16 v[156:171], v[78:81], v[62:65], v[156:171]
    ds_read_b128 v[90:93], v48 offset:8192
    ds_read_b128 v[94:97], v48 offset:12288
    s_waitcnt lgkmcnt(9)
    v_mfma_f32_32x32x16_bf16 v[172:187], v[74:77], v[66:69], v[172:187]
    v_mfma_f32_32x32x16_bf16 v[188:203], v[78:81], v[66:69], v[188:203]
    s_waitcnt lgkmcnt(8)
    v_mfma_f32_32x32x16_bf16 v[204:219], v[74:77], v[70:73], v[204:219]
    v_mfma_f32_32x32x16_bf16 v[220:235], v[78:81], v[70:73], v[220:235]
    s_waitcnt lgkmcnt(0)
    s_waitcnt vmcnt(0)
    s_barrier
    ds_read_b128 v[58:61], v49 offset:0
    ds_read_b64_tr_b16 v[74:75], v55 offset:32768
    ds_read_b64_tr_b16 v[76:77], v55 offset:33792
    ds_read_b128 v[62:65], v49 offset:4096
    ds_read_b64_tr_b16 v[78:79], v56 offset:32768
    ds_read_b64_tr_b16 v[80:81], v56 offset:33792
    ds_read_b128 v[66:69], v49 offset:8192
    ds_read_b128 v[70:73], v49 offset:12288
    v_mfma_f32_32x32x16_bf16 v[108:123], v[98:101], v[82:85], v[108:123]
    s_lshl_b32 s48, s50, 7
    s_add_u32 s48, s48, s53
    s_add_u32 m0, s43, 0
    s_nop 0
    buffer_load_dwordx4 v37, s[8:11], s48 offen lds
    v_mfma_f32_32x32x16_bf16 v[124:139], v[102:105], v[82:85], v[124:139]
    s_add_u32 m0, s43, 8192
    s_nop 0
    buffer_load_dwordx4 v38, s[8:11], s48 offen lds
    v_mfma_f32_32x32x16_bf16 v[140:155], v[98:101], v[86:89], v[140:155]
    s_add_u32 m0, s43, 16384
    s_nop 0
    buffer_load_dwordx4 v39, s[8:11], s48 offen lds
    v_mfma_f32_32x32x16_bf16 v[156:171], v[102:105], v[86:89], v[156:171]
    s_add_u32 m0, s43, 24576
    s_nop 0
    buffer_load_dwordx4 v40, s[8:11], s48 offen lds
    v_mfma_f32_32x32x16_bf16 v[172:187], v[98:101], v[90:93], v[172:187]
    s_mul_i32 s49, s50, 524288
    s_add_u32 s49, s49, s54
    s_add_u32 s50, s50, 1
    s_cmp_eq_u32 s50, 8
    s_cselect_b32 s50, 0, s50
    s_add_u32 m0, s43, 32768
    s_nop 0
    buffer_load_dwordx4 v41, s[12:15], s49 offen lds
    v_mfma_f32_32x32x16_bf16 v[188:203], v[102:105], v[90:93], v[188:203]
    s_add_u32 m0, s43, 40960
    s_nop 0
    buffer_load_dwordx4 v42, s[12:15], s49 offen lds
    v_mfma_f32_32x32x16_bf16 v[204:219], v[98:101], v[94:97], v[204:219]
    s_add_u32 m0, s43, 49152
    s_nop 0
    buffer_load_dwordx4 v43, s[12:15], s49 offen lds
    v_mfma_f32_32x32x16_bf16 v[220:235], v[102:105], v[94:97], v[220:235]
    s_add_u32 m0, s43, 57344
    s_nop 0
    buffer_load_dwordx4 v44, s[12:15], s49 offen lds
    s_waitcnt lgkmcnt(5)
    v_mfma_f32_32x32x16_bf16 v[108:123], v[74:77], v[58:61], v[108:123]
    ds_read_b128 v[82:85], v50 offset:0
    ds_read_b64_tr_b16 v[98:99], v55 offset:36864
    s_waitcnt lgkmcnt(4)
    v_mfma_f32_32x32x16_bf16 v[124:139], v[78:81], v[58:61], v[124:139]
    ds_read_b64_tr_b16 v[100:101], v55 offset:37888
    ds_read_b128 v[86:89], v50 offset:4096
    v_mfma_f32_32x32x16_bf16 v[140:155], v[74:77], v[62:65], v[140:155]
    ds_read_b64_tr_b16 v[102:103], v56 offset:36864
    ds_read_b64_tr_b16 v[104:105], v56 offset:37888
    v_mfma_f32_32x32x16_bf16 v[156:171], v[78:81], v[62:65], v[156:171]
    ds_read_b128 v[90:93], v50 offset:8192
    ds_read_b128 v[94:97], v50 offset:12288
    s_waitcnt lgkmcnt(9)
    v_mfma_f32_32x32x16_bf16 v[172:187], v[74:77], v[66:69], v[172:187]
    v_mfma_f32_32x32x16_bf16 v[188:203], v[78:81], v[66:69], v[188:203]
    s_waitcnt lgkmcnt(8)
    v_mfma_f32_32x32x16_bf16 v[204:219], v[74:77], v[70:73], v[204:219]
    v_mfma_f32_32x32x16_bf16 v[220:235], v[78:81], v[70:73], v[220:235]
    s_waitcnt lgkmcnt(5)
    v_mfma_f32_32x32x16_bf16 v[108:123], v[98:101], v[82:85], v[108:123]
    ds_read_b128 v[58:61], v51 offset:0
    ds_read_b64_tr_b16 v[74:75], v55 offset:40960
    s_waitcnt lgkmcnt(4)
    v_mfma_f32_32x32x16_bf16 v[124:139], v[102:105], v[82:85], v[124:139]
    ds_read_b64_tr_b16 v[76:77], v55 offset:41984
    ds_read_b128 v[62:65], v51 offset:4096
    v_mfma_f32_32x32x16_bf16 v[140:155], v[98:101], v[86:89], v[140:155]
    ds_read_b64_tr_b16 v[78:79], v56 offset:40960
    ds_read_b64_tr_b16 v[80:81], v56 offset:41984
    v_mfma_f32_32x32x16_bf16 v[156:171], v[102:105], v[86:89], v[156:171]
    ds_read_b128 v[66:69], v51 offset:8192
    ds_read_b128 v[70:73], v51 offset:12288
    s_waitcnt lgkmcnt(9)
    v_mfma_f32_32x32x16_bf16 v[172:187], v[98:101], v[90:93], v[172:187]
    v_mfma_f32_32x32x16_bf16 v[188:203], v[102:105], v[90:93], v[188:203]
    s_waitcnt lgkmcnt(8)
    v_mfma_f32_32x32x16_bf16 v[204:219], v[98:101], v[94:97], v[204:219]
    v_mfma_f32_32x32x16_bf16 v[220:235], v[102:105], v[94:97], v[220:235]
    s_waitcnt lgkmcnt(5)
    v_mfma_f32_32x32x16_bf16 v[108:123], v[74:77], v[58:61], v[108:123]
    ds_read_b128 v[82:85], v52 offset:0
    ds_read_b64_tr_b16 v[98:99], v55 offset:45056
    s_waitcnt lgkmcnt(4)
    v_mfma_f32_32x32x16_bf16 v[124:139], v[78:81], v[58:61], v[124:139]
    ds_read_b64_tr_b16 v[100:101], v55 offset:46080
    ds_read_b128 v[86:89], v52 offset:4096
    v_mfma_f32_32x32x16_bf16 v[140:155], v[74:77], v[62:65], v[140:155]
    ds_read_b64_tr_b16 v[102:103], v56 offset:45056
    ds_read_b64_tr_b16 v[104:105], v56 offset:46080
    v_mfma_f32_32x32x16_bf16 v[156:171], v[78:81], v[62:65], v[156:171]
    ds_read_b128 v[90:93], v52 offset:8192
    ds_read_b128 v[94:97], v52 offset:12288
    s_waitcnt lgkmcnt(9)
    v_mfma_f32_32x32x16_bf16 v[172:187], v[74:77], v[66:69], v[172:187]
    v_mfma_f32_32x32x16_bf16 v[188:203], v[78:81], v[66:69], v[188:203]
    s_waitcnt lgkmcnt(8)
    v_mfma_f32_32x32x16_bf16 v[204:219], v[74:77], v[70:73], v[204:219]
    v_mfma_f32_32x32x16_bf16 v[220:235], v[78:81], v[70:73], v[220:235]
    s_waitcnt lgkmcnt(0)
    s_waitcnt vmcnt(0)
    s_barrier
    ds_read_b128 v[58:61], v45 offset:0
    ds_read_b64_tr_b16 v[74:75], v53 offset:32768
    ds_read_b64_tr_b16 v[76:77], v53 offset:33792
    ds_read_b128 v[62:65], v45 offset:4096
    ds_read_b64_tr_b16 v[78:79], v54 offset:32768
    ds_read_b64_tr_b16 v[80:81], v54 offset:33792
    ds_read_b128 v[66:69], v45 offset:8192
    ds_read_b128 v[70:73], v45 offset:12288
    v_mfma_f32_32x32x16_bf16 v[108:123], v[98:101], v[82:85], v[108:123]
    s_lshl_b32 s48, s50, 7
    s_add_u32 s48, s48, s53
    s_add_u32 m0, s43, 65536
    s_nop 0
    buffer_load_dwordx4 v37, s[8:11], s48 offen lds
    v_mfma_f32_32x32x16_bf16 v[124:139], v[102:105], v[82:85], v[124:139]
    s_add_u32 m0, s43, 73728
    s_nop 0
    buffer_load_dwordx4 v38, s[8:11], s48 offen lds
    v_mfma_f32_32x32x16_bf16 v[140:155], v[98:101], v[86:89], v[140:155]
    s_add_u32 m0, s43, 81920
    s_nop 0
    buffer_load_dwordx4 v39, s[8:11], s48 offen lds
    v_mfma_f32_32x32x16_bf16 v[156:171], v[102:105], v[86:89], v[156:171]
    s_add_u32 m0, s43, 90112
    s_nop 0
    buffer_load_dwordx4 v40, s[8:11], s48 offen lds
    v_mfma_f32_32x32x16_bf16 v[172:187], v[98:101], v[90:93], v[172:187]
    s_mul_i32 s49, s50, 524288
    s_add_u32 s49, s49, s54
    s_add_u32 s50, s50, 1
    s_cmp_eq_u32 s50, 8
    s_cselect_b32 s50, 0, s50
    s_add_u32 m0, s43, 98304
    s_nop 0
    buffer_load_dwordx4 v41, s[12:15], s49 offen lds
    v_mfma_f32_32x32x16_bf16 v[188:203], v[102:105], v[90:93], v[188:203]
    s_add_u32 m0, s43, 106496
    s_nop 0
    buffer_load_dwordx4 v42, s[12:15], s49 offen lds
    v_mfma_f32_32x32x16_bf16 v[204:219], v[98:101], v[94:97], v[204:219]
    s_add_u32 m0, s43, 114688
    s_nop 0
    buffer_load_dwordx4 v43, s[12:15], s49 offen lds
    v_mfma_f32_32x32x16_bf16 v[220:235], v[102:105], v[94:97], v[220:235]
    s_add_u32 m0, s43, 122880
    s_nop 0
    buffer_load_dwordx4 v44, s[12:15], s49 offen lds
    s_waitcnt lgkmcnt(5)
    v_mfma_f32_32x32x16_bf16 v[108:123], v[74:77], v[58:61], v[108:123]
    ds_read_b128 v[82:85], v46 offset:0
    ds_read_b64_tr_b16 v[98:99], v53 offset:36864
    s_waitcnt lgkmcnt(4)
    v_mfma_f32_32x32x16_bf16 v[124:139], v[78:81], v[58:61], v[124:139]
    ds_read_b64_tr_b16 v[100:101], v53 offset:37888
    ds_read_b128 v[86:89], v46 offset:4096
    v_mfma_f32_32x32x16_bf16 v[140:155], v[74:77], v[62:65], v[140:155]
    ds_read_b64_tr_b16 v[102:103], v54 offset:36864
    ds_read_b64_tr_b16 v[104:105], v54 offset:37888
    v_mfma_f32_32x32x16_bf16 v[156:171], v[78:81], v[62:65], v[156:171]
    ds_read_b128 v[90:93], v46 offset:8192
    ds_read_b128 v[94:97], v46 offset:12288
    s_waitcnt lgkmcnt(9)
    v_mfma_f32_32x32x16_bf16 v[172:187], v[74:77], v[66:69], v[172:187]
    v_mfma_f32_32x32x16_bf16 v[188:203], v[78:81], v[66:69], v[188:203]
    s_waitcnt lgkmcnt(8)
    v_mfma_f32_32x32x16_bf16 v[204:219], v[74:77], v[70:73], v[204:219]
    v_mfma_f32_32x32x16_bf16 v[220:235], v[78:81], v[70:73], v[220:235]
    s_waitcnt lgkmcnt(5)
    v_mfma_f32_32x32x16_bf16 v[108:123], v[98:101], v[82:85], v[108:123]
    ds_read_b128 v[58:61], v47 offset:0
    ds_read_b64_tr_b16 v[74:75], v53 offset:40960
    s_waitcnt lgkmcnt(4)
    v_mfma_f32_32x32x16_bf16 v[124:139], v[102:105], v[82:85], v[124:139]
    ds_read_b64_tr_b16 v[76:77], v53 offset:41984
    ds_read_b128 v[62:65], v47 offset:4096
    v_mfma_f32_32x32x16_bf16 v[140:155], v[98:101], v[86:89], v[140:155]
    ds_read_b64_tr_b16 v[78:79], v54 offset:40960
    ds_read_b64_tr_b16 v[80:81], v54 offset:41984
    v_mfma_f32_32x32x16_bf16 v[156:171], v[102:105], v[86:89], v[156:171]
    ds_read_b128 v[66:69], v47 offset:8192
    ds_read_b128 v[70:73], v47 offset:12288
    s_waitcnt lgkmcnt(9)
    v_mfma_f32_32x32x16_bf16 v[172:187], v[98:101], v[90:93], v[172:187]
    v_mfma_f32_32x32x16_bf16 v[188:203], v[102:105], v[90:93], v[188:203]
    s_waitcnt lgkmcnt(8)
    v_mfma_f32_32x32x16_bf16 v[204:219], v[98:101], v[94:97], v[204:219]
    v_mfma_f32_32x32x16_bf16 v[220:235], v[102:105], v[94:97], v[220:235]
    s_waitcnt lgkmcnt(5)
    v_mfma_f32_32x32x16_bf16 v[108:123], v[74:77], v[58:61], v[108:123]
    ds_read_b128 v[82:85], v48 offset:0
    ds_read_b64_tr_b16 v[98:99], v53 offset:45056
    s_waitcnt lgkmcnt(4)
    v_mfma_f32_32x32x16_bf16 v[124:139], v[78:81], v[58:61], v[124:139]
    ds_read_b64_tr_b16 v[100:101], v53 offset:46080
    ds_read_b128 v[86:89], v48 offset:4096
    v_mfma_f32_32x32x16_bf16 v[140:155], v[74:77], v[62:65], v[140:155]
    ds_read_b64_tr_b16 v[102:103], v54 offset:45056
    ds_read_b64_tr_b16 v[104:105], v54 offset:46080
    v_mfma_f32_32x32x16_bf16 v[156:171], v[78:81], v[62:65], v[156:171]
    ds_read_b128 v[90:93], v48 offset:8192
    ds_read_b128 v[94:97], v48 offset:12288
    s_waitcnt lgkmcnt(9)
    v_mfma_f32_32x32x16_bf16 v[172:187], v[74:77], v[66:69], v[172:187]
    v_mfma_f32_32x32x16_bf16 v[188:203], v[78:81], v[66:69], v[188:203]
    s_waitcnt lgkmcnt(8)
    v_mfma_f32_32x32x16_bf16 v[204:219], v[74:77], v[70:73], v[204:219]
    v_mfma_f32_32x32x16_bf16 v[220:235], v[78:81], v[70:73], v[220:235]
    s_waitcnt lgkmcnt(0)
    s_waitcnt vmcnt(0)
    s_barrier
    ds_read_b128 v[58:61], v49 offset:0
    ds_read_b64_tr_b16 v[74:75], v55 offset:32768
    ds_read_b64_tr_b16 v[76:77], v55 offset:33792
    ds_read_b128 v[62:65], v49 offset:4096
    ds_read_b64_tr_b16 v[78:79], v56 offset:32768
    ds_read_b64_tr_b16 v[80:81], v56 offset:33792
    ds_read_b128 v[66:69], v49 offset:8192
    ds_read_b128 v[70:73], v49 offset:12288
    v_mfma_f32_32x32x16_bf16 v[108:123], v[98:101], v[82:85], v[108:123]
    s_lshl_b32 s48, s50, 7
    s_add_u32 s48, s48, s53
    s_add_u32 m0, s43, 0
    s_nop 0
    buffer_load_dwordx4 v37, s[8:11], s48 offen lds
    v_mfma_f32_32x32x16_bf16 v[124:139], v[102:105], v[82:85], v[124:139]
    s_add_u32 m0, s43, 8192
    s_nop 0
    buffer_load_dwordx4 v38, s[8:11], s48 offen lds
    v_mfma_f32_32x32x16_bf16 v[140:155], v[98:101], v[86:89], v[140:155]
    s_add_u32 m0, s43, 16384
    s_nop 0
    buffer_load_dwordx4 v39, s[8:11], s48 offen lds
    v_mfma_f32_32x32x16_bf16 v[156:171], v[102:105], v[86:89], v[156:171]
    s_add_u32 m0, s43, 24576
    s_nop 0
    buffer_load_dwordx4 v40, s[8:11], s48 offen lds
    v_mfma_f32_32x32x16_bf16 v[172:187], v[98:101], v[90:93], v[172:187]
    s_mul_i32 s49, s50, 524288
    s_add_u32 s49, s49, s54
    s_add_u32 s50, s50, 1
    s_cmp_eq_u32 s50, 8
    s_cselect_b32 s50, 0, s50
    s_add_u32 m0, s43, 32768
    s_nop 0
    buffer_load_dwordx4 v41, s[12:15], s49 offen lds
    v_mfma_f32_32x32x16_bf16 v[188:203], v[102:105], v[90:93], v[188:203]
    s_add_u32 m0, s43, 40960
    s_nop 0
    buffer_load_dwordx4 v42, s[12:15], s49 offen lds
    v_mfma_f32_32x32x16_bf16 v[204:219], v[98:101], v[94:97], v[204:219]
    s_add_u32 m0, s43, 49152
    s_nop 0
    buffer_load_dwordx4 v43, s[12:15], s49 offen lds
    v_mfma_f32_32x32x16_bf16 v[220:235], v[102:105], v[94:97], v[220:235]
    s_add_u32 m0, s43, 57344
    s_nop 0
    buffer_load_dwordx4 v44, s[12:15], s49 offen lds
    s_waitcnt lgkmcnt(5)
    v_mfma_f32_32x32x16_bf16 v[108:123], v[74:77], v[58:61], v[108:123]
    ds_read_b128 v[82:85], v50 offset:0
    ds_read_b64_tr_b16 v[98:99], v55 offset:36864
    s_waitcnt lgkmcnt(4)
    v_mfma_f32_32x32x16_bf16 v[124:139], v[78:81], v[58:61], v[124:139]
    ds_read_b64_tr_b16 v[100:101], v55 offset:37888
    ds_read_b128 v[86:89], v50 offset:4096
    v_mfma_f32_32x32x16_bf16 v[140:155], v[74:77], v[62:65], v[140:155]
    ds_read_b64_tr_b16 v[102:103], v56 offset:36864
    ds_read_b64_tr_b16 v[104:105], v56 offset:37888
    v_mfma_f32_32x32x16_bf16 v[156:171], v[78:81], v[62:65], v[156:171]
    ds_read_b128 v[90:93], v50 offset:8192
    ds_read_b128 v[94:97], v50 offset:12288
    s_waitcnt lgkmcnt(9)
    v_mfma_f32_32x32x16_bf16 v[172:187], v[74:77], v[66:69], v[172:187]
    v_mfma_f32_32x32x16_bf16 v[188:203], v[78:81], v[66:69], v[188:203]
    s_waitcnt lgkmcnt(8)
    v_mfma_f32_32x32x16_bf16 v[204:219], v[74:77], v[70:73], v[204:219]
    v_mfma_f32_32x32x16_bf16 v[220:235], v[78:81], v[70:73], v[220:235]
    s_waitcnt lgkmcnt(5)
    v_mfma_f32_32x32x16_bf16 v[108:123], v[98:101], v[82:85], v[108:123]
    ds_read_b128 v[58:61], v51 offset:0
    ds_read_b64_tr_b16 v[74:75], v55 offset:40960
    s_waitcnt lgkmcnt(4)
    v_mfma_f32_32x32x16_bf16 v[124:139], v[102:105], v[82:85], v[124:139]
    ds_read_b64_tr_b16 v[76:77], v55 offset:41984
    ds_read_b128 v[62:65], v51 offset:4096
    v_mfma_f32_32x32x16_bf16 v[140:155], v[98:101], v[86:89], v[140:155]
    ds_read_b64_tr_b16 v[78:79], v56 offset:40960
    ds_read_b64_tr_b16 v[80:81], v56 offset:41984
    v_mfma_f32_32x32x16_bf16 v[156:171], v[102:105], v[86:89], v[156:171]
    ds_read_b128 v[66:69], v51 offset:8192
    ds_read_b128 v[70:73], v51 offset:12288
    s_waitcnt lgkmcnt(9)
    v_mfma_f32_32x32x16_bf16 v[172:187], v[98:101], v[90:93], v[172:187]
    v_mfma_f32_32x32x16_bf16 v[188:203], v[102:105], v[90:93], v[188:203]
    s_waitcnt lgkmcnt(8)
    v_mfma_f32_32x32x16_bf16 v[204:219], v[98:101], v[94:97], v[204:219]
    v_mfma_f32_32x32x16_bf16 v[220:235], v[102:105], v[94:97], v[220:235]
    s_waitcnt lgkmcnt(5)
    v_mfma_f32_32x32x16_bf16 v[108:123], v[74:77], v[58:61], v[108:123]
    ds_read_b128 v[82:85], v52 offset:0
    ds_read_b64_tr_b16 v[98:99], v55 offset:45056
    s_waitcnt lgkmcnt(4)
    v_mfma_f32_32x32x16_bf16 v[124:139], v[78:81], v[58:61], v[124:139]
    ds_read_b64_tr_b16 v[100:101], v55 offset:46080
    ds_read_b128 v[86:89], v52 offset:4096
    v_mfma_f32_32x32x16_bf16 v[140:155], v[74:77], v[62:65], v[140:155]
    ds_read_b64_tr_b16 v[102:103], v56 offset:45056
    ds_read_b64_tr_b16 v[104:105], v56 offset:46080
    v_mfma_f32_32x32x16_bf16 v[156:171], v[78:81], v[62:65], v[156:171]
    ds_read_b128 v[90:93], v52 offset:8192
    ds_read_b128 v[94:97], v52 offset:12288
    s_waitcnt lgkmcnt(9)
    v_mfma_f32_32x32x16_bf16 v[172:187], v[74:77], v[66:69], v[172:187]
    v_mfma_f32_32x32x16_bf16 v[188:203], v[78:81], v[66:69], v[188:203]
    s_waitcnt lgkmcnt(8)
    v_mfma_f32_32x32x16_bf16 v[204:219], v[74:77], v[70:73], v[204:219]
    v_mfma_f32_32x32x16_bf16 v[220:235], v[78:81], v[70:73], v[220:235]
    s_waitcnt lgkmcnt(0)
    s_waitcnt vmcnt(0)
    s_barrier
    ds_read_b128 v[58:61], v45 offset:0
    ds_read_b64_tr_b16 v[74:75], v53 offset:32768
    ds_read_b64_tr_b16 v[76:77], v53 offset:33792
    ds_read_b128 v[62:65], v45 offset:4096
    ds_read_b64_tr_b16 v[78:79], v54 offset:32768
    ds_read_b64_tr_b16 v[80:81], v54 offset:33792
    ds_read_b128 v[66:69], v45 offset:8192
    ds_read_b128 v[70:73], v45 offset:12288
    v_mfma_f32_32x32x16_bf16 v[108:123], v[98:101], v[82:85], v[108:123]
    s_lshl_b32 s48, s50, 7
    s_add_u32 s48, s48, s53
    s_add_u32 m0, s43, 65536
    s_nop 0
    buffer_load_dwordx4 v37, s[8:11], s48 offen lds
    v_mfma_f32_32x32x16_bf16 v[124:139], v[102:105], v[82:85], v[124:139]
    s_add_u32 m0, s43, 73728
    s_nop 0
    buffer_load_dwordx4 v38, s[8:11], s48 offen lds
    v_mfma_f32_32x32x16_bf16 v[140:155], v[98:101], v[86:89], v[140:155]
    s_add_u32 m0, s43, 81920
    s_nop 0
    buffer_load_dwordx4 v39, s[8:11], s48 offen lds
    v_mfma_f32_32x32x16_bf16 v[156:171], v[102:105], v[86:89], v[156:171]
    s_add_u32 m0, s43, 90112
    s_nop 0
    buffer_load_dwordx4 v40, s[8:11], s48 offen lds
    v_mfma_f32_32x32x16_bf16 v[172:187], v[98:101], v[90:93], v[172:187]
    s_mul_i32 s49, s50, 524288
    s_add_u32 s49, s49, s54
    s_add_u32 s50, s50, 1
    s_cmp_eq_u32 s50, 8
    s_cselect_b32 s50, 0, s50
    s_add_u32 m0, s43, 98304
    s_nop 0
    buffer_load_dwordx4 v41, s[12:15], s49 offen lds
    v_mfma_f32_32x32x16_bf16 v[188:203], v[102:105], v[90:93], v[188:203]
    s_add_u32 m0, s43, 106496
    s_nop 0
    buffer_load_dwordx4 v42, s[12:15], s49 offen lds
    v_mfma_f32_32x32x16_bf16 v[204:219], v[98:101], v[94:97], v[204:219]
    s_add_u32 m0, s43, 114688
    s_nop 0
    buffer_load_dwordx4 v43, s[12:15], s49 offen lds
    v_mfma_f32_32x32x16_bf16 v[220:235], v[102:105], v[94:97], v[220:235]
    s_add_u32 m0, s43, 122880
    s_nop 0
    buffer_load_dwordx4 v44, s[12:15], s49 offen lds
    s_waitcnt lgkmcnt(5)
    v_mfma_f32_32x32x16_bf16 v[108:123], v[74:77], v[58:61], v[108:123]
    ds_read_b128 v[82:85], v46 offset:0
    ds_read_b64_tr_b16 v[98:99], v53 offset:36864
    s_waitcnt lgkmcnt(4)
    v_mfma_f32_32x32x16_bf16 v[124:139], v[78:81], v[58:61], v[124:139]
    ds_read_b64_tr_b16 v[100:101], v53 offset:37888
    ds_read_b128 v[86:89], v46 offset:4096
    v_mfma_f32_32x32x16_bf16 v[140:155], v[74:77], v[62:65], v[140:155]
    ds_read_b64_tr_b16 v[102:103], v54 offset:36864
    ds_read_b64_tr_b16 v[104:105], v54 offset:37888
    v_mfma_f32_32x32x16_bf16 v[156:171], v[78:81], v[62:65], v[156:171]
    ds_read_b128 v[90:93], v46 offset:8192
    ds_read_b128 v[94:97], v46 offset:12288
    s_waitcnt lgkmcnt(9)
    v_mfma_f32_32x32x16_bf16 v[172:187], v[74:77], v[66:69], v[172:187]
    v_mfma_f32_32x32x16_bf16 v[188:203], v[78:81], v[66:69], v[188:203]
    s_waitcnt lgkmcnt(8)
    v_mfma_f32_32x32x16_bf16 v[204:219], v[74:77], v[70:73], v[204:219]
    v_mfma_f32_32x32x16_bf16 v[220:235], v[78:81], v[70:73], v[220:235]
    s_waitcnt lgkmcnt(5)
    v_mfma_f32_32x32x16_bf16 v[108:123], v[98:101], v[82:85], v[108:123]
    ds_read_b128 v[58:61], v47 offset:0
    ds_read_b64_tr_b16 v[74:75], v53 offset:40960
    s_waitcnt lgkmcnt(4)
    v_mfma_f32_32x32x16_bf16 v[124:139], v[102:105], v[82:85], v[124:139]
    ds_read_b64_tr_b16 v[76:77], v53 offset:41984
    ds_read_b128 v[62:65], v47 offset:4096
    v_mfma_f32_32x32x16_bf16 v[140:155], v[98:101], v[86:89], v[140:155]
    ds_read_b64_tr_b16 v[78:79], v54 offset:40960
    ds_read_b64_tr_b16 v[80:81], v54 offset:41984
    v_mfma_f32_32x32x16_bf16 v[156:171], v[102:105], v[86:89], v[156:171]
    ds_read_b128 v[66:69], v47 offset:8192
    ds_read_b128 v[70:73], v47 offset:12288
    s_waitcnt lgkmcnt(9)
    v_mfma_f32_32x32x16_bf16 v[172:187], v[98:101], v[90:93], v[172:187]
    v_mfma_f32_32x32x16_bf16 v[188:203], v[102:105], v[90:93], v[188:203]
    s_waitcnt lgkmcnt(8)
    v_mfma_f32_32x32x16_bf16 v[204:219], v[98:101], v[94:97], v[204:219]
    v_mfma_f32_32x32x16_bf16 v[220:235], v[102:105], v[94:97], v[220:235]
    s_waitcnt lgkmcnt(5)
    v_mfma_f32_32x32x16_bf16 v[108:123], v[74:77], v[58:61], v[108:123]
    ds_read_b128 v[82:85], v48 offset:0
    ds_read_b64_tr_b16 v[98:99], v53 offset:45056
    s_waitcnt lgkmcnt(4)
    v_mfma_f32_32x32x16_bf16 v[124:139], v[78:81], v[58:61], v[124:139]
    ds_read_b64_tr_b16 v[100:101], v53 offset:46080
    ds_read_b128 v[86:89], v48 offset:4096
    v_mfma_f32_32x32x16_bf16 v[140:155], v[74:77], v[62:65], v[140:155]
    ds_read_b64_tr_b16 v[102:103], v54 offset:45056
    ds_read_b64_tr_b16 v[104:105], v54 offset:46080
    v_mfma_f32_32x32x16_bf16 v[156:171], v[78:81], v[62:65], v[156:171]
    ds_read_b128 v[90:93], v48 offset:8192
    ds_read_b128 v[94:97], v48 offset:12288
    s_waitcnt lgkmcnt(9)
    v_mfma_f32_32x32x16_bf16 v[172:187], v[74:77], v[66:69], v[172:187]
    v_mfma_f32_32x32x16_bf16 v[188:203], v[78:81], v[66:69], v[188:203]
    s_waitcnt lgkmcnt(8)
    v_mfma_f32_32x32x16_bf16 v[204:219], v[74:77], v[70:73], v[204:219]
    v_mfma_f32_32x32x16_bf16 v[220:235], v[78:81], v[70:73], v[220:235]
    s_waitcnt lgkmcnt(0)
    s_waitcnt vmcnt(0)
    s_barrier
    ds_read_b128 v[58:61], v49 offset:0
    ds_read_b64_tr_b16 v[74:75], v55 offset:32768
    ds_read_b64_tr_b16 v[76:77], v55 offset:33792
    ds_read_b128 v[62:65], v49 offset:4096
    ds_read_b64_tr_b16 v[78:79], v56 offset:32768
    ds_read_b64_tr_b16 v[80:81], v56 offset:33792
    ds_read_b128 v[66:69], v49 offset:8192
    ds_read_b128 v[70:73], v49 offset:12288
    v_mfma_f32_32x32x16_bf16 v[108:123], v[98:101], v[82:85], v[108:123]
    s_lshl_b32 s48, s50, 7
    s_add_u32 s48, s48, s53
    s_add_u32 m0, s43, 0
    s_nop 0
    buffer_load_dwordx4 v37, s[8:11], s48 offen lds
    v_mfma_f32_32x32x16_bf16 v[124:139], v[102:105], v[82:85], v[124:139]
    s_add_u32 m0, s43, 8192
    s_nop 0
    buffer_load_dwordx4 v38, s[8:11], s48 offen lds
    v_mfma_f32_32x32x16_bf16 v[140:155], v[98:101], v[86:89], v[140:155]
    s_add_u32 m0, s43, 16384
    s_nop 0
    buffer_load_dwordx4 v39, s[8:11], s48 offen lds
    v_mfma_f32_32x32x16_bf16 v[156:171], v[102:105], v[86:89], v[156:171]
    s_add_u32 m0, s43, 24576
    s_nop 0
    buffer_load_dwordx4 v40, s[8:11], s48 offen lds
    v_mfma_f32_32x32x16_bf16 v[172:187], v[98:101], v[90:93], v[172:187]
    s_mul_i32 s49, s50, 524288
    s_add_u32 s49, s49, s54
    s_add_u32 s50, s50, 1
    s_cmp_eq_u32 s50, 8
    s_cselect_b32 s50, 0, s50
    s_add_u32 m0, s43, 32768
    s_nop 0
    buffer_load_dwordx4 v41, s[12:15], s49 offen lds
    v_mfma_f32_32x32x16_bf16 v[188:203], v[102:105], v[90:93], v[188:203]
    s_add_u32 m0, s43, 40960
    s_nop 0
    buffer_load_dwordx4 v42, s[12:15], s49 offen lds
    v_mfma_f32_32x32x16_bf16 v[204:219], v[98:101], v[94:97], v[204:219]
    s_add_u32 m0, s43, 49152
    s_nop 0
    buffer_load_dwordx4 v43, s[12:15], s49 offen lds
    v_mfma_f32_32x32x16_bf16 v[220:235], v[102:105], v[94:97], v[220:235]
    s_add_u32 m0, s43, 57344
    s_nop 0
    buffer_load_dwordx4 v44, s[12:15], s49 offen lds
    s_waitcnt lgkmcnt(5)
    v_mfma_f32_32x32x16_bf16 v[108:123], v[74:77], v[58:61], v[108:123]
    ds_read_b128 v[82:85], v50 offset:0
    ds_read_b64_tr_b16 v[98:99], v55 offset:36864
    s_waitcnt lgkmcnt(4)
    v_mfma_f32_32x32x16_bf16 v[124:139], v[78:81], v[58:61], v[124:139]
    ds_read_b64_tr_b16 v[100:101], v55 offset:37888
    ds_read_b128 v[86:89], v50 offset:4096
    v_mfma_f32_32x32x16_bf16 v[140:155], v[74:77], v[62:65], v[140:155]
    ds_read_b64_tr_b16 v[102:103], v56 offset:36864
    ds_read_b64_tr_b16 v[104:105], v56 offset:37888
    v_mfma_f32_32x32x16_bf16 v[156:171], v[78:81], v[62:65], v[156:171]
    ds_read_b128 v[90:93], v50 offset:8192
    ds_read_b128 v[94:97], v50 offset:12288
    s_waitcnt lgkmcnt(9)
    v_mfma_f32_32x32x16_bf16 v[172:187], v[74:77], v[66:69], v[172:187]
    v_mfma_f32_32x32x16_bf16 v[188:203], v[78:81], v[66:69], v[188:203]
    s_waitcnt lgkmcnt(8)
    v_mfma_f32_32x32x16_bf16 v[204:219], v[74:77], v[70:73], v[204:219]
    v_mfma_f32_32x32x16_bf16 v[220:235], v[78:81], v[70:73], v[220:235]
    s_waitcnt lgkmcnt(5)
    v_mfma_f32_32x32x16_bf16 v[108:123], v[98:101], v[82:85], v[108:123]
    ds_read_b128 v[58:61], v51 offset:0
    ds_read_b64_tr_b16 v[74:75], v55 offset:40960
    s_waitcnt lgkmcnt(4)
    v_mfma_f32_32x32x16_bf16 v[124:139], v[102:105], v[82:85], v[124:139]
    ds_read_b64_tr_b16 v[76:77], v55 offset:41984
    ds_read_b128 v[62:65], v51 offset:4096
    v_mfma_f32_32x32x16_bf16 v[140:155], v[98:101], v[86:89], v[140:155]
    ds_read_b64_tr_b16 v[78:79], v56 offset:40960
    ds_read_b64_tr_b16 v[80:81], v56 offset:41984
    v_mfma_f32_32x32x16_bf16 v[156:171], v[102:105], v[86:89], v[156:171]
    ds_read_b128 v[66:69], v51 offset:8192
    ds_read_b128 v[70:73], v51 offset:12288
    s_waitcnt lgkmcnt(9)
    v_mfma_f32_32x32x16_bf16 v[172:187], v[98:101], v[90:93], v[172:187]
    v_mfma_f32_32x32x16_bf16 v[188:203], v[102:105], v[90:93], v[188:203]
    s_waitcnt lgkmcnt(8)
    v_mfma_f32_32x32x16_bf16 v[204:219], v[98:101], v[94:97], v[204:219]
    v_mfma_f32_32x32x16_bf16 v[220:235], v[102:105], v[94:97], v[220:235]
    s_waitcnt lgkmcnt(5)
    v_mfma_f32_32x32x16_bf16 v[108:123], v[74:77], v[58:61], v[108:123]
    ds_read_b128 v[82:85], v52 offset:0
    ds_read_b64_tr_b16 v[98:99], v55 offset:45056
    s_waitcnt lgkmcnt(4)
    v_mfma_f32_32x32x16_bf16 v[124:139], v[78:81], v[58:61], v[124:139]
    ds_read_b64_tr_b16 v[100:101], v55 offset:46080
    ds_read_b128 v[86:89], v52 offset:4096
    v_mfma_f32_32x32x16_bf16 v[140:155], v[74:77], v[62:65], v[140:155]
    ds_read_b64_tr_b16 v[102:103], v56 offset:45056
    ds_read_b64_tr_b16 v[104:105], v56 offset:46080
    v_mfma_f32_32x32x16_bf16 v[156:171], v[78:81], v[62:65], v[156:171]
    ds_read_b128 v[90:93], v52 offset:8192
    ds_read_b128 v[94:97], v52 offset:12288
    s_waitcnt lgkmcnt(9)
    v_mfma_f32_32x32x16_bf16 v[172:187], v[74:77], v[66:69], v[172:187]
    v_mfma_f32_32x32x16_bf16 v[188:203], v[78:81], v[66:69], v[188:203]
    s_waitcnt lgkmcnt(8)
    v_mfma_f32_32x32x16_bf16 v[204:219], v[74:77], v[70:73], v[204:219]
    v_mfma_f32_32x32x16_bf16 v[220:235], v[78:81], v[70:73], v[220:235]
    s_waitcnt lgkmcnt(0)
    s_waitcnt vmcnt(0)
    s_barrier
    ds_read_b128 v[58:61], v45 offset:0
    ds_read_b64_tr_b16 v[74:75], v53 offset:32768
    ds_read_b64_tr_b16 v[76:77], v53 offset:33792
    ds_read_b128 v[62:65], v45 offset:4096
    ds_read_b64_tr_b16 v[78:79], v54 offset:32768
    ds_read_b64_tr_b16 v[80:81], v54 offset:33792
    ds_read_b128 v[66:69], v45 offset:8192
    ds_read_b128 v[70:73], v45 offset:12288
    v_mfma_f32_32x32x16_bf16 v[108:123], v[98:101], v[82:85], v[108:123]
    s_lshl_b32 s48, s50, 7
    s_add_u32 s48, s48, s53
    s_add_u32 m0, s43, 65536
    s_nop 0
    buffer_load_dwordx4 v37, s[8:11], s48 offen lds
    v_mfma_f32_32x32x16_bf16 v[124:139], v[102:105], v[82:85], v[124:139]
    s_add_u32 m0, s43, 73728
    s_nop 0
    buffer_load_dwordx4 v38, s[8:11], s48 offen lds
    v_mfma_f32_32x32x16_bf16 v[140:155], v[98:101], v[86:89], v[140:155]
    s_add_u32 m0, s43, 81920
    s_nop 0
    buffer_load_dwordx4 v39, s[8:11], s48 offen lds
    v_mfma_f32_32x32x16_bf16 v[156:171], v[102:105], v[86:89], v[156:171]
    s_add_u32 m0, s43, 90112
    s_nop 0
    buffer_load_dwordx4 v40, s[8:11], s48 offen lds
    v_mfma_f32_32x32x16_bf16 v[172:187], v[98:101], v[90:93], v[172:187]
    s_mul_i32 s49, s50, 524288
    s_add_u32 s49, s49, s54
    s_add_u32 s50, s50, 1
    s_cmp_eq_u32 s50, 8
    s_cselect_b32 s50, 0, s50
    s_add_u32 m0, s43, 98304
    s_nop 0
    buffer_load_dwordx4 v41, s[12:15], s49 offen lds
    v_mfma_f32_32x32x16_bf16 v[188:203], v[102:105], v[90:93], v[188:203]
    s_add_u32 m0, s43, 106496
    s_nop 0
    buffer_load_dwordx4 v42, s[12:15], s49 offen lds
    v_mfma_f32_32x32x16_bf16 v[204:219], v[98:101], v[94:97], v[204:219]
    s_add_u32 m0, s43, 114688
    s_nop 0
    buffer_load_dwordx4 v43, s[12:15], s49 offen lds
    v_mfma_f32_32x32x16_bf16 v[220:235], v[102:105], v[94:97], v[220:235]
    s_add_u32 m0, s43, 122880
    s_nop 0
    buffer_load_dwordx4 v44, s[12:15], s49 offen lds
    s_waitcnt lgkmcnt(5)
    v_mfma_f32_32x32x16_bf16 v[108:123], v[74:77], v[58:61], v[108:123]
    ds_read_b128 v[82:85], v46 offset:0
    ds_read_b64_tr_b16 v[98:99], v53 offset:36864
    s_waitcnt lgkmcnt(4)
    v_mfma_f32_32x32x16_bf16 v[124:139], v[78:81], v[58:61], v[124:139]
    ds_read_b64_tr_b16 v[100:101], v53 offset:37888
    ds_read_b128 v[86:89], v46 offset:4096
    v_mfma_f32_32x32x16_bf16 v[140:155], v[74:77], v[62:65], v[140:155]
    ds_read_b64_tr_b16 v[102:103], v54 offset:36864
    ds_read_b64_tr_b16 v[104:105], v54 offset:37888
    v_mfma_f32_32x32x16_bf16 v[156:171], v[78:81], v[62:65], v[156:171]
    ds_read_b128 v[90:93], v46 offset:8192
    ds_read_b128 v[94:97], v46 offset:12288
    s_waitcnt lgkmcnt(9)
    v_mfma_f32_32x32x16_bf16 v[172:187], v[74:77], v[66:69], v[172:187]
    v_mfma_f32_32x32x16_bf16 v[188:203], v[78:81], v[66:69], v[188:203]
    s_waitcnt lgkmcnt(8)
    v_mfma_f32_32x32x16_bf16 v[204:219], v[74:77], v[70:73], v[204:219]
    v_mfma_f32_32x32x16_bf16 v[220:235], v[78:81], v[70:73], v[220:235]
    s_waitcnt lgkmcnt(5)
    v_mfma_f32_32x32x16_bf16 v[108:123], v[98:101], v[82:85], v[108:123]
    ds_read_b128 v[58:61], v47 offset:0
    ds_read_b64_tr_b16 v[74:75], v53 offset:40960
    s_waitcnt lgkmcnt(4)
    v_mfma_f32_32x32x16_bf16 v[124:139], v[102:105], v[82:85], v[124:139]
    ds_read_b64_tr_b16 v[76:77], v53 offset:41984
    ds_read_b128 v[62:65], v47 offset:4096
    v_mfma_f32_32x32x16_bf16 v[140:155], v[98:101], v[86:89], v[140:155]
    ds_read_b64_tr_b16 v[78:79], v54 offset:40960
    ds_read_b64_tr_b16 v[80:81], v54 offset:41984
    v_mfma_f32_32x32x16_bf16 v[156:171], v[102:105], v[86:89], v[156:171]
    ds_read_b128 v[66:69], v47 offset:8192
    ds_read_b128 v[70:73], v47 offset:12288
    s_waitcnt lgkmcnt(9)
    v_mfma_f32_32x32x16_bf16 v[172:187], v[98:101], v[90:93], v[172:187]
    v_mfma_f32_32x32x16_bf16 v[188:203], v[102:105], v[90:93], v[188:203]
    s_waitcnt lgkmcnt(8)
    v_mfma_f32_32x32x16_bf16 v[204:219], v[98:101], v[94:97], v[204:219]
    v_mfma_f32_32x32x16_bf16 v[220:235], v[102:105], v[94:97], v[220:235]
    s_waitcnt lgkmcnt(5)
    v_mfma_f32_32x32x16_bf16 v[108:123], v[74:77], v[58:61], v[108:123]
    ds_read_b128 v[82:85], v48 offset:0
    ds_read_b64_tr_b16 v[98:99], v53 offset:45056
    s_waitcnt lgkmcnt(4)
    v_mfma_f32_32x32x16_bf16 v[124:139], v[78:81], v[58:61], v[124:139]
    ds_read_b64_tr_b16 v[100:101], v53 offset:46080
    ds_read_b128 v[86:89], v48 offset:4096
    v_mfma_f32_32x32x16_bf16 v[140:155], v[74:77], v[62:65], v[140:155]
    ds_read_b64_tr_b16 v[102:103], v54 offset:45056
    ds_read_b64_tr_b16 v[104:105], v54 offset:46080
    v_mfma_f32_32x32x16_bf16 v[156:171], v[78:81], v[62:65], v[156:171]
    ds_read_b128 v[90:93], v48 offset:8192
    ds_read_b128 v[94:97], v48 offset:12288
    s_waitcnt lgkmcnt(9)
    v_mfma_f32_32x32x16_bf16 v[172:187], v[74:77], v[66:69], v[172:187]
    v_mfma_f32_32x32x16_bf16 v[188:203], v[78:81], v[66:69], v[188:203]
    s_waitcnt lgkmcnt(8)
    v_mfma_f32_32x32x16_bf16 v[204:219], v[74:77], v[70:73], v[204:219]
    v_mfma_f32_32x32x16_bf16 v[220:235], v[78:81], v[70:73], v[220:235]
    s_waitcnt lgkmcnt(0)
    s_waitcnt vmcnt(0)
    s_barrier
    ds_read_b128 v[58:61], v49 offset:0
    ds_read_b64_tr_b16 v[74:75], v55 offset:32768
    ds_read_b64_tr_b16 v[76:77], v55 offset:33792
    ds_read_b128 v[62:65], v49 offset:4096
    ds_read_b64_tr_b16 v[78:79], v56 offset:32768
    ds_read_b64_tr_b16 v[80:81], v56 offset:33792
    ds_read_b128 v[66:69], v49 offset:8192
    ds_read_b128 v[70:73], v49 offset:12288
    v_mfma_f32_32x32x16_bf16 v[108:123], v[98:101], v[82:85], v[108:123]
    buffer_load_dwordx4 v[4:7], v8, s[36:39], 0 offen
    v_mfma_f32_32x32x16_bf16 v[124:139], v[102:105], v[82:85], v[124:139]
    buffer_load_dwordx4 v[4:7], v8, s[36:39], s41 offen
    v_mfma_f32_32x32x16_bf16 v[140:155], v[98:101], v[86:89], v[140:155]
    v_mfma_f32_32x32x16_bf16 v[156:171], v[102:105], v[86:89], v[156:171]
    v_mfma_f32_32x32x16_bf16 v[172:187], v[98:101], v[90:93], v[172:187]
    v_mfma_f32_32x32x16_bf16 v[188:203], v[102:105], v[90:93], v[188:203]
    v_mfma_f32_32x32x16_bf16 v[204:219], v[98:101], v[94:97], v[204:219]
    v_mfma_f32_32x32x16_bf16 v[220:235], v[102:105], v[94:97], v[220:235]
    s_waitcnt lgkmcnt(5)
    v_mfma_f32_32x32x16_bf16 v[108:123], v[74:77], v[58:61], v[108:123]
    ds_read_b128 v[82:85], v50 offset:0
    ds_read_b64_tr_b16 v[98:99], v55 offset:36864
    s_waitcnt lgkmcnt(4)
    v_mfma_f32_32x32x16_bf16 v[124:139], v[78:81], v[58:61], v[124:139]
    ds_read_b64_tr_b16 v[100:101], v55 offset:37888
    ds_read_b128 v[86:89], v50 offset:4096
    v_mfma_f32_32x32x16_bf16 v[140:155], v[74:77], v[62:65], v[140:155]
    ds_read_b64_tr_b16 v[102:103], v56 offset:36864
    ds_read_b64_tr_b16 v[104:105], v56 offset:37888
    v_mfma_f32_32x32x16_bf16 v[156:171], v[78:81], v[62:65], v[156:171]
    ds_read_b128 v[90:93], v50 offset:8192
    ds_read_b128 v[94:97], v50 offset:12288
    s_waitcnt lgkmcnt(9)
    v_mfma_f32_32x32x16_bf16 v[172:187], v[74:77], v[66:69], v[172:187]
    v_mfma_f32_32x32x16_bf16 v[188:203], v[78:81], v[66:69], v[188:203]
    s_waitcnt lgkmcnt(8)
    v_mfma_f32_32x32x16_bf16 v[204:219], v[74:77], v[70:73], v[204:219]
    v_mfma_f32_32x32x16_bf16 v[220:235], v[78:81], v[70:73], v[220:235]
    s_waitcnt lgkmcnt(5)
    v_mfma_f32_32x32x16_bf16 v[108:123], v[98:101], v[82:85], v[108:123]
    ds_read_b128 v[58:61], v51 offset:0
    ds_read_b64_tr_b16 v[74:75], v55 offset:40960
    s_waitcnt lgkmcnt(4)
    v_mfma_f32_32x32x16_bf16 v[124:139], v[102:105], v[82:85], v[124:139]
    ds_read_b64_tr_b16 v[76:77], v55 offset:41984
    ds_read_b128 v[62:65], v51 offset:4096
    v_mfma_f32_32x32x16_bf16 v[140:155], v[98:101], v[86:89], v[140:155]
    ds_read_b64_tr_b16 v[78:79], v56 offset:40960
    ds_read_b64_tr_b16 v[80:81], v56 offset:41984
    v_mfma_f32_32x32x16_bf16 v[156:171], v[102:105], v[86:89], v[156:171]
    ds_read_b128 v[66:69], v51 offset:8192
    ds_read_b128 v[70:73], v51 offset:12288
    s_waitcnt lgkmcnt(9)
    v_mfma_f32_32x32x16_bf16 v[172:187], v[98:101], v[90:93], v[172:187]
    v_mfma_f32_32x32x16_bf16 v[188:203], v[102:105], v[90:93], v[188:203]
    s_waitcnt lgkmcnt(8)
    v_mfma_f32_32x32x16_bf16 v[204:219], v[98:101], v[94:97], v[204:219]
    v_mfma_f32_32x32x16_bf16 v[220:235], v[102:105], v[94:97], v[220:235]
    s_waitcnt lgkmcnt(5)
    v_mfma_f32_32x32x16_bf16 v[108:123], v[74:77], v[58:61], v[108:123]
    ds_read_b128 v[82:85], v52 offset:0
    ds_read_b64_tr_b16 v[98:99], v55 offset:45056
    s_waitcnt lgkmcnt(4)
    v_mfma_f32_32x32x16_bf16 v[124:139], v[78:81], v[58:61], v[124:139]
    ds_read_b64_tr_b16 v[100:101], v55 offset:46080
    ds_read_b128 v[86:89], v52 offset:4096
    v_mfma_f32_32x32x16_bf16 v[140:155], v[74:77], v[62:65], v[140:155]
    ds_read_b64_tr_b16 v[102:103], v56 offset:45056
    ds_read_b64_tr_b16 v[104:105], v56 offset:46080
    v_mfma_f32_32x32x16_bf16 v[156:171], v[78:81], v[62:65], v[156:171]
    ds_read_b128 v[90:93], v52 offset:8192
    ds_read_b128 v[94:97], v52 offset:12288
    s_waitcnt lgkmcnt(9)
    v_mfma_f32_32x32x16_bf16 v[172:187], v[74:77], v[66:69], v[172:187]
    v_mfma_f32_32x32x16_bf16 v[188:203], v[78:81], v[66:69], v[188:203]
    s_waitcnt lgkmcnt(8)
    v_mfma_f32_32x32x16_bf16 v[204:219], v[74:77], v[70:73], v[204:219]
    v_mfma_f32_32x32x16_bf16 v[220:235], v[78:81], v[70:73], v[220:235]
    s_waitcnt lgkmcnt(5)
    v_mfma_f32_32x32x16_bf16 v[108:123], v[98:101], v[82:85], v[108:123]
    s_waitcnt lgkmcnt(2)
    v_mfma_f32_32x32x16_bf16 v[124:139], v[102:105], v[82:85], v[124:139]
    v_mfma_f32_32x32x16_bf16 v[140:155], v[98:101], v[86:89], v[140:155]
    v_mfma_f32_32x32x16_bf16 v[156:171], v[102:105], v[86:89], v[156:171]
    s_waitcnt lgkmcnt(1)
    v_mfma_f32_32x32x16_bf16 v[172:187], v[98:101], v[90:93], v[172:187]
    v_mfma_f32_32x32x16_bf16 v[188:203], v[102:105], v[90:93], v[188:203]
    s_waitcnt lgkmcnt(0)
    v_mfma_f32_32x32x16_bf16 v[204:219], v[98:101], v[94:97], v[204:219]
    v_mfma_f32_32x32x16_bf16 v[220:235], v[102:105], v[94:97], v[220:235]
    s_nop 15
    v_lshrrev_b32 v34, 5, v1
    v_and_b32 v35, 31, v1
    s_and_b32 s56, s45, 1
    s_lshl_b32 s53, s40, 13
    v_and_b32 v36, 7, v1
    v_xor_b32 v34, v34, v36
    v_lshlrev_b32 v34, 4, v34
    v_lshl_add_u32 v34, v35, 7, v34
    v_add_u32 v34, s53, v34
    v_xor_b32 v45, 0, v34
    v_xor_b32 v46, 32, v34
    v_xor_b32 v47, 64, v34
    v_xor_b32 v48, 96, v34
    v_add_u32 v34, s53, v32
    s_lshl_b32 s56, s56, 7
    v_lshrrev_b32 v35, 3, v1
    v_lshlrev_b32 v35, 8, v35
    v_lshl_add_u32 v35, v36, 4, v35
    v_add_u32 v35, s56, v35
    v_xor_b32 v36, 0x80, v35
    v_cvt_pk_bf16_f32 v108, v108, v109
    v_cvt_pk_bf16_f32 v109, v110, v111
    v_cvt_pk_bf16_f32 v110, v112, v113
    v_cvt_pk_bf16_f32 v111, v114, v115
    ds_write_b128 v45, v[108:111] offset:0
    v_cvt_pk_bf16_f32 v116, v116, v117
    v_cvt_pk_bf16_f32 v117, v118, v119
    v_cvt_pk_bf16_f32 v118, v120, v121
    v_cvt_pk_bf16_f32 v119, v122, v123
    ds_write_b128 v46, v[116:119] offset:0
    v_cvt_pk_bf16_f32 v124, v124, v125
    v_cvt_pk_bf16_f32 v125, v126, v127
    v_cvt_pk_bf16_f32 v126, v128, v129
    v_cvt_pk_bf16_f32 v127, v130, v131
    ds_write_b128 v47, v[124:127] offset:0
    v_cvt_pk_bf16_f32 v132, v132, v133
    v_cvt_pk_bf16_f32 v133, v134, v135
    v_cvt_pk_bf16_f32 v134, v136, v137
    v_cvt_pk_bf16_f32 v135, v138, v139
    ds_write_b128 v48, v[132:135] offset:0
    ds_read_b128 v[112:115], v34 offset:0
    ds_read_b128 v[120:123], v34 offset:1024
    ds_read_b128 v[128:131], v34 offset:2048
    ds_read_b128 v[136:139], v34 offset:3072
    v_cvt_pk_bf16_f32 v140, v140, v141
    v_cvt_pk_bf16_f32 v141, v142, v143
    v_cvt_pk_bf16_f32 v142, v144, v145
    v_cvt_pk_bf16_f32 v143, v146, v147
    ds_write_b128 v45, v[140:143] offset:4096
    v_cvt_pk_bf16_f32 v148, v148, v149
    v_cvt_pk_bf16_f32 v149, v150, v151
    v_cvt_pk_bf16_f32 v150, v152, v153
    v_cvt_pk_bf16_f32 v151, v154, v155
    ds_write_b128 v46, v[148:151] offset:4096
    v_cvt_pk_bf16_f32 v156, v156, v157
    v_cvt_pk_bf16_f32 v157, v158, v159
    v_cvt_pk_bf16_f32 v158, v160, v161
    v_cvt_pk_bf16_f32 v159, v162, v163
    ds_write_b128 v47, v[156:159] offset:4096
    v_cvt_pk_bf16_f32 v164, v164, v165
    v_cvt_pk_bf16_f32 v165, v166, v167
    v_cvt_pk_bf16_f32 v166, v168, v169
    v_cvt_pk_bf16_f32 v167, v170, v171
    ds_write_b128 v48, v[164:167] offset:4096
    ds_read_b128 v[144:147], v34 offset:4096
    ds_read_b128 v[152:155], v34 offset:5120
    ds_read_b128 v[160:163], v34 offset:6144
    ds_read_b128 v[168:171], v34 offset:7168
    s_waitcnt lgkmcnt(8)
    s_add_u32 s56, s55, 0
    s_add_u32 s54, s56, 4096
    buffer_store_dwordx4 v[112:115], v35, s[28:31], s56 offen offset:0 sc1
    buffer_store_dwordx4 v[120:123], v36, s[28:31], s56 offen offset:2048 sc1
    buffer_store_dwordx4 v[128:131], v35, s[28:31], s54 offen offset:0 sc1
    buffer_store_dwordx4 v[136:139], v36, s[28:31], s54 offen offset:2048 sc1
    v_cvt_pk_bf16_f32 v172, v172, v173
    v_cvt_pk_bf16_f32 v173, v174, v175
    v_cvt_pk_bf16_f32 v174, v176, v177
    v_cvt_pk_bf16_f32 v175, v178, v179
    ds_write_b128 v45, v[172:175] offset:0
    v_cvt_pk_bf16_f32 v180, v180, v181
    v_cvt_pk_bf16_f32 v181, v182, v183
    v_cvt_pk_bf16_f32 v182, v184, v185
    v_cvt_pk_bf16_f32 v183, v186, v187
    ds_write_b128 v46, v[180:183] offset:0
    v_cvt_pk_bf16_f32 v188, v188, v189
    v_cvt_pk_bf16_f32 v189, v190, v191
    v_cvt_pk_bf16_f32 v190, v192, v193
    v_cvt_pk_bf16_f32 v191, v194, v195
    ds_write_b128 v47, v[188:191] offset:0
    v_cvt_pk_bf16_f32 v196, v196, v197
    v_cvt_pk_bf16_f32 v197, v198, v199
    v_cvt_pk_bf16_f32 v198, v200, v201
    v_cvt_pk_bf16_f32 v199, v202, v203
    ds_write_b128 v48, v[196:199] offset:0
    ds_read_b128 v[176:179], v34 offset:0
    ds_read_b128 v[184:187], v34 offset:1024
    ds_read_b128 v[192:195], v34 offset:2048
    ds_read_b128 v[200:203], v34 offset:3072
    s_waitcnt lgkmcnt(8)
    s_add_u32 s56, s55, 8192
    s_add_u32 s54, s56, 4096
    buffer_store_dwordx4 v[144:147], v35, s[28:31], s56 offen offset:0 sc1
    buffer_store_dwordx4 v[152:155], v36, s[28:31], s56 offen offset:2048 sc1
    buffer_store_dwordx4 v[160:163], v35, s[28:31], s54 offen offset:0 sc1
    buffer_store_dwordx4 v[168:171], v36, s[28:31], s54 offen offset:2048 sc1
    v_cvt_pk_bf16_f32 v204, v204, v205
    v_cvt_pk_bf16_f32 v205, v206, v207
    v_cvt_pk_bf16_f32 v206, v208, v209
    v_cvt_pk_bf16_f32 v207, v210, v211
    ds_write_b128 v45, v[204:207] offset:4096
    v_cvt_pk_bf16_f32 v212, v212, v213
    v_cvt_pk_bf16_f32 v213, v214, v215
    v_cvt_pk_bf16_f32 v214, v216, v217
    v_cvt_pk_bf16_f32 v215, v218, v219
    ds_write_b128 v46, v[212:215] offset:4096
    v_cvt_pk_bf16_f32 v220, v220, v221
    v_cvt_pk_bf16_f32 v221, v222, v223
    v_cvt_pk_bf16_f32 v222, v224, v225
    v_cvt_pk_bf16_f32 v223, v226, v227
    ds_write_b128 v47, v[220:223] offset:4096
    v_cvt_pk_bf16_f32 v228, v228, v229
    v_cvt_pk_bf16_f32 v229, v230, v231
    v_cvt_pk_bf16_f32 v230, v232, v233
    v_cvt_pk_bf16_f32 v231, v234, v235
    ds_write_b128 v48, v[228:231] offset:4096
    ds_read_b128 v[208:211], v34 offset:4096
    ds_read_b128 v[216:219], v34 offset:5120
    ds_read_b128 v[224:227], v34 offset:6144
    ds_read_b128 v[232:235], v34 offset:7168
    s_waitcnt lgkmcnt(8)
    s_add_u32 s56, s55, 16384
    s_add_u32 s54, s56, 4096
    buffer_store_dwordx4 v[176:179], v35, s[28:31], s56 offen offset:0 sc1
    buffer_store_dwordx4 v[184:187], v36, s[28:31], s56 offen offset:2048 sc1
    buffer_store_dwordx4 v[192:195], v35, s[28:31], s54 offen offset:0 sc1
    buffer_store_dwordx4 v[200:203], v36, s[28:31], s54 offen offset:2048 sc1
    s_waitcnt lgkmcnt(0)
    s_add_u32 s56, s55, 24576
    s_add_u32 s54, s56, 4096
    buffer_store_dwordx4 v[208:211], v35, s[28:31], s56 offen offset:0 sc1
    buffer_store_dwordx4 v[216:219], v36, s[28:31], s56 offen offset:2048 sc1
    buffer_store_dwordx4 v[224:227], v35, s[28:31], s54 offen offset:0 sc1
    buffer_store_dwordx4 v[232:235], v36, s[28:31], s54 offen offset:2048 sc1
    s_branch kv_kernel_L3
kv_kernel_L2:
    s_lshl_b32 s48, s50, 7
    s_add_u32 s48, s48, s53
    s_add_u32 m0, s43, 0
    s_nop 0
    buffer_load_dwordx4 v37, s[8:11], s48 offen lds
    s_add_u32 m0, s43, 8192
    s_nop 0
    buffer_load_dwordx4 v38, s[8:11], s48 offen lds
    s_add_u32 m0, s43, 16384
    s_nop 0
    buffer_load_dwordx4 v39, s[8:11], s48 offen lds
    s_add_u32 m0, s43, 24576
    s_nop 0
    buffer_load_dwordx4 v40, s[8:11], s48 offen lds
    s_mul_i32 s49, s50, 524288
    s_add_u32 s49, s49, s54
    s_add_u32 s50, s50, 1
    s_cmp_eq_u32 s50, 8
    s_cselect_b32 s50, 0, s50
    s_add_u32 m0, s43, 32768
    s_nop 0
    buffer_load_dwordx4 v41, s[16:19], s49 offen lds
    s_add_u32 m0, s43, 40960
    s_nop 0
    buffer_load_dwordx4 v42, s[16:19], s49 offen lds
    s_add_u32 m0, s43, 49152
    s_nop 0
    buffer_load_dwordx4 v43, s[16:19], s49 offen lds
    s_add_u32 m0, s43, 57344
    s_nop 0
    buffer_load_dwordx4 v44, s[16:19], s49 offen lds
    s_lshl_b32 s48, s50, 7
    s_add_u32 s48, s48, s53
    s_add_u32 m0, s43, 65536
    s_nop 0
    buffer_load_dwordx4 v37, s[8:11], s48 offen lds
    s_add_u32 m0, s43, 73728
    s_nop 0
    buffer_load_dwordx4 v38, s[8:11], s48 offen lds
    s_add_u32 m0, s43, 81920
    s_nop 0
    buffer_load_dwordx4 v39, s[8:11], s48 offen lds
    s_add_u32 m0, s43, 90112
    s_nop 0
    buffer_load_dwordx4 v40, s[8:11], s48 offen lds
    s_mul_i32 s49, s50, 524288
    s_add_u32 s49, s49, s54
    s_add_u32 s50, s50, 1
    s_cmp_eq_u32 s50, 8
    s_cselect_b32 s50, 0, s50
    s_add_u32 m0, s43, 98304
    s_nop 0
    buffer_load_dwordx4 v41, s[16:19], s49 offen lds
    s_add_u32 m0, s43, 106496
    s_nop 0
    buffer_load_dwordx4 v42, s[16:19], s49 offen lds
    s_add_u32 m0, s43, 114688
    s_nop 0
    buffer_load_dwordx4 v43, s[16:19], s49 offen lds
    s_add_u32 m0, s43, 122880
    s_nop 0
    buffer_load_dwordx4 v44, s[16:19], s49 offen lds
    s_waitcnt vmcnt(8)
    s_barrier
    ds_read_b128 v[58:61], v45 offset:0
    ds_read_b64_tr_b16 v[74:75], v53 offset:32768
    ds_read_b64_tr_b16 v[76:77], v53 offset:33792
    ds_read_b128 v[62:65], v45 offset:4096
    ds_read_b64_tr_b16 v[78:79], v54 offset:32768
    ds_read_b64_tr_b16 v[80:81], v54 offset:33792
    ds_read_b128 v[66:69], v45 offset:8192
    ds_read_b128 v[70:73], v45 offset:12288
    s_waitcnt lgkmcnt(5)
    v_mfma_f32_32x32x16_bf16 v[108:123], v[58:61], v[74:77], 0
    ds_read_b128 v[82:85], v46 offset:0
    ds_read_b64_tr_b16 v[98:99], v53 offset:36864
    s_waitcnt lgkmcnt(4)
    v_mfma_f32_32x32x16_bf16 v[124:139], v[58:61], v[78:81], 0
    ds_read_b64_tr_b16 v[100:101], v53 offset:37888
    ds_read_b128 v[86:89], v46 offset:4096
    v_mfma_f32_32x32x16_bf16 v[140:155], v[62:65], v[74:77], 0
    ds_read_b64_tr_b16 v[102:103], v54 offset:36864
    ds_read_b64_tr_b16 v[104:105], v54 offset:37888
    v_mfma_f32_32x32x16_bf16 v[156:171], v[62:65], v[78:81], 0
    ds_read_b128 v[90:93], v46 offset:8192
    ds_read_b128 v[94:97], v46 offset:12288
    s_waitcnt lgkmcnt(9)
    v_mfma_f32_32x32x16_bf16 v[172:187], v[66:69], v[74:77], 0
    v_mfma_f32_32x32x16_bf16 v[188:203], v[66:69], v[78:81], 0
    s_waitcnt lgkmcnt(8)
    v_mfma_f32_32x32x16_bf16 v[204:219], v[70:73], v[74:77], 0
    v_mfma_f32_32x32x16_bf16 v[220:235], v[70:73], v[78:81], 0
    s_waitcnt lgkmcnt(5)
    v_mfma_f32_32x32x16_bf16 v[108:123], v[82:85], v[98:101], v[108:123]
    ds_read_b128 v[58:61], v47 offset:0
    ds_read_b64_tr_b16 v[74:75], v53 offset:40960
    s_waitcnt lgkmcnt(4)
    v_mfma_f32_32x32x16_bf16 v[124:139], v[82:85], v[102:105], v[124:139]
    ds_read_b64_tr_b16 v[76:77], v53 offset:41984
    ds_read_b128 v[62:65], v47 offset:4096
    v_mfma_f32_32x32x16_bf16 v[140:155], v[86:89], v[98:101], v[140:155]
    ds_read_b64_tr_b16 v[78:79], v54 offset:40960
    ds_read_b64_tr_b16 v[80:81], v54 offset:41984
    v_mfma_f32_32x32x16_bf16 v[156:171], v[86:89], v[102:105], v[156:171]
    ds_read_b128 v[66:69], v47 offset:8192
    ds_read_b128 v[70:73], v47 offset:12288
    s_waitcnt lgkmcnt(9)
    v_mfma_f32_32x32x16_bf16 v[172:187], v[90:93], v[98:101], v[172:187]
    v_mfma_f32_32x32x16_bf16 v[188:203], v[90:93], v[102:105], v[188:203]
    s_waitcnt lgkmcnt(8)
    v_mfma_f32_32x32x16_bf16 v[204:219], v[94:97], v[98:101], v[204:219]
    v_mfma_f32_32x32x16_bf16 v[220:235], v[94:97], v[102:105], v[220:235]
    s_waitcnt lgkmcnt(5)
    v_mfma_f32_32x32x16_bf16 v[108:123], v[58:61], v[74:77], v[108:123]
    ds_read_b128 v[82:85], v48 offset:0
    ds_read_b64_tr_b16 v[98:99], v53 offset:45056
    s_waitcnt lgkmcnt(4)
    v_mfma_f32_32x32x16_bf16 v[124:139], v[58:61], v[78:81], v[124:139]
    ds_read_b64_tr_b16 v[100:101], v53 offset:46080
    ds_read_b128 v[86:89], v48 offset:4096
    v_mfma_f32_32x32x16_bf16 v[140:155], v[62:65], v[74:77], v[140:155]
    ds_read_b64_tr_b16 v[102:103], v54 offset:45056
    ds_read_b64_tr_b16 v[104:105], v54 offset:46080
    v_mfma_f32_32x32x16_bf16 v[156:171], v[62:65], v[78:81], v[156:171]
    ds_read_b128 v[90:93], v48 offset:8192
    ds_read_b128 v[94:97], v48 offset:12288
    s_waitcnt lgkmcnt(9)
    v_mfma_f32_32x32x16_bf16 v[172:187], v[66:69], v[74:77], v[172:187]
    v_mfma_f32_32x32x16_bf16 v[188:203], v[66:69], v[78:81], v[188:203]
    s_waitcnt lgkmcnt(8)
    v_mfma_f32_32x32x16_bf16 v[204:219], v[70:73], v[74:77], v[204:219]
    v_mfma_f32_32x32x16_bf16 v[220:235], v[70:73], v[78:81], v[220:235]
    s_waitcnt lgkmcnt(0)
    s_waitcnt vmcnt(0)
    s_barrier
    ds_read_b128 v[58:61], v49 offset:0
    ds_read_b64_tr_b16 v[74:75], v55 offset:32768
    ds_read_b64_tr_b16 v[76:77], v55 offset:33792
    ds_read_b128 v[62:65], v49 offset:4096
    ds_read_b64_tr_b16 v[78:79], v56 offset:32768
    ds_read_b64_tr_b16 v[80:81], v56 offset:33792
    ds_read_b128 v[66:69], v49 offset:8192
    ds_read_b128 v[70:73], v49 offset:12288
    v_mfma_f32_32x32x16_bf16 v[108:123], v[82:85], v[98:101], v[108:123]
    s_lshl_b32 s48, s50, 7
    s_add_u32 s48, s48, s53
    s_add_u32 m0, s43, 0
    s_nop 0
    buffer_load_dwordx4 v37, s[8:11], s48 offen lds
    v_mfma_f32_32x32x16_bf16 v[124:139], v[82:85], v[102:105], v[124:139]
    s_add_u32 m0, s43, 8192
    s_nop 0
    buffer_load_dwordx4 v38, s[8:11], s48 offen lds
    v_mfma_f32_32x32x16_bf16 v[140:155], v[86:89], v[98:101], v[140:155]
    s_add_u32 m0, s43, 16384
    s_nop 0
    buffer_load_dwordx4 v39, s[8:11], s48 offen lds
    v_mfma_f32_32x32x16_bf16 v[156:171], v[86:89], v[102:105], v[156:171]
    s_add_u32 m0, s43, 24576
    s_nop 0
    buffer_load_dwordx4 v40, s[8:11], s48 offen lds
    v_mfma_f32_32x32x16_bf16 v[172:187], v[90:93], v[98:101], v[172:187]
    s_mul_i32 s49, s50, 524288
    s_add_u32 s49, s49, s54
    s_add_u32 s50, s50, 1
    s_cmp_eq_u32 s50, 8
    s_cselect_b32 s50, 0, s50
    s_add_u32 m0, s43, 32768
    s_nop 0
    buffer_load_dwordx4 v41, s[16:19], s49 offen lds
    v_mfma_f32_32x32x16_bf16 v[188:203], v[90:93], v[102:105], v[188:203]
    s_add_u32 m0, s43, 40960
    s_nop 0
    buffer_load_dwordx4 v42, s[16:19], s49 offen lds
    v_mfma_f32_32x32x16_bf16 v[204:219], v[94:97], v[98:101], v[204:219]
    s_add_u32 m0, s43, 49152
    s_nop 0
    buffer_load_dwordx4 v43, s[16:19], s49 offen lds
    v_mfma_f32_32x32x16_bf16 v[220:235], v[94:97], v[102:105], v[220:235]
    s_add_u32 m0, s43, 57344
    s_nop 0
    buffer_load_dwordx4 v44, s[16:19], s49 offen lds
    s_waitcnt lgkmcnt(5)
    v_mfma_f32_32x32x16_bf16 v[108:123], v[58:61], v[74:77], v[108:123]
    ds_read_b128 v[82:85], v50 offset:0
    ds_read_b64_tr_b16 v[98:99], v55 offset:36864
    s_waitcnt lgkmcnt(4)
    v_mfma_f32_32x32x16_bf16 v[124:139], v[58:61], v[78:81], v[124:139]
    ds_read_b64_tr_b16 v[100:101], v55 offset:37888
    ds_read_b128 v[86:89], v50 offset:4096
    v_mfma_f32_32x32x16_bf16 v[140:155], v[62:65], v[74:77], v[140:155]
    ds_read_b64_tr_b16 v[102:103], v56 offset:36864
    ds_read_b64_tr_b16 v[104:105], v56 offset:37888
    v_mfma_f32_32x32x16_bf16 v[156:171], v[62:65], v[78:81], v[156:171]
    ds_read_b128 v[90:93], v50 offset:8192
    ds_read_b128 v[94:97], v50 offset:12288
    s_waitcnt lgkmcnt(9)
    v_mfma_f32_32x32x16_bf16 v[172:187], v[66:69], v[74:77], v[172:187]
    v_mfma_f32_32x32x16_bf16 v[188:203], v[66:69], v[78:81], v[188:203]
    s_waitcnt lgkmcnt(8)
    v_mfma_f32_32x32x16_bf16 v[204:219], v[70:73], v[74:77], v[204:219]
    v_mfma_f32_32x32x16_bf16 v[220:235], v[70:73], v[78:81], v[220:235]
    s_waitcnt lgkmcnt(5)
    v_mfma_f32_32x32x16_bf16 v[108:123], v[82:85], v[98:101], v[108:123]
    ds_read_b128 v[58:61], v51 offset:0
    ds_read_b64_tr_b16 v[74:75], v55 offset:40960
    s_waitcnt lgkmcnt(4)
    v_mfma_f32_32x32x16_bf16 v[124:139], v[82:85], v[102:105], v[124:139]
    ds_read_b64_tr_b16 v[76:77], v55 offset:41984
    ds_read_b128 v[62:65], v51 offset:4096
    v_mfma_f32_32x32x16_bf16 v[140:155], v[86:89], v[98:101], v[140:155]
    ds_read_b64_tr_b16 v[78:79], v56 offset:40960
    ds_read_b64_tr_b16 v[80:81], v56 offset:41984
    v_mfma_f32_32x32x16_bf16 v[156:171], v[86:89], v[102:105], v[156:171]
    ds_read_b128 v[66:69], v51 offset:8192
    ds_read_b128 v[70:73], v51 offset:12288
    s_waitcnt lgkmcnt(9)
    v_mfma_f32_32x32x16_bf16 v[172:187], v[90:93], v[98:101], v[172:187]
    v_mfma_f32_32x32x16_bf16 v[188:203], v[90:93], v[102:105], v[188:203]
    s_waitcnt lgkmcnt(8)
    v_mfma_f32_32x32x16_bf16 v[204:219], v[94:97], v[98:101], v[204:219]
    v_mfma_f32_32x32x16_bf16 v[220:235], v[94:97], v[102:105], v[220:235]
    s_waitcnt lgkmcnt(5)
    v_mfma_f32_32x32x16_bf16 v[108:123], v[58:61], v[74:77], v[108:123]
    ds_read_b128 v[82:85], v52 offset:0
    ds_read_b64_tr_b16 v[98:99], v55 offset:45056
    s_waitcnt lgkmcnt(4)
    v_mfma_f32_32x32x16_bf16 v[124:139], v[58:61], v[78:81], v[124:139]
    ds_read_b64_tr_b16 v[100:101], v55 offset:46080
    ds_read_b128 v[86:89], v52 offset:4096
    v_mfma_f32_32x32x16_bf16 v[140:155], v[62:65], v[74:77], v[140:155]
    ds_read_b64_tr_b16 v[102:103], v56 offset:45056
    ds_read_b64_tr_b16 v[104:105], v56 offset:46080
    v_mfma_f32_32x32x16_bf16 v[156:171], v[62:65], v[78:81], v[156:171]
    ds_read_b128 v[90:93], v52 offset:8192
    ds_read_b128 v[94:97], v52 offset:12288
    s_waitcnt lgkmcnt(9)
    v_mfma_f32_32x32x16_bf16 v[172:187], v[66:69], v[74:77], v[172:187]
    v_mfma_f32_32x32x16_bf16 v[188:203], v[66:69], v[78:81], v[188:203]
    s_waitcnt lgkmcnt(8)
    v_mfma_f32_32x32x16_bf16 v[204:219], v[70:73], v[74:77], v[204:219]
    v_mfma_f32_32x32x16_bf16 v[220:235], v[70:73], v[78:81], v[220:235]
    s_waitcnt lgkmcnt(0)
    s_waitcnt vmcnt(0)
    s_barrier
    ds_read_b128 v[58:61], v45 offset:0
    ds_read_b64_tr_b16 v[74:75], v53 offset:32768
    ds_read_b64_tr_b16 v[76:77], v53 offset:33792
    ds_read_b128 v[62:65], v45 offset:4096
    ds_read_b64_tr_b16 v[78:79], v54 offset:32768
    ds_read_b64_tr_b16 v[80:81], v54 offset:33792
    ds_read_b128 v[66:69], v45 offset:8192
    ds_read_b128 v[70:73], v45 offset:12288
    v_mfma_f32_32x32x16_bf16 v[108:123], v[82:85], v[98:101], v[108:123]
    s_lshl_b32 s48, s50, 7
    s_add_u32 s48, s48, s53
    s_add_u32 m0, s43, 65536
    s_nop 0
    buffer_load_dwordx4 v37, s[8:11], s48 offen lds
    v_mfma_f32_32x32x16_bf16 v[124:139], v[82:85], v[102:105], v[124:139]
    s_add_u32 m0, s43, 73728
    s_nop 0
    buffer_load_dwordx4 v38, s[8:11], s48 offen lds
    v_mfma_f32_32x32x16_bf16 v[140:155], v[86:89], v[98:101], v[140:155]
    s_add_u32 m0, s43, 81920
    s_nop 0
    buffer_load_dwordx4 v39, s[8:11], s48 offen lds
    v_mfma_f32_32x32x16_bf16 v[156:171], v[86:89], v[102:105], v[156:171]
    s_add_u32 m0, s43, 90112
    s_nop 0
    buffer_load_dwordx4 v40, s[8:11], s48 offen lds
    v_mfma_f32_32x32x16_bf16 v[172:187], v[90:93], v[98:101], v[172:187]
    s_mul_i32 s49, s50, 524288
    s_add_u32 s49, s49, s54
    s_add_u32 s50, s50, 1
    s_cmp_eq_u32 s50, 8
    s_cselect_b32 s50, 0, s50
    s_add_u32 m0, s43, 98304
    s_nop 0
    buffer_load_dwordx4 v41, s[16:19], s49 offen lds
    v_mfma_f32_32x32x16_bf16 v[188:203], v[90:93], v[102:105], v[188:203]
    s_add_u32 m0, s43, 106496
    s_nop 0
    buffer_load_dwordx4 v42, s[16:19], s49 offen lds
    v_mfma_f32_32x32x16_bf16 v[204:219], v[94:97], v[98:101], v[204:219]
    s_add_u32 m0, s43, 114688
    s_nop 0
    buffer_load_dwordx4 v43, s[16:19], s49 offen lds
    v_mfma_f32_32x32x16_bf16 v[220:235], v[94:97], v[102:105], v[220:235]
    s_add_u32 m0, s43, 122880
    s_nop 0
    buffer_load_dwordx4 v44, s[16:19], s49 offen lds
    s_waitcnt lgkmcnt(5)
    v_mfma_f32_32x32x16_bf16 v[108:123], v[58:61], v[74:77], v[108:123]
    ds_read_b128 v[82:85], v46 offset:0
    ds_read_b64_tr_b16 v[98:99], v53 offset:36864
    s_waitcnt lgkmcnt(4)
    v_mfma_f32_32x32x16_bf16 v[124:139], v[58:61], v[78:81], v[124:139]
    ds_read_b64_tr_b16 v[100:101], v53 offset:37888
    ds_read_b128 v[86:89], v46 offset:4096
    v_mfma_f32_32x32x16_bf16 v[140:155], v[62:65], v[74:77], v[140:155]
    ds_read_b64_tr_b16 v[102:103], v54 offset:36864
    ds_read_b64_tr_b16 v[104:105], v54 offset:37888
    v_mfma_f32_32x32x16_bf16 v[156:171], v[62:65], v[78:81], v[156:171]
    ds_read_b128 v[90:93], v46 offset:8192
    ds_read_b128 v[94:97], v46 offset:12288
    s_waitcnt lgkmcnt(9)
    v_mfma_f32_32x32x16_bf16 v[172:187], v[66:69], v[74:77], v[172:187]
    v_mfma_f32_32x32x16_bf16 v[188:203], v[66:69], v[78:81], v[188:203]
    s_waitcnt lgkmcnt(8)
    v_mfma_f32_32x32x16_bf16 v[204:219], v[70:73], v[74:77], v[204:219]
    v_mfma_f32_32x32x16_bf16 v[220:235], v[70:73], v[78:81], v[220:235]
    s_waitcnt lgkmcnt(5)
    v_mfma_f32_32x32x16_bf16 v[108:123], v[82:85], v[98:101], v[108:123]
    ds_read_b128 v[58:61], v47 offset:0
    ds_read_b64_tr_b16 v[74:75], v53 offset:40960
    s_waitcnt lgkmcnt(4)
    v_mfma_f32_32x32x16_bf16 v[124:139], v[82:85], v[102:105], v[124:139]
    ds_read_b64_tr_b16 v[76:77], v53 offset:41984
    ds_read_b128 v[62:65], v47 offset:4096
    v_mfma_f32_32x32x16_bf16 v[140:155], v[86:89], v[98:101], v[140:155]
    ds_read_b64_tr_b16 v[78:79], v54 offset:40960
    ds_read_b64_tr_b16 v[80:81], v54 offset:41984
    v_mfma_f32_32x32x16_bf16 v[156:171], v[86:89], v[102:105], v[156:171]
    ds_read_b128 v[66:69], v47 offset:8192
    ds_read_b128 v[70:73], v47 offset:12288
    s_waitcnt lgkmcnt(9)
    v_mfma_f32_32x32x16_bf16 v[172:187], v[90:93], v[98:101], v[172:187]
    v_mfma_f32_32x32x16_bf16 v[188:203], v[90:93], v[102:105], v[188:203]
    s_waitcnt lgkmcnt(8)
    v_mfma_f32_32x32x16_bf16 v[204:219], v[94:97], v[98:101], v[204:219]
    v_mfma_f32_32x32x16_bf16 v[220:235], v[94:97], v[102:105], v[220:235]
    s_waitcnt lgkmcnt(5)
    v_mfma_f32_32x32x16_bf16 v[108:123], v[58:61], v[74:77], v[108:123]
    ds_read_b128 v[82:85], v48 offset:0
    ds_read_b64_tr_b16 v[98:99], v53 offset:45056
    s_waitcnt lgkmcnt(4)
    v_mfma_f32_32x32x16_bf16 v[124:139], v[58:61], v[78:81], v[124:139]
    ds_read_b64_tr_b16 v[100:101], v53 offset:46080
    ds_read_b128 v[86:89], v48 offset:4096
    v_mfma_f32_32x32x16_bf16 v[140:155], v[62:65], v[74:77], v[140:155]
    ds_read_b64_tr_b16 v[102:103], v54 offset:45056
    ds_read_b64_tr_b16 v[104:105], v54 offset:46080
    v_mfma_f32_32x32x16_bf16 v[156:171], v[62:65], v[78:81], v[156:171]
    ds_read_b128 v[90:93], v48 offset:8192
    ds_read_b128 v[94:97], v48 offset:12288
    s_waitcnt lgkmcnt(9)
    v_mfma_f32_32x32x16_bf16 v[172:187], v[66:69], v[74:77], v[172:187]
    v_mfma_f32_32x32x16_bf16 v[188:203], v[66:69], v[78:81], v[188:203]
    s_waitcnt lgkmcnt(8)
    v_mfma_f32_32x32x16_bf16 v[204:219], v[70:73], v[74:77], v[204:219]
    v_mfma_f32_32x32x16_bf16 v[220:235], v[70:73], v[78:81], v[220:235]
    s_waitcnt lgkmcnt(0)
    s_waitcnt vmcnt(0)
    s_barrier
    ds_read_b128 v[58:61], v49 offset:0
    ds_read_b64_tr_b16 v[74:75], v55 offset:32768
    ds_read_b64_tr_b16 v[76:77], v55 offset:33792
    ds_read_b128 v[62:65], v49 offset:4096
    ds_read_b64_tr_b16 v[78:79], v56 offset:32768
    ds_read_b64_tr_b16 v[80:81], v56 offset:33792
    ds_read_b128 v[66:69], v49 offset:8192
    ds_read_b128 v[70:73], v49 offset:12288
    v_mfma_f32_32x32x16_bf16 v[108:123], v[82:85], v[98:101], v[108:123]
    s_lshl_b32 s48, s50, 7
    s_add_u32 s48, s48, s53
    s_add_u32 m0, s43, 0
    s_nop 0
    buffer_load_dwordx4 v37, s[8:11], s48 offen lds
    v_mfma_f32_32x32x16_bf16 v[124:139], v[82:85], v[102:105], v[124:139]
    s_add_u32 m0, s43, 8192
    s_nop 0
    buffer_load_dwordx4 v38, s[8:11], s48 offen lds
    v_mfma_f32_32x32x16_bf16 v[140:155], v[86:89], v[98:101], v[140:155]
    s_add_u32 m0, s43, 16384
    s_nop 0
    buffer_load_dwordx4 v39, s[8:11], s48 offen lds
    v_mfma_f32_32x32x16_bf16 v[156:171], v[86:89], v[102:105], v[156:171]
    s_add_u32 m0, s43, 24576
    s_nop 0
    buffer_load_dwordx4 v40, s[8:11], s48 offen lds
    v_mfma_f32_32x32x16_bf16 v[172:187], v[90:93], v[98:101], v[172:187]
    s_mul_i32 s49, s50, 524288
    s_add_u32 s49, s49, s54
    s_add_u32 s50, s50, 1
    s_cmp_eq_u32 s50, 8
    s_cselect_b32 s50, 0, s50
    s_add_u32 m0, s43, 32768
    s_nop 0
    buffer_load_dwordx4 v41, s[16:19], s49 offen lds
    v_mfma_f32_32x32x16_bf16 v[188:203], v[90:93], v[102:105], v[188:203]
    s_add_u32 m0, s43, 40960
    s_nop 0
    buffer_load_dwordx4 v42, s[16:19], s49 offen lds
    v_mfma_f32_32x32x16_bf16 v[204:219], v[94:97], v[98:101], v[204:219]
    s_add_u32 m0, s43, 49152
    s_nop 0
    buffer_load_dwordx4 v43, s[16:19], s49 offen lds
    v_mfma_f32_32x32x16_bf16 v[220:235], v[94:97], v[102:105], v[220:235]
    s_add_u32 m0, s43, 57344
    s_nop 0
    buffer_load_dwordx4 v44, s[16:19], s49 offen lds
    s_waitcnt lgkmcnt(5)
    v_mfma_f32_32x32x16_bf16 v[108:123], v[58:61], v[74:77], v[108:123]
    ds_read_b128 v[82:85], v50 offset:0
    ds_read_b64_tr_b16 v[98:99], v55 offset:36864
    s_waitcnt lgkmcnt(4)
    v_mfma_f32_32x32x16_bf16 v[124:139], v[58:61], v[78:81], v[124:139]
    ds_read_b64_tr_b16 v[100:101], v55 offset:37888
    ds_read_b128 v[86:89], v50 offset:4096
    v_mfma_f32_32x32x16_bf16 v[140:155], v[62:65], v[74:77], v[140:155]
    ds_read_b64_tr_b16 v[102:103], v56 offset:36864
    ds_read_b64_tr_b16 v[104:105], v56 offset:37888
    v_mfma_f32_32x32x16_bf16 v[156:171], v[62:65], v[78:81], v[156:171]
    ds_read_b128 v[90:93], v50 offset:8192
    ds_read_b128 v[94:97], v50 offset:12288
    s_waitcnt lgkmcnt(9)
    v_mfma_f32_32x32x16_bf16 v[172:187], v[66:69], v[74:77], v[172:187]
    v_mfma_f32_32x32x16_bf16 v[188:203], v[66:69], v[78:81], v[188:203]
    s_waitcnt lgkmcnt(8)
    v_mfma_f32_32x32x16_bf16 v[204:219], v[70:73], v[74:77], v[204:219]
    v_mfma_f32_32x32x16_bf16 v[220:235], v[70:73], v[78:81], v[220:235]
    s_waitcnt lgkmcnt(5)
    v_mfma_f32_32x32x16_bf16 v[108:123], v[82:85], v[98:101], v[108:123]
    ds_read_b128 v[58:61], v51 offset:0
    ds_read_b64_tr_b16 v[74:75], v55 offset:40960
    s_waitcnt lgkmcnt(4)
    v_mfma_f32_32x32x16_bf16 v[124:139], v[82:85], v[102:105], v[124:139]
    ds_read_b64_tr_b16 v[76:77], v55 offset:41984
    ds_read_b128 v[62:65], v51 offset:4096
    v_mfma_f32_32x32x16_bf16 v[140:155], v[86:89], v[98:101], v[140:155]
    ds_read_b64_tr_b16 v[78:79], v56 offset:40960
    ds_read_b64_tr_b16 v[80:81], v56 offset:41984
    v_mfma_f32_32x32x16_bf16 v[156:171], v[86:89], v[102:105], v[156:171]
    ds_read_b128 v[66:69], v51 offset:8192
    ds_read_b128 v[70:73], v51 offset:12288
    s_waitcnt lgkmcnt(9)
    v_mfma_f32_32x32x16_bf16 v[172:187], v[90:93], v[98:101], v[172:187]
    v_mfma_f32_32x32x16_bf16 v[188:203], v[90:93], v[102:105], v[188:203]
    s_waitcnt lgkmcnt(8)
    v_mfma_f32_32x32x16_bf16 v[204:219], v[94:97], v[98:101], v[204:219]
    v_mfma_f32_32x32x16_bf16 v[220:235], v[94:97], v[102:105], v[220:235]
    s_waitcnt lgkmcnt(5)
    v_mfma_f32_32x32x16_bf16 v[108:123], v[58:61], v[74:77], v[108:123]
    ds_read_b128 v[82:85], v52 offset:0
    ds_read_b64_tr_b16 v[98:99], v55 offset:45056
    s_waitcnt lgkmcnt(4)
    v_mfma_f32_32x32x16_bf16 v[124:139], v[58:61], v[78:81], v[124:139]
    ds_read_b64_tr_b16 v[100:101], v55 offset:46080
    ds_read_b128 v[86:89], v52 offset:4096
    v_mfma_f32_32x32x16_bf16 v[140:155], v[62:65], v[74:77], v[140:155]
    ds_read_b64_tr_b16 v[102:103], v56 offset:45056
    ds_read_b64_tr_b16 v[104:105], v56 offset:46080
    v_mfma_f32_32x32x16_bf16 v[156:171], v[62:65], v[78:81], v[156:171]
    ds_read_b128 v[90:93], v52 offset:8192
    ds_read_b128 v[94:97], v52 offset:12288
    s_waitcnt lgkmcnt(9)
    v_mfma_f32_32x32x16_bf16 v[172:187], v[66:69], v[74:77], v[172:187]
    v_mfma_f32_32x32x16_bf16 v[188:203], v[66:69], v[78:81], v[188:203]
    s_waitcnt lgkmcnt(8)
    v_mfma_f32_32x32x16_bf16 v[204:219], v[70:73], v[74:77], v[204:219]
    v_mfma_f32_32x32x16_bf16 v[220:235], v[70:73], v[78:81], v[220:235]
    s_waitcnt lgkmcnt(0)
    s_waitcnt vmcnt(0)
    s_barrier
    ds_read_b128 v[58:61], v45 offset:0
    ds_read_b64_tr_b16 v[74:75], v53 offset:32768
    ds_read_b64_tr_b16 v[76:77], v53 offset:33792
    ds_read_b128 v[62:65], v45 offset:4096
    ds_read_b64_tr_b16 v[78:79], v54 offset:32768
    ds_read_b64_tr_b16 v[80:81], v54 offset:33792
    ds_read_b128 v[66:69], v45 offset:8192
    ds_read_b128 v[70:73], v45 offset:12288
    v_mfma_f32_32x32x16_bf16 v[108:123], v[82:85], v[98:101], v[108:123]
    s_lshl_b32 s48, s50, 7
    s_add_u32 s48, s48, s53
    s_add_u32 m0, s43, 65536
    s_nop 0
    buffer_load_dwordx4 v37, s[8:11], s48 offen lds
    v_mfma_f32_32x32x16_bf16 v[124:139], v[82:85], v[102:105], v[124:139]
    s_add_u32 m0, s43, 73728
    s_nop 0
    buffer_load_dwordx4 v38, s[8:11], s48 offen lds
    v_mfma_f32_32x32x16_bf16 v[140:155], v[86:89], v[98:101], v[140:155]
    s_add_u32 m0, s43, 81920
    s_nop 0
    buffer_load_dwordx4 v39, s[8:11], s48 offen lds
    v_mfma_f32_32x32x16_bf16 v[156:171], v[86:89], v[102:105], v[156:171]
    s_add_u32 m0, s43, 90112
    s_nop 0
    buffer_load_dwordx4 v40, s[8:11], s48 offen lds
    v_mfma_f32_32x32x16_bf16 v[172:187], v[90:93], v[98:101], v[172:187]
    s_mul_i32 s49, s50, 524288
    s_add_u32 s49, s49, s54
    s_add_u32 s50, s50, 1
    s_cmp_eq_u32 s50, 8
    s_cselect_b32 s50, 0, s50
    s_add_u32 m0, s43, 98304
    s_nop 0
    buffer_load_dwordx4 v41, s[16:19], s49 offen lds
    v_mfma_f32_32x32x16_bf16 v[188:203], v[90:93], v[102:105], v[188:203]
    s_add_u32 m0, s43, 106496
    s_nop 0
    buffer_load_dwordx4 v42, s[16:19], s49 offen lds
    v_mfma_f32_32x32x16_bf16 v[204:219], v[94:97], v[98:101], v[204:219]
    s_add_u32 m0, s43, 114688
    s_nop 0
    buffer_load_dwordx4 v43, s[16:19], s49 offen lds
    v_mfma_f32_32x32x16_bf16 v[220:235], v[94:97], v[102:105], v[220:235]
    s_add_u32 m0, s43, 122880
    s_nop 0
    buffer_load_dwordx4 v44, s[16:19], s49 offen lds
    s_waitcnt lgkmcnt(5)
    v_mfma_f32_32x32x16_bf16 v[108:123], v[58:61], v[74:77], v[108:123]
    ds_read_b128 v[82:85], v46 offset:0
    ds_read_b64_tr_b16 v[98:99], v53 offset:36864
    s_waitcnt lgkmcnt(4)
    v_mfma_f32_32x32x16_bf16 v[124:139], v[58:61], v[78:81], v[124:139]
    ds_read_b64_tr_b16 v[100:101], v53 offset:37888
    ds_read_b128 v[86:89], v46 offset:4096
    v_mfma_f32_32x32x16_bf16 v[140:155], v[62:65], v[74:77], v[140:155]
    ds_read_b64_tr_b16 v[102:103], v54 offset:36864
    ds_read_b64_tr_b16 v[104:105], v54 offset:37888
    v_mfma_f32_32x32x16_bf16 v[156:171], v[62:65], v[78:81], v[156:171]
    ds_read_b128 v[90:93], v46 offset:8192
    ds_read_b128 v[94:97], v46 offset:12288
    s_waitcnt lgkmcnt(9)
    v_mfma_f32_32x32x16_bf16 v[172:187], v[66:69], v[74:77], v[172:187]
    v_mfma_f32_32x32x16_bf16 v[188:203], v[66:69], v[78:81], v[188:203]
    s_waitcnt lgkmcnt(8)
    v_mfma_f32_32x32x16_bf16 v[204:219], v[70:73], v[74:77], v[204:219]
    v_mfma_f32_32x32x16_bf16 v[220:235], v[70:73], v[78:81], v[220:235]
    s_waitcnt lgkmcnt(5)
    v_mfma_f32_32x32x16_bf16 v[108:123], v[82:85], v[98:101], v[108:123]
    ds_read_b128 v[58:61], v47 offset:0
    ds_read_b64_tr_b16 v[74:75], v53 offset:40960
    s_waitcnt lgkmcnt(4)
    v_mfma_f32_32x32x16_bf16 v[124:139], v[82:85], v[102:105], v[124:139]
    ds_read_b64_tr_b16 v[76:77], v53 offset:41984
    ds_read_b128 v[62:65], v47 offset:4096
    v_mfma_f32_32x32x16_bf16 v[140:155], v[86:89], v[98:101], v[140:155]
    ds_read_b64_tr_b16 v[78:79], v54 offset:40960
    ds_read_b64_tr_b16 v[80:81], v54 offset:41984
    v_mfma_f32_32x32x16_bf16 v[156:171], v[86:89], v[102:105], v[156:171]
    ds_read_b128 v[66:69], v47 offset:8192
    ds_read_b128 v[70:73], v47 offset:12288
    s_waitcnt lgkmcnt(9)
    v_mfma_f32_32x32x16_bf16 v[172:187], v[90:93], v[98:101], v[172:187]
    v_mfma_f32_32x32x16_bf16 v[188:203], v[90:93], v[102:105], v[188:203]
    s_waitcnt lgkmcnt(8)
    v_mfma_f32_32x32x16_bf16 v[204:219], v[94:97], v[98:101], v[204:219]
    v_mfma_f32_32x32x16_bf16 v[220:235], v[94:97], v[102:105], v[220:235]
    s_waitcnt lgkmcnt(5)
    v_mfma_f32_32x32x16_bf16 v[108:123], v[58:61], v[74:77], v[108:123]
    ds_read_b128 v[82:85], v48 offset:0
    ds_read_b64_tr_b16 v[98:99], v53 offset:45056
    s_waitcnt lgkmcnt(4)
    v_mfma_f32_32x32x16_bf16 v[124:139], v[58:61], v[78:81], v[124:139]
    ds_read_b64_tr_b16 v[100:101], v53 offset:46080
    ds_read_b128 v[86:89], v48 offset:4096
    v_mfma_f32_32x32x16_bf16 v[140:155], v[62:65], v[74:77], v[140:155]
    ds_read_b64_tr_b16 v[102:103], v54 offset:45056
    ds_read_b64_tr_b16 v[104:105], v54 offset:46080
    v_mfma_f32_32x32x16_bf16 v[156:171], v[62:65], v[78:81], v[156:171]
    ds_read_b128 v[90:93], v48 offset:8192
    ds_read_b128 v[94:97], v48 offset:12288
    s_waitcnt lgkmcnt(9)
    v_mfma_f32_32x32x16_bf16 v[172:187], v[66:69], v[74:77], v[172:187]
    v_mfma_f32_32x32x16_bf16 v[188:203], v[66:69], v[78:81], v[188:203]
    s_waitcnt lgkmcnt(8)
    v_mfma_f32_32x32x16_bf16 v[204:219], v[70:73], v[74:77], v[204:219]
    v_mfma_f32_32x32x16_bf16 v[220:235], v[70:73], v[78:81], v[220:235]
    s_waitcnt lgkmcnt(0)
    s_waitcnt vmcnt(0)
    s_barrier
    ds_read_b128 v[58:61], v49 offset:0
    ds_read_b64_tr_b16 v[74:75], v55 offset:32768
    ds_read_b64_tr_b16 v[76:77], v55 offset:33792
    ds_read_b128 v[62:65], v49 offset:4096
    ds_read_b64_tr_b16 v[78:79], v56 offset:32768
    ds_read_b64_tr_b16 v[80:81], v56 offset:33792
    ds_read_b128 v[66:69], v49 offset:8192
    ds_read_b128 v[70:73], v49 offset:12288
    v_mfma_f32_32x32x16_bf16 v[108:123], v[82:85], v[98:101], v[108:123]
    s_lshl_b32 s48, s50, 7
    s_add_u32 s48, s48, s53
    s_add_u32 m0, s43, 0
    s_nop 0
    buffer_load_dwordx4 v37, s[8:11], s48 offen lds
    v_mfma_f32_32x32x16_bf16 v[124:139], v[82:85], v[102:105], v[124:139]
    s_add_u32 m0, s43, 8192
    s_nop 0
    buffer_load_dwordx4 v38, s[8:11], s48 offen lds
    v_mfma_f32_32x32x16_bf16 v[140:155], v[86:89], v[98:101], v[140:155]
    s_add_u32 m0, s43, 16384
    s_nop 0
    buffer_load_dwordx4 v39, s[8:11], s48 offen lds
    v_mfma_f32_32x32x16_bf16 v[156:171], v[86:89], v[102:105], v[156:171]
    s_add_u32 m0, s43, 24576
    s_nop 0
    buffer_load_dwordx4 v40, s[8:11], s48 offen lds
    v_mfma_f32_32x32x16_bf16 v[172:187], v[90:93], v[98:101], v[172:187]
    s_mul_i32 s49, s50, 524288
    s_add_u32 s49, s49, s54
    s_add_u32 s50, s50, 1
    s_cmp_eq_u32 s50, 8
    s_cselect_b32 s50, 0, s50
    s_add_u32 m0, s43, 32768
    s_nop 0
    buffer_load_dwordx4 v41, s[16:19], s49 offen lds
    v_mfma_f32_32x32x16_bf16 v[188:203], v[90:93], v[102:105], v[188:203]
    s_add_u32 m0, s43, 40960
    s_nop 0
    buffer_load_dwordx4 v42, s[16:19], s49 offen lds
    v_mfma_f32_32x32x16_bf16 v[204:219], v[94:97], v[98:101], v[204:219]
    s_add_u32 m0, s43, 49152
    s_nop 0
    buffer_load_dwordx4 v43, s[16:19], s49 offen lds
    v_mfma_f32_32x32x16_bf16 v[220:235], v[94:97], v[102:105], v[220:235]
    s_add_u32 m0, s43, 57344
    s_nop 0
    buffer_load_dwordx4 v44, s[16:19], s49 offen lds
    s_waitcnt lgkmcnt(5)
    v_mfma_f32_32x32x16_bf16 v[108:123], v[58:61], v[74:77], v[108:123]
    ds_read_b128 v[82:85], v50 offset:0
    ds_read_b64_tr_b16 v[98:99], v55 offset:36864
    s_waitcnt lgkmcnt(4)
    v_mfma_f32_32x32x16_bf16 v[124:139], v[58:61], v[78:81], v[124:139]
    ds_read_b64_tr_b16 v[100:101], v55 offset:37888
    ds_read_b128 v[86:89], v50 offset:4096
    v_mfma_f32_32x32x16_bf16 v[140:155], v[62:65], v[74:77], v[140:155]
    ds_read_b64_tr_b16 v[102:103], v56 offset:36864
    ds_read_b64_tr_b16 v[104:105], v56 offset:37888
    v_mfma_f32_32x32x16_bf16 v[156:171], v[62:65], v[78:81], v[156:171]
    ds_read_b128 v[90:93], v50 offset:8192
    ds_read_b128 v[94:97], v50 offset:12288
    s_waitcnt lgkmcnt(9)
    v_mfma_f32_32x32x16_bf16 v[172:187], v[66:69], v[74:77], v[172:187]
    v_mfma_f32_32x32x16_bf16 v[188:203], v[66:69], v[78:81], v[188:203]
    s_waitcnt lgkmcnt(8)
    v_mfma_f32_32x32x16_bf16 v[204:219], v[70:73], v[74:77], v[204:219]
    v_mfma_f32_32x32x16_bf16 v[220:235], v[70:73], v[78:81], v[220:235]
    s_waitcnt lgkmcnt(5)
    v_mfma_f32_32x32x16_bf16 v[108:123], v[82:85], v[98:101], v[108:123]
    ds_read_b128 v[58:61], v51 offset:0
    ds_read_b64_tr_b16 v[74:75], v55 offset:40960
    s_waitcnt lgkmcnt(4)
    v_mfma_f32_32x32x16_bf16 v[124:139], v[82:85], v[102:105], v[124:139]
    ds_read_b64_tr_b16 v[76:77], v55 offset:41984
    ds_read_b128 v[62:65], v51 offset:4096
    v_mfma_f32_32x32x16_bf16 v[140:155], v[86:89], v[98:101], v[140:155]
    ds_read_b64_tr_b16 v[78:79], v56 offset:40960
    ds_read_b64_tr_b16 v[80:81], v56 offset:41984
    v_mfma_f32_32x32x16_bf16 v[156:171], v[86:89], v[102:105], v[156:171]
    ds_read_b128 v[66:69], v51 offset:8192
    ds_read_b128 v[70:73], v51 offset:12288
    s_waitcnt lgkmcnt(9)
    v_mfma_f32_32x32x16_bf16 v[172:187], v[90:93], v[98:101], v[172:187]
    v_mfma_f32_32x32x16_bf16 v[188:203], v[90:93], v[102:105], v[188:203]
    s_waitcnt lgkmcnt(8)
    v_mfma_f32_32x32x16_bf16 v[204:219], v[94:97], v[98:101], v[204:219]
    v_mfma_f32_32x32x16_bf16 v[220:235], v[94:97], v[102:105], v[220:235]
    s_waitcnt lgkmcnt(5)
    v_mfma_f32_32x32x16_bf16 v[108:123], v[58:61], v[74:77], v[108:123]
    ds_read_b128 v[82:85], v52 offset:0
    ds_read_b64_tr_b16 v[98:99], v55 offset:45056
    s_waitcnt lgkmcnt(4)
    v_mfma_f32_32x32x16_bf16 v[124:139], v[58:61], v[78:81], v[124:139]
    ds_read_b64_tr_b16 v[100:101], v55 offset:46080
    ds_read_b128 v[86:89], v52 offset:4096
    v_mfma_f32_32x32x16_bf16 v[140:155], v[62:65], v[74:77], v[140:155]
    ds_read_b64_tr_b16 v[102:103], v56 offset:45056
    ds_read_b64_tr_b16 v[104:105], v56 offset:46080
    v_mfma_f32_32x32x16_bf16 v[156:171], v[62:65], v[78:81], v[156:171]
    ds_read_b128 v[90:93], v52 offset:8192
    ds_read_b128 v[94:97], v52 offset:12288
    s_waitcnt lgkmcnt(9)
    v_mfma_f32_32x32x16_bf16 v[172:187], v[66:69], v[74:77], v[172:187]
    v_mfma_f32_32x32x16_bf16 v[188:203], v[66:69], v[78:81], v[188:203]
    s_waitcnt lgkmcnt(8)
    v_mfma_f32_32x32x16_bf16 v[204:219], v[70:73], v[74:77], v[204:219]
    v_mfma_f32_32x32x16_bf16 v[220:235], v[70:73], v[78:81], v[220:235]
    s_waitcnt lgkmcnt(0)
    s_waitcnt vmcnt(0)
    s_barrier
    ds_read_b128 v[58:61], v45 offset:0
    ds_read_b64_tr_b16 v[74:75], v53 offset:32768
    ds_read_b64_tr_b16 v[76:77], v53 offset:33792
    ds_read_b128 v[62:65], v45 offset:4096
    ds_read_b64_tr_b16 v[78:79], v54 offset:32768
    ds_read_b64_tr_b16 v[80:81], v54 offset:33792
    ds_read_b128 v[66:69], v45 offset:8192
    ds_read_b128 v[70:73], v45 offset:12288
    v_mfma_f32_32x32x16_bf16 v[108:123], v[82:85], v[98:101], v[108:123]
    s_lshl_b32 s48, s50, 7
    s_add_u32 s48, s48, s53
    s_add_u32 m0, s43, 65536
    s_nop 0
    buffer_load_dwordx4 v37, s[8:11], s48 offen lds
    v_mfma_f32_32x32x16_bf16 v[124:139], v[82:85], v[102:105], v[124:139]
    s_add_u32 m0, s43, 73728
    s_nop 0
    buffer_load_dwordx4 v38, s[8:11], s48 offen lds
    v_mfma_f32_32x32x16_bf16 v[140:155], v[86:89], v[98:101], v[140:155]
    s_add_u32 m0, s43, 81920
    s_nop 0
    buffer_load_dwordx4 v39, s[8:11], s48 offen lds
    v_mfma_f32_32x32x16_bf16 v[156:171], v[86:89], v[102:105], v[156:171]
    s_add_u32 m0, s43, 90112
    s_nop 0
    buffer_load_dwordx4 v40, s[8:11], s48 offen lds
    v_mfma_f32_32x32x16_bf16 v[172:187], v[90:93], v[98:101], v[172:187]
    s_mul_i32 s49, s50, 524288
    s_add_u32 s49, s49, s54
    s_add_u32 s50, s50, 1
    s_cmp_eq_u32 s50, 8
    s_cselect_b32 s50, 0, s50
    s_add_u32 m0, s43, 98304
    s_nop 0
    buffer_load_dwordx4 v41, s[16:19], s49 offen lds
    v_mfma_f32_32x32x16_bf16 v[188:203], v[90:93], v[102:105], v[188:203]
    s_add_u32 m0, s43, 106496
    s_nop 0
    buffer_load_dwordx4 v42, s[16:19], s49 offen lds
    v_mfma_f32_32x32x16_bf16 v[204:219], v[94:97], v[98:101], v[204:219]
    s_add_u32 m0, s43, 114688
    s_nop 0
    buffer_load_dwordx4 v43, s[16:19], s49 offen lds
    v_mfma_f32_32x32x16_bf16 v[220:235], v[94:97], v[102:105], v[220:235]
    s_add_u32 m0, s43, 122880
    s_nop 0
    buffer_load_dwordx4 v44, s[16:19], s49 offen lds
    s_waitcnt lgkmcnt(5)
    v_mfma_f32_32x32x16_bf16 v[108:123], v[58:61], v[74:77], v[108:123]
    ds_read_b128 v[82:85], v46 offset:0
    ds_read_b64_tr_b16 v[98:99], v53 offset:36864
    s_waitcnt lgkmcnt(4)
    v_mfma_f32_32x32x16_bf16 v[124:139], v[58:61], v[78:81], v[124:139]
    ds_read_b64_tr_b16 v[100:101], v53 offset:37888
    ds_read_b128 v[86:89], v46 offset:4096
    v_mfma_f32_32x32x16_bf16 v[140:155], v[62:65], v[74:77], v[140:155]
    ds_read_b64_tr_b16 v[102:103], v54 offset:36864
    ds_read_b64_tr_b16 v[104:105], v54 offset:37888
    v_mfma_f32_32x32x16_bf16 v[156:171], v[62:65], v[78:81], v[156:171]
    ds_read_b128 v[90:93], v46 offset:8192
    ds_read_b128 v[94:97], v46 offset:12288
    s_waitcnt lgkmcnt(9)
    v_mfma_f32_32x32x16_bf16 v[172:187], v[66:69], v[74:77], v[172:187]
    v_mfma_f32_32x32x16_bf16 v[188:203], v[66:69], v[78:81], v[188:203]
    s_waitcnt lgkmcnt(8)
    v_mfma_f32_32x32x16_bf16 v[204:219], v[70:73], v[74:77], v[204:219]
    v_mfma_f32_32x32x16_bf16 v[220:235], v[70:73], v[78:81], v[220:235]
    s_waitcnt lgkmcnt(5)
    v_mfma_f32_32x32x16_bf16 v[108:123], v[82:85], v[98:101], v[108:123]
    ds_read_b128 v[58:61], v47 offset:0
    ds_read_b64_tr_b16 v[74:75], v53 offset:40960
    s_waitcnt lgkmcnt(4)
    v_mfma_f32_32x32x16_bf16 v[124:139], v[82:85], v[102:105], v[124:139]
    ds_read_b64_tr_b16 v[76:77], v53 offset:41984
    ds_read_b128 v[62:65], v47 offset:4096
    v_mfma_f32_32x32x16_bf16 v[140:155], v[86:89], v[98:101], v[140:155]
    ds_read_b64_tr_b16 v[78:79], v54 offset:40960
    ds_read_b64_tr_b16 v[80:81], v54 offset:41984
    v_mfma_f32_32x32x16_bf16 v[156:171], v[86:89], v[102:105], v[156:171]
    ds_read_b128 v[66:69], v47 offset:8192
    ds_read_b128 v[70:73], v47 offset:12288
    s_waitcnt lgkmcnt(9)
    v_mfma_f32_32x32x16_bf16 v[172:187], v[90:93], v[98:101], v[172:187]
    v_mfma_f32_32x32x16_bf16 v[188:203], v[90:93], v[102:105], v[188:203]
    s_waitcnt lgkmcnt(8)
    v_mfma_f32_32x32x16_bf16 v[204:219], v[94:97], v[98:101], v[204:219]
    v_mfma_f32_32x32x16_bf16 v[220:235], v[94:97], v[102:105], v[220:235]
    s_waitcnt lgkmcnt(5)
    v_mfma_f32_32x32x16_bf16 v[108:123], v[58:61], v[74:77], v[108:123]
    ds_read_b128 v[82:85], v48 offset:0
    ds_read_b64_tr_b16 v[98:99], v53 offset:45056
    s_waitcnt lgkmcnt(4)
    v_mfma_f32_32x32x16_bf16 v[124:139], v[58:61], v[78:81], v[124:139]
    ds_read_b64_tr_b16 v[100:101], v53 offset:46080
    ds_read_b128 v[86:89], v48 offset:4096
    v_mfma_f32_32x32x16_bf16 v[140:155], v[62:65], v[74:77], v[140:155]
    ds_read_b64_tr_b16 v[102:103], v54 offset:45056
    ds_read_b64_tr_b16 v[104:105], v54 offset:46080
    v_mfma_f32_32x32x16_bf16 v[156:171], v[62:65], v[78:81], v[156:171]
    ds_read_b128 v[90:93], v48 offset:8192
    ds_read_b128 v[94:97], v48 offset:12288
    s_waitcnt lgkmcnt(9)
    v_mfma_f32_32x32x16_bf16 v[172:187], v[66:69], v[74:77], v[172:187]
    v_mfma_f32_32x32x16_bf16 v[188:203], v[66:69], v[78:81], v[188:203]
    s_waitcnt lgkmcnt(8)
    v_mfma_f32_32x32x16_bf16 v[204:219], v[70:73], v[74:77], v[204:219]
    v_mfma_f32_32x32x16_bf16 v[220:235], v[70:73], v[78:81], v[220:235]
    s_waitcnt lgkmcnt(0)
    s_waitcnt vmcnt(0)
    s_barrier
    ds_read_b128 v[58:61], v49 offset:0
    ds_read_b64_tr_b16 v[74:75], v55 offset:32768
    ds_read_b64_tr_b16 v[76:77], v55 offset:33792
    ds_read_b128 v[62:65], v49 offset:4096
    ds_read_b64_tr_b16 v[78:79], v56 offset:32768
    ds_read_b64_tr_b16 v[80:81], v56 offset:33792
    ds_read_b128 v[66:69], v49 offset:8192
    ds_read_b128 v[70:73], v49 offset:12288
    v_mfma_f32_32x32x16_bf16 v[108:123], v[82:85], v[98:101], v[108:123]
    buffer_load_dwordx4 v[4:7], v8, s[36:39], 0 offen
    v_mfma_f32_32x32x16_bf16 v[124:139], v[82:85], v[102:105], v[124:139]
    buffer_load_dwordx4 v[4:7], v8, s[36:39], s41 offen
    v_mfma_f32_32x32x16_bf16 v[140:155], v[86:89], v[98:101], v[140:155]
    v_mfma_f32_32x32x16_bf16 v[156:171], v[86:89], v[102:105], v[156:171]
    v_mfma_f32_32x32x16_bf16 v[172:187], v[90:93], v[98:101], v[172:187]
    v_mfma_f32_32x32x16_bf16 v[188:203], v[90:93], v[102:105], v[188:203]
    v_mfma_f32_32x32x16_bf16 v[204:219], v[94:97], v[98:101], v[204:219]
    v_mfma_f32_32x32x16_bf16 v[220:235], v[94:97], v[102:105], v[220:235]
    s_waitcnt lgkmcnt(5)
    v_mfma_f32_32x32x16_bf16 v[108:123], v[58:61], v[74:77], v[108:123]
    ds_read_b128 v[82:85], v50 offset:0
    ds_read_b64_tr_b16 v[98:99], v55 offset:36864
    s_waitcnt lgkmcnt(4)
    v_mfma_f32_32x32x16_bf16 v[124:139], v[58:61], v[78:81], v[124:139]
    ds_read_b64_tr_b16 v[100:101], v55 offset:37888
    ds_read_b128 v[86:89], v50 offset:4096
    v_mfma_f32_32x32x16_bf16 v[140:155], v[62:65], v[74:77], v[140:155]
    ds_read_b64_tr_b16 v[102:103], v56 offset:36864
    ds_read_b64_tr_b16 v[104:105], v56 offset:37888
    v_mfma_f32_32x32x16_bf16 v[156:171], v[62:65], v[78:81], v[156:171]
    ds_read_b128 v[90:93], v50 offset:8192
    ds_read_b128 v[94:97], v50 offset:12288
    s_waitcnt lgkmcnt(9)
    v_mfma_f32_32x32x16_bf16 v[172:187], v[66:69], v[74:77], v[172:187]
    v_mfma_f32_32x32x16_bf16 v[188:203], v[66:69], v[78:81], v[188:203]
    s_waitcnt lgkmcnt(8)
    v_mfma_f32_32x32x16_bf16 v[204:219], v[70:73], v[74:77], v[204:219]
    v_mfma_f32_32x32x16_bf16 v[220:235], v[70:73], v[78:81], v[220:235]
    s_waitcnt lgkmcnt(5)
    v_mfma_f32_32x32x16_bf16 v[108:123], v[82:85], v[98:101], v[108:123]
    ds_read_b128 v[58:61], v51 offset:0
    ds_read_b64_tr_b16 v[74:75], v55 offset:40960
    s_waitcnt lgkmcnt(4)
    v_mfma_f32_32x32x16_bf16 v[124:139], v[82:85], v[102:105], v[124:139]
    ds_read_b64_tr_b16 v[76:77], v55 offset:41984
    ds_read_b128 v[62:65], v51 offset:4096
    v_mfma_f32_32x32x16_bf16 v[140:155], v[86:89], v[98:101], v[140:155]
    ds_read_b64_tr_b16 v[78:79], v56 offset:40960
    ds_read_b64_tr_b16 v[80:81], v56 offset:41984
    v_mfma_f32_32x32x16_bf16 v[156:171], v[86:89], v[102:105], v[156:171]
    ds_read_b128 v[66:69], v51 offset:8192
    ds_read_b128 v[70:73], v51 offset:12288
    s_waitcnt lgkmcnt(9)
    v_mfma_f32_32x32x16_bf16 v[172:187], v[90:93], v[98:101], v[172:187]
    v_mfma_f32_32x32x16_bf16 v[188:203], v[90:93], v[102:105], v[188:203]
    s_waitcnt lgkmcnt(8)
    v_mfma_f32_32x32x16_bf16 v[204:219], v[94:97], v[98:101], v[204:219]
    v_mfma_f32_32x32x16_bf16 v[220:235], v[94:97], v[102:105], v[220:235]
    s_waitcnt lgkmcnt(5)
    v_mfma_f32_32x32x16_bf16 v[108:123], v[58:61], v[74:77], v[108:123]
    ds_read_b128 v[82:85], v52 offset:0
    ds_read_b64_tr_b16 v[98:99], v55 offset:45056
    s_waitcnt lgkmcnt(4)
    v_mfma_f32_32x32x16_bf16 v[124:139], v[58:61], v[78:81], v[124:139]
    ds_read_b64_tr_b16 v[100:101], v55 offset:46080
    ds_read_b128 v[86:89], v52 offset:4096
    v_mfma_f32_32x32x16_bf16 v[140:155], v[62:65], v[74:77], v[140:155]
    ds_read_b64_tr_b16 v[102:103], v56 offset:45056
    ds_read_b64_tr_b16 v[104:105], v56 offset:46080
    v_mfma_f32_32x32x16_bf16 v[156:171], v[62:65], v[78:81], v[156:171]
    ds_read_b128 v[90:93], v52 offset:8192
    ds_read_b128 v[94:97], v52 offset:12288
    s_waitcnt lgkmcnt(9)
    v_mfma_f32_32x32x16_bf16 v[172:187], v[66:69], v[74:77], v[172:187]
    v_mfma_f32_32x32x16_bf16 v[188:203], v[66:69], v[78:81], v[188:203]
    s_waitcnt lgkmcnt(8)
    v_mfma_f32_32x32x16_bf16 v[204:219], v[70:73], v[74:77], v[204:219]
    v_mfma_f32_32x32x16_bf16 v[220:235], v[70:73], v[78:81], v[220:235]
    s_waitcnt lgkmcnt(5)
    v_mfma_f32_32x32x16_bf16 v[108:123], v[82:85], v[98:101], v[108:123]
    s_waitcnt lgkmcnt(2)
    v_mfma_f32_32x32x16_bf16 v[124:139], v[82:85], v[102:105], v[124:139]
    v_mfma_f32_32x32x16_bf16 v[140:155], v[86:89], v[98:101], v[140:155]
    v_mfma_f32_32x32x16_bf16 v[156:171], v[86:89], v[102:105], v[156:171]
    s_waitcnt lgkmcnt(1)
    v_mfma_f32_32x32x16_bf16 v[172:187], v[90:93], v[98:101], v[172:187]
    v_mfma_f32_32x32x16_bf16 v[188:203], v[90:93], v[102:105], v[188:203]
    s_waitcnt lgkmcnt(0)
    v_mfma_f32_32x32x16_bf16 v[204:219], v[94:97], v[98:101], v[204:219]
    v_mfma_f32_32x32x16_bf16 v[220:235], v[94:97], v[102:105], v[220:235]
    s_nop 15
    v_lshrrev_b32 v34, 5, v1
    v_and_b32 v35, 31, v1
    s_and_b32 s56, s45, 1
    s_lshl_b32 s53, s40, 13
    s_lshl_b32 s56, s56, 13
    s_add_u32 s55, s55, s56
    v_bfe_u32 v36, v1, 1, 3
    v_xor_b32 v34, v34, v36
    v_lshlrev_b32 v34, 4, v34
    v_lshl_add_u32 v34, v35, 7, v34
    v_add_u32 v34, s53, v34
    v_xor_b32 v45, 0, v34
    v_xor_b32 v46, 32, v34
    v_xor_b32 v47, 64, v34
    v_xor_b32 v48, 96, v34
    v_add_u32 v34, s53, v32
    v_cvt_pk_bf16_f32 v108, v108, v109
    v_cvt_pk_bf16_f32 v109, v110, v111
    v_cvt_pk_bf16_f32 v110, v112, v113
    v_cvt_pk_bf16_f32 v111, v114, v115
    ds_write_b128 v45, v[108:111] offset:0
    v_cvt_pk_bf16_f32 v116, v116, v117
    v_cvt_pk_bf16_f32 v117, v118, v119
    v_cvt_pk_bf16_f32 v118, v120, v121
    v_cvt_pk_bf16_f32 v119, v122, v123
    ds_write_b128 v46, v[116:119] offset:0
    v_cvt_pk_bf16_f32 v140, v140, v141
    v_cvt_pk_bf16_f32 v141, v142, v143
    v_cvt_pk_bf16_f32 v142, v144, v145
    v_cvt_pk_bf16_f32 v143, v146, v147
    ds_write_b128 v47, v[140:143] offset:0
    v_cvt_pk_bf16_f32 v148, v148, v149
    v_cvt_pk_bf16_f32 v149, v150, v151
    v_cvt_pk_bf16_f32 v150, v152, v153
    v_cvt_pk_bf16_f32 v151, v154, v155
    ds_write_b128 v48, v[148:151] offset:0
    ds_read_b128 v[112:115], v34 offset:0
    ds_read_b128 v[120:123], v34 offset:1024
    ds_read_b128 v[144:147], v34 offset:2048
    ds_read_b128 v[152:155], v34 offset:3072
    v_cvt_pk_bf16_f32 v124, v124, v125
    v_cvt_pk_bf16_f32 v125, v126, v127
    v_cvt_pk_bf16_f32 v126, v128, v129
    v_cvt_pk_bf16_f32 v127, v130, v131
    ds_write_b128 v45, v[124:127] offset:4096
    v_cvt_pk_bf16_f32 v132, v132, v133
    v_cvt_pk_bf16_f32 v133, v134, v135
    v_cvt_pk_bf16_f32 v134, v136, v137
    v_cvt_pk_bf16_f32 v135, v138, v139
    ds_write_b128 v46, v[132:135] offset:4096
    v_cvt_pk_bf16_f32 v156, v156, v157
    v_cvt_pk_bf16_f32 v157, v158, v159
    v_cvt_pk_bf16_f32 v158, v160, v161
    v_cvt_pk_bf16_f32 v159, v162, v163
    ds_write_b128 v47, v[156:159] offset:4096
    v_cvt_pk_bf16_f32 v164, v164, v165
    v_cvt_pk_bf16_f32 v165, v166, v167
    v_cvt_pk_bf16_f32 v166, v168, v169
    v_cvt_pk_bf16_f32 v167, v170, v171
    ds_write_b128 v48, v[164:167] offset:4096
    ds_read_b128 v[128:131], v34 offset:4096
    ds_read_b128 v[136:139], v34 offset:5120
    ds_read_b128 v[160:163], v34 offset:6144
    ds_read_b128 v[168:171], v34 offset:7168
    s_waitcnt lgkmcnt(8)
    s_add_u32 s56, s55, 0
    s_add_u32 s54, s56, 4096
    buffer_store_dwordx4 v[112:115], v32, s[32:35], s56 offen offset:0 sc1
    buffer_store_dwordx4 v[120:123], v32, s[32:35], s56 offen offset:1024 sc1
    buffer_store_dwordx4 v[144:147], v32, s[32:35], s56 offen offset:2048 sc1
    buffer_store_dwordx4 v[152:155], v32, s[32:35], s56 offen offset:3072 sc1
    v_cvt_pk_bf16_f32 v172, v172, v173
    v_cvt_pk_bf16_f32 v173, v174, v175
    v_cvt_pk_bf16_f32 v174, v176, v177
    v_cvt_pk_bf16_f32 v175, v178, v179
    ds_write_b128 v45, v[172:175] offset:0
    v_cvt_pk_bf16_f32 v180, v180, v181
    v_cvt_pk_bf16_f32 v181, v182, v183
    v_cvt_pk_bf16_f32 v182, v184, v185
    v_cvt_pk_bf16_f32 v183, v186, v187
    ds_write_b128 v46, v[180:183] offset:0
    v_cvt_pk_bf16_f32 v204, v204, v205
    v_cvt_pk_bf16_f32 v205, v206, v207
    v_cvt_pk_bf16_f32 v206, v208, v209
    v_cvt_pk_bf16_f32 v207, v210, v211
    ds_write_b128 v47, v[204:207] offset:0
    v_cvt_pk_bf16_f32 v212, v212, v213
    v_cvt_pk_bf16_f32 v213, v214, v215
    v_cvt_pk_bf16_f32 v214, v216, v217
    v_cvt_pk_bf16_f32 v215, v218, v219
    ds_write_b128 v48, v[212:215] offset:0
    ds_read_b128 v[176:179], v34 offset:0
    ds_read_b128 v[184:187], v34 offset:1024
    ds_read_b128 v[208:211], v34 offset:2048
    ds_read_b128 v[216:219], v34 offset:3072
    s_waitcnt lgkmcnt(8)
    s_add_u32 s56, s55, 4096
    s_add_u32 s54, s56, 4096
    buffer_store_dwordx4 v[128:131], v32, s[32:35], s56 offen offset:0 sc1
    buffer_store_dwordx4 v[136:139], v32, s[32:35], s56 offen offset:1024 sc1
    buffer_store_dwordx4 v[160:163], v32, s[32:35], s56 offen offset:2048 sc1
    buffer_store_dwordx4 v[168:171], v32, s[32:35], s56 offen offset:3072 sc1
    v_cvt_pk_bf16_f32 v188, v188, v189
    v_cvt_pk_bf16_f32 v189, v190, v191
    v_cvt_pk_bf16_f32 v190, v192, v193
    v_cvt_pk_bf16_f32 v191, v194, v195
    ds_write_b128 v45, v[188:191] offset:4096
    v_cvt_pk_bf16_f32 v196, v196, v197
    v_cvt_pk_bf16_f32 v197, v198, v199
    v_cvt_pk_bf16_f32 v198, v200, v201
    v_cvt_pk_bf16_f32 v199, v202, v203
    ds_write_b128 v46, v[196:199] offset:4096
    v_cvt_pk_bf16_f32 v220, v220, v221
    v_cvt_pk_bf16_f32 v221, v222, v223
    v_cvt_pk_bf16_f32 v222, v224, v225
    v_cvt_pk_bf16_f32 v223, v226, v227
    ds_write_b128 v47, v[220:223] offset:4096
    v_cvt_pk_bf16_f32 v228, v228, v229
    v_cvt_pk_bf16_f32 v229, v230, v231
    v_cvt_pk_bf16_f32 v230, v232, v233
    v_cvt_pk_bf16_f32 v231, v234, v235
    ds_write_b128 v48, v[228:231] offset:4096
    ds_read_b128 v[192:195], v34 offset:4096
    ds_read_b128 v[200:203], v34 offset:5120
    ds_read_b128 v[224:227], v34 offset:6144
    ds_read_b128 v[232:235], v34 offset:7168
    s_waitcnt lgkmcnt(8)
    s_add_u32 s56, s55, 16384
    s_add_u32 s54, s56, 4096
    buffer_store_dwordx4 v[176:179], v32, s[32:35], s56 offen offset:0 sc1
    buffer_store_dwordx4 v[184:187], v32, s[32:35], s56 offen offset:1024 sc1
    buffer_store_dwordx4 v[208:211], v32, s[32:35], s56 offen offset:2048 sc1
    buffer_store_dwordx4 v[216:219], v32, s[32:35], s56 offen offset:3072 sc1
    s_waitcnt lgkmcnt(0)
    s_add_u32 s56, s55, 20480
    s_add_u32 s54, s56, 4096
    buffer_store_dwordx4 v[192:195], v32, s[32:35], s56 offen offset:0 sc1
    buffer_store_dwordx4 v[200:203], v32, s[32:35], s56 offen offset:1024 sc1
    buffer_store_dwordx4 v[224:227], v32, s[32:35], s56 offen offset:2048 sc1
    buffer_store_dwordx4 v[232:235], v32, s[32:35], s56 offen offset:3072 sc1
kv_kernel_L3:
    v_lshlrev_b32 v108, 16, v12
    v_and_b32 v109, 0xffff0000, v12
    v_lshlrev_b32 v110, 16, v13
    v_and_b32 v111, 0xffff0000, v13
    v_lshlrev_b32 v112, 16, v14
    v_and_b32 v113, 0xffff0000, v14
    v_lshlrev_b32 v114, 16, v15
    v_and_b32 v115, 0xffff0000, v15
    v_add_f32 v116, v108, v109
    v_add_f32 v116, v116, v110
    v_add_f32 v116, v116, v111
    v_add_f32 v116, v116, v112
    v_add_f32 v116, v116, v113
    v_add_f32 v116, v116, v114
    v_add_f32 v116, v116, v115
    s_nop 1
    v_add_f32_dpp v116, v116, v116 row_ror:8 row_mask:0xf bank_mask:0xf
    s_nop 1
    v_add_f32_dpp v116, v116, v116 row_ror:4 row_mask:0xf bank_mask:0xf
    s_nop 1
    v_add_f32_dpp v116, v116, v116 row_ror:2 row_mask:0xf bank_mask:0xf
    s_nop 1
    v_add_f32_dpp v116, v116, v116 row_ror:1 row_mask:0xf bank_mask:0xf
    v_mov_b32 v117, v116
    s_nop 1
    v_permlane16_swap_b32 v117, v116
    s_nop 1
    v_add_f32 v116, v116, v117
    v_mov_b32 v117, v116
    s_nop 1
    v_permlane32_swap_b32 v117, v116
    s_nop 1
    v_add_f32 v116, v116, v117
    v_mul_f32 v116, 0x3b000000, v116
    v_sub_f32 v108, v108, v116
    v_sub_f32 v109, v109, v116
    v_sub_f32 v110, v110, v116
    v_sub_f32 v111, v111, v116
    v_sub_f32 v112, v112, v116
    v_sub_f32 v113, v113, v116
    v_sub_f32 v114, v114, v116
    v_sub_f32 v115, v115, v116
    v_mul_f32 v116, v108, v108
    v_fmac_f32 v116, v109, v109
    v_fmac_f32 v116, v110, v110
    v_fmac_f32 v116, v111, v111
    v_fmac_f32 v116, v112, v112
    v_fmac_f32 v116, v113, v113
    v_fmac_f32 v116, v114, v114
    v_fmac_f32 v116, v115, v115
    s_nop 1
    v_add_f32_dpp v116, v116, v116 row_ror:8 row_mask:0xf bank_mask:0xf
    s_nop 1
    v_add_f32_dpp v116, v116, v116 row_ror:4 row_mask:0xf bank_mask:0xf
    s_nop 1
    v_add_f32_dpp v116, v116, v116 row_ror:2 row_mask:0xf bank_mask:0xf
    s_nop 1
    v_add_f32_dpp v116, v116, v116 row_ror:1 row_mask:0xf bank_mask:0xf
    v_mov_b32 v117, v116
    s_nop 1
    v_permlane16_swap_b32 v117, v116
    s_nop 1
    v_add_f32 v116, v116, v117
    v_mov_b32 v117, v116
    s_nop 1
    v_permlane32_swap_b32 v117, v116
    s_nop 1
    v_add_f32 v116, v116, v117
    v_mov_b32 v117, 0x3727c5ac
    v_fmac_f32 v117, 0x3b000000, v116
    v_rsq_f32 v116, v117
    s_nop 0
    v_mul_f32 v108, v108, v116
    v_add_f32 v24, 1.0, v24
    v_fma_f32 v108, v108, v24, v16
    v_mul_f32 v109, v109, v116
    v_add_f32 v25, 1.0, v25
    v_fma_f32 v109, v109, v25, v17
    v_mul_f32 v110, v110, v116
    v_add_f32 v26, 1.0, v26
    v_fma_f32 v110, v110, v26, v18
    v_mul_f32 v111, v111, v116
    v_add_f32 v27, 1.0, v27
    v_fma_f32 v111, v111, v27, v19
    v_mul_f32 v112, v112, v116
    v_add_f32 v28, 1.0, v28
    v_fma_f32 v112, v112, v28, v20
    v_mul_f32 v113, v113, v116
    v_add_f32 v29, 1.0, v29
    v_fma_f32 v113, v113, v29, v21
    v_mul_f32 v114, v114, v116
    v_add_f32 v30, 1.0, v30
    v_fma_f32 v114, v114, v30, v22
    v_mul_f32 v115, v115, v116
    v_add_f32 v31, 1.0, v31
    v_fma_f32 v115, v115, v31, v23
    v_cvt_pk_bf16_f32 v120, v108, v109
    v_cvt_pk_bf16_f32 v121, v110, v111
    v_cvt_pk_bf16_f32 v122, v112, v113
    v_cvt_pk_bf16_f32 v123, v114, v115
    buffer_store_dwordx4 v[120:123], v32, s[24:27], s42 offen sc1
    s_endpgm
.globl attn_kernel
.p2align 8
.type attn_kernel,@function
attn_kernel:
    s_cmp_lt_u32 s2, 256
    s_cbranch_scc1 attn_kernel_L1
    s_endpgm
attn_kernel_L1:
    s_load_dwordx2 s[4:5], s[0:1], 112
    s_load_dwordx2 s[8:9], s[0:1], 16
    s_load_dwordx2 s[12:13], s[0:1], 112
    s_load_dwordx2 s[16:17], s[0:1], 112
    s_load_dwordx2 s[20:21], s[0:1], 112
    s_load_dwordx2 s[24:25], s[0:1], 112
    s_load_dwordx2 s[28:29], s[0:1], 40
    s_load_dwordx2 s[32:33], s[0:1], 56
    s_load_dwordx2 s[36:37], s[0:1], 64
    s_load_dwordx2 s[40:41], s[0:1], 72
    v_lshrrev_b32 v1, 6, v0
    s_nop 0
    v_readfirstlane_b32 s44, v1
    v_and_b32 v1, 63, v0
    s_waitcnt lgkmcnt(0)
    s_add_u32 s4, s4, 0x10000
    s_addc_u32 s5, s5, 0
    s_and_b32 s5, s5, 0xffff
    s_mov_b32 s6, 0x200000
    s_mov_b32 s7, 0x20000
    s_and_b32 s9, s9, 0xffff
    s_mov_b32 s10, 0x400000
    s_mov_b32 s11, 0x20000
    s_add_u32 s12, s12, 0x400000
    s_addc_u32 s13, s13, 0
    s_and_b32 s13, s13, 0xffff
    s_mov_b32 s14, 0x1000000
    s_mov_b32 s15, 0x20000
    s_add_u32 s16, s16, 0x1400000
    s_addc_u32 s17, s17, 0
    s_and_b32 s17, s17, 0xffff
    s_mov_b32 s18, 0x1000000
    s_mov_b32 s19, 0x20000
    s_add_u32 s20, s20, 0x2400000
    s_addc_u32 s21, s21, 0
    s_and_b32 s21, s21, 0xffff
    s_mov_b32 s22, 0x1000000
    s_mov_b32 s23, 0x20000
    s_add_u32 s24, s24, 0x400000
    s_addc_u32 s25, s25, 0
    s_and_b32 s25, s25, 0xffff
    s_mov_b32 s26, 0x2000000
    s_mov_b32 s27, 0x20000
    s_and_b32 s29, s29, 0xffff
    s_mov_b32 s30, 0x400000
    s_mov_b32 s31, 0x20000
    s_and_b32 s33, s33, 0xffff
    s_mov_b32 s34, 0x1c0000
    s_mov_b32 s35, 0x20000
    s_and_b32 s37, s37, 0xffff
    s_mov_b32 s38, 0x1c0000
    s_mov_b32 s39, 0x20000
    s_and_b32 s41, s41, 0xffff
    s_mov_b32 s42, 0x1c0000
    s_mov_b32 s43, 0x20000
    s_and_b32 s45, s2, 7
    s_lshl_b32 s45, s45, 2
    s_bfe_u32 s53, s2, 0x20003
    s_add_u32 s45, s45, s53
    s_lshr_b32 s47, s2, 5
    s_sub_u32 s46, 15, s47
    s_lshl_b32 s57, s46, 17
    s_add_u32 s58, s57, 65536
    s_lshl_b32 s59, s47, 17
    s_add_u32 s60, s59, 65536
    s_mov_b32 s54, 0
    s_lshl_b32 s55, s45, 8
    s_lshr_b32 s51, s44, 2
    s_and_b32 s52, s44, 3
    s_mov_b32 s62, 0x3e0293ee
    s_mov_b32 s63, s62
    s_lshl_b32 s53, s2, 13
    v_lshlrev_b32 v0, 4, v0
    v_add_u32 v0, s53, v0
    s_lshl_b32 s73, s44, 10
    s_lshr_b32 s74, s44, 0
    s_and_b32 s75, s44, 0
    s_lshl_b32 s76, s44, 2
    v_lshrrev_b32 v108, 4, v1
    v_add_u32 v108, s76, v108
    v_xor_b32 v108, v108, v1
    v_and_b32 v108, 7, v108
    v_lshlrev_b32 v108, 4, v108
    s_lshl_b32 s76, s44, 3
    v_lshrrev_b32 v109, 3, v1
    v_add_u32 v109, s76, v109
    s_mov_b32 s76, 1024
    v_mul_lo_u32 v109, v109, s76
    v_add_u32 v111, v108, v109
    v_add_u32 v114, s60, v111
    v_add_u32 v113, s59, v111
    v_add_u32 v112, s58, v111
    v_add_u32 v111, s57, v111
    v_lshrrev_b32 v109, 4, v1
    v_lshlrev_b32 v108, 2, v109
    v_xor_b32 v108, v108, v1
    v_and_b32 v108, 15, v108
    v_lshlrev_b32 v108, 4, v108
    s_mul_i32 s76, s44, 4
    v_add_u32 v109, s76, v109
    s_mov_b32 s76, 8192
    v_mul_lo_u32 v109, v109, s76
    v_add_u32 v115, v108, v109
    v_add_u32 v116, 262144, v115
    v_lshrrev_b32 v108, 5, v1
    v_bfe_u32 v109, v1, 1, 3
    v_xor_b32 v108, v108, v109
    v_lshlrev_b32 v108, 4, v108
    v_and_b32 v109, 31, v1
    v_lshl_add_u32 v108, v109, 7, v108
    s_mul_i32 s76, s74, 4096
    v_add_u32 v108, s76, v108
    v_xor_b32 v117, 0, v108
    v_xor_b32 v118, 32, v108
    v_xor_b32 v119, 64, v108
    v_xor_b32 v120, 96, v108
    v_xor_b32 v121, 0, v108
    v_add_u32 v121, 65536, v121
    v_xor_b32 v122, 32, v108
    v_add_u32 v122, 65536, v122
    v_xor_b32 v123, 64, v108
    v_add_u32 v123, 65536, v123
    v_xor_b32 v124, 96, v108
    v_add_u32 v124, 65536, v124
    v_xor_b32 v125, 0, v108
    v_add_u32 v125, 131072, v125
    v_xor_b32 v126, 32, v108
    v_add_u32 v126, 131072, v126
    v_xor_b32 v127, 64, v108
    v_add_u32 v127, 131072, v127
    v_xor_b32 v128, 96, v108
    v_add_u32 v128, 131072, v128
    v_lshrrev_b32 v108, 5, v1
    v_lshlrev_b32 v108, 3, v108
    v_bfe_u32 v109, v1, 2, 2
    v_add_u32 v108, v108, v109
    v_mul_u32_u24 v108, 256, v108
    v_bfe_u32 v110, v1, 4, 1
    v_lshl_add_u32 v108, v110, 5, v108
    v_and_b32 v110, 3, v1
    v_lshl_add_u32 v108, v110, 3, v108
    s_mul_i32 s76, s75, 0
    s_add_u32 s76, s76, 0
    s_and_b32 s77, s76, 3
    v_xor_b32 v110, s77, v109
    v_lshl_add_u32 v110, v110, 6, v108
    s_lshr_b32 s76, s76, 2
    s_mul_i32 s76, s76, 16384
    v_add_u32 v129, s76, v110
    v_add_u32 v133, s76, v110
    v_add_u32 v133, 65536, v133
    v_add_u32 v137, s76, v110
    v_add_u32 v137, 131072, v137
    s_mul_i32 s76, s75, 0
    s_add_u32 s76, s76, 1
    s_and_b32 s77, s76, 3
    v_xor_b32 v110, s77, v109
    v_lshl_add_u32 v110, v110, 6, v108
    s_lshr_b32 s76, s76, 2
    s_mul_i32 s76, s76, 16384
    v_add_u32 v130, s76, v110
    v_add_u32 v134, s76, v110
    v_add_u32 v134, 65536, v134
    v_add_u32 v138, s76, v110
    v_add_u32 v138, 131072, v138
    s_mul_i32 s76, s75, 0
    s_add_u32 s76, s76, 2
    s_and_b32 s77, s76, 3
    v_xor_b32 v110, s77, v109
    v_lshl_add_u32 v110, v110, 6, v108
    s_lshr_b32 s76, s76, 2
    s_mul_i32 s76, s76, 16384
    v_add_u32 v131, s76, v110
    v_add_u32 v135, s76, v110
    v_add_u32 v135, 65536, v135
    v_add_u32 v139, s76, v110
    v_add_u32 v139, 131072, v139
    s_mul_i32 s76, s75, 0
    s_add_u32 s76, s76, 3
    s_and_b32 s77, s76, 3
    v_xor_b32 v110, s77, v109
    v_lshl_add_u32 v110, v110, 6, v108
    s_lshr_b32 s76, s76, 2
    s_mul_i32 s76, s76, 16384
    v_add_u32 v132, s76, v110
    v_add_u32 v136, s76, v110
    v_add_u32 v136, 65536, v136
    v_add_u32 v140, s76, v110
    v_add_u32 v140, 131072, v140
    s_lshr_b32 s80, s2, 3
    s_mov_b32 s80, 0
    s_and_b32 s80, s80, 7
    v_lshlrev_b32 v240, 4, v1
    s_lshl_b32 s50, s52, 12
    v_add_u32 v240, s50, v240
    s_lshl_b32 s50, s44, 12
    v_lshrrev_b32 v243, 5, v1
    v_and_b32 v244, 31, v1
    s_lshl_b32 s53, s51, 14
    v_and_b32 v242, 15, v1
    v_xor_b32 v242, v242, v243
    v_lshlrev_b32 v242, 4, v242
    v_lshl_add_u32 v242, v244, 8, v242
    v_add_u32 v242, s53, v242
    v_xor_b32 v228, 0, v242
    v_xor_b32 v229, 32, v242
    v_xor_b32 v230, 64, v242
    v_xor_b32 v231, 96, v242
    v_xor_b32 v232, 128, v242
    v_xor_b32 v233, 160, v242
    v_xor_b32 v234, 192, v242
    v_xor_b32 v235, 224, v242
    s_add_u32 s53, s53, 65536
    v_bfe_u32 v242, v1, 1, 3
    v_xor_b32 v242, v242, v243
    v_lshlrev_b32 v242, 4, v242
    v_lshl_add_u32 v242, v244, 7, v242
    v_add_u32 v242, s53, v242
    v_xor_b32 v236, 0, v242
    v_xor_b32 v237, 32, v242
    v_xor_b32 v238, 64, v242
    v_xor_b32 v239, 96, v242
    s_lshl_b32 s53, s52, 5
    v_add_u32 v241, s53, v244
    v_lshlrev_b32 v247, 13, v241
    v_lshl_add_u32 v247, v243, 4, v247
    v_lshlrev_b32 v243, 2, v243
    v_sub_u32 v241, v241, v243
    s_lshl_b32 s53, s52, 13
    v_lshlrev_b32 v248, 7, v1
    v_add_u32 v248, s53, v248
    s_mul_i32 s53, s51, 16744448
    s_add_u32 s53, s53, 32768
    v_add_u32 v248, s53, v248
    v_mov_b32 v245, 0xff800000
    s_lshl_b32 s53, s52, 13
    s_add_u32 s53, s53, 131072
    v_lshlrev_b32 v246, 4, v1
    v_add_u32 v246, s53, v246
    s_lshl_b32 s49, s45, 19
    s_lshl_b32 s56, s47, 1
    s_add_u32 s56, s56, 2
    s_sub_u32 s72, 17, s56
    s_cmp_eq_u32 s51, 0
    s_cselect_b32 s56, 99, s56
    s_cselect_b32 s81, s46, s47
    s_lshl_b32 s81, s81, 1
    s_mov_b32 s48, 0
    s_lshl_b32 s78, s80, 7
    s_add_u32 s78, s78, s54
    s_add_u32 m0, s73, 16384
    s_nop 0
    buffer_load_dwordx4 v111, s[4:7], s78 offen lds
    s_add_u32 m0, s73, 24576
    s_nop 0
    buffer_load_dwordx4 v112, s[4:7], s78 offen lds
    s_add_u32 m0, s73, 32768
    s_nop 0
    buffer_load_dwordx4 v113, s[4:7], s78 offen lds
    s_add_u32 m0, s73, 40960
    s_nop 0
    buffer_load_dwordx4 v114, s[4:7], s78 offen lds
    s_mul_i32 s79, s80, 524288
    s_add_u32 s79, s79, s55
    s_add_u32 s80, s80, 1
    s_cmp_eq_u32 s80, 8
    s_cselect_b32 s80, 0, s80
    s_add_u32 m0, s73, 49152
    s_nop 0
    buffer_load_dwordx4 v115, s[8:11], s79 offen lds
    s_add_u32 m0, s73, 57344
    s_nop 0
    buffer_load_dwordx4 v116, s[8:11], s79 offen lds
    s_lshl_b32 s78, s80, 7
    s_add_u32 s78, s78, s54
    s_add_u32 m0, s73, 65536
    s_nop 0
    buffer_load_dwordx4 v111, s[4:7], s78 offen lds
    s_add_u32 m0, s73, 73728
    s_nop 0
    buffer_load_dwordx4 v112, s[4:7], s78 offen lds
    s_add_u32 m0, s73, 81920
    s_nop 0
    buffer_load_dwordx4 v113, s[4:7], s78 offen lds
    s_add_u32 m0, s73, 90112
    s_nop 0
    buffer_load_dwordx4 v114, s[4:7], s78 offen lds
    s_mul_i32 s79, s80, 524288
    s_add_u32 s79, s79, s55
    s_add_u32 s80, s80, 1
    s_cmp_eq_u32 s80, 8
    s_cselect_b32 s80, 0, s80
    s_add_u32 m0, s73, 98304
    s_nop 0
    buffer_load_dwordx4 v115, s[8:11], s79 offen lds
    s_add_u32 m0, s73, 106496
    s_nop 0
    buffer_load_dwordx4 v116, s[8:11], s79 offen lds
    s_lshl_b32 s78, s80, 7
    s_add_u32 s78, s78, s54
    s_add_u32 m0, s73, 114688
    s_nop 0
    buffer_load_dwordx4 v111, s[4:7], s78 offen lds
    s_add_u32 m0, s73, 122880
    s_nop 0
    buffer_load_dwordx4 v112, s[4:7], s78 offen lds
    s_add_u32 m0, s73, 131072
    s_nop 0
    buffer_load_dwordx4 v113, s[4:7], s78 offen lds
    s_add_u32 m0, s73, 139264
    s_nop 0
    buffer_load_dwordx4 v114, s[4:7], s78 offen lds
    s_mul_i32 s79, s80, 524288
    s_add_u32 s79, s79, s55
    s_add_u32 s80, s80, 1
    s_cmp_eq_u32 s80, 8
    s_cselect_b32 s80, 0, s80
    s_add_u32 m0, s73, 147456
    s_nop 0
    buffer_load_dwordx4 v115, s[8:11], s79 offen lds
    s_add_u32 m0, s73, 155648
    s_nop 0
    buffer_load_dwordx4 v116, s[8:11], s79 offen lds
    s_waitcnt vmcnt(12)
    s_barrier
    ds_read_b128 v[68:71], v117 offset:16384
    ds_read_b64_tr_b16 v[72:73], v129 offset:49152
    ds_read_b64_tr_b16 v[74:75], v129 offset:50176
    ds_read_b64_tr_b16 v[76:77], v130 offset:49152
    ds_read_b64_tr_b16 v[78:79], v130 offset:50176
    ds_read_b64_tr_b16 v[80:81], v131 offset:49152
    ds_read_b64_tr_b16 v[82:83], v131 offset:50176
    ds_read_b64_tr_b16 v[84:85], v132 offset:49152
    ds_read_b64_tr_b16 v[86:87], v132 offset:50176
    s_waitcnt lgkmcnt(6)
    v_mfma_f32_32x32x16_bf16 v[4:19], v[72:75], v[68:71], 0
    ds_read_b128 v[88:91], v118 offset:16384
    ds_read_b64_tr_b16 v[92:93], v129 offset:53248
    s_waitcnt lgkmcnt(6)
    v_mfma_f32_32x32x16_bf16 v[20:35], v[76:79], v[68:71], 0
    ds_read_b64_tr_b16 v[94:95], v129 offset:54272
    ds_read_b64_tr_b16 v[96:97], v130 offset:53248
    s_waitcnt lgkmcnt(6)
    v_mfma_f32_32x32x16_bf16 v[36:51], v[80:83], v[68:71], 0
    ds_read_b64_tr_b16 v[98:99], v130 offset:54272
    ds_read_b64_tr_b16 v[100:101], v131 offset:53248
    s_waitcnt lgkmcnt(6)
    v_mfma_f32_32x32x16_bf16 v[52:67], v[84:87], v[68:71], 0
    ds_read_b64_tr_b16 v[102:103], v131 offset:54272
    ds_read_b64_tr_b16 v[104:105], v132 offset:53248
    ds_read_b64_tr_b16 v[106:107], v132 offset:54272
    s_waitcnt lgkmcnt(6)
    v_mfma_f32_32x32x16_bf16 v[4:19], v[92:95], v[88:91], v[4:19]
    ds_read_b128 v[68:71], v119 offset:16384
    ds_read_b64_tr_b16 v[72:73], v129 offset:57344
    s_waitcnt lgkmcnt(6)
    v_mfma_f32_32x32x16_bf16 v[20:35], v[96:99], v[88:91], v[20:35]
    ds_read_b64_tr_b16 v[74:75], v129 offset:58368
    ds_read_b64_tr_b16 v[76:77], v130 offset:57344
    s_waitcnt lgkmcnt(6)
    v_mfma_f32_32x32x16_bf16 v[36:51], v[100:103], v[88:91], v[36:51]
    ds_read_b64_tr_b16 v[78:79], v130 offset:58368
    ds_read_b64_tr_b16 v[80:81], v131 offset:57344
    s_waitcnt lgkmcnt(6)
    v_mfma_f32_32x32x16_bf16 v[52:67], v[104:107], v[88:91], v[52:67]
    ds_read_b64_tr_b16 v[82:83], v131 offset:58368
    ds_read_b64_tr_b16 v[84:85], v132 offset:57344
    ds_read_b64_tr_b16 v[86:87], v132 offset:58368
    s_waitcnt lgkmcnt(6)
    v_mfma_f32_32x32x16_bf16 v[4:19], v[72:75], v[68:71], v[4:19]
    ds_read_b128 v[88:91], v120 offset:16384
    ds_read_b64_tr_b16 v[92:93], v129 offset:61440
    s_waitcnt lgkmcnt(6)
    v_mfma_f32_32x32x16_bf16 v[20:35], v[76:79], v[68:71], v[20:35]
    ds_read_b64_tr_b16 v[94:95], v129 offset:62464
    ds_read_b64_tr_b16 v[96:97], v130 offset:61440
    s_waitcnt lgkmcnt(6)
    v_mfma_f32_32x32x16_bf16 v[36:51], v[80:83], v[68:71], v[36:51]
    ds_read_b64_tr_b16 v[98:99], v130 offset:62464
    ds_read_b64_tr_b16 v[100:101], v131 offset:61440
    s_waitcnt lgkmcnt(6)
    v_mfma_f32_32x32x16_bf16 v[52:67], v[84:87], v[68:71], v[52:67]
    ds_read_b64_tr_b16 v[102:103], v131 offset:62464
    ds_read_b64_tr_b16 v[104:105], v132 offset:61440
    ds_read_b64_tr_b16 v[106:107], v132 offset:62464
    s_waitcnt lgkmcnt(0)
    s_waitcnt vmcnt(6)
    s_barrier
    ds_read_b128 v[68:71], v121 offset:0
    ds_read_b64_tr_b16 v[72:73], v133 offset:32768
    ds_read_b64_tr_b16 v[74:75], v133 offset:33792
    ds_read_b64_tr_b16 v[76:77], v134 offset:32768
    ds_read_b64_tr_b16 v[78:79], v134 offset:33792
    ds_read_b64_tr_b16 v[80:81], v135 offset:32768
    ds_read_b64_tr_b16 v[82:83], v135 offset:33792
    ds_read_b64_tr_b16 v[84:85], v136 offset:32768
    ds_read_b64_tr_b16 v[86:87], v136 offset:33792
    v_mfma_f32_32x32x16_bf16 v[4:19], v[92:95], v[88:91], v[4:19]
    s_lshl_b32 s78, s80, 7
    s_add_u32 s78, s78, s54
    s_add_u32 m0, s73, 16384
    s_nop 0
    buffer_load_dwordx4 v111, s[4:7], s78 offen lds
    v_mfma_f32_32x32x16_bf16 v[20:35], v[96:99], v[88:91], v[20:35]
    s_add_u32 m0, s73, 24576
    s_nop 0
    buffer_load_dwordx4 v112, s[4:7], s78 offen lds
    v_mfma_f32_32x32x16_bf16 v[36:51], v[100:103], v[88:91], v[36:51]
    s_add_u32 m0, s73, 32768
    s_nop 0
    buffer_load_dwordx4 v113, s[4:7], s78 offen lds
    v_mfma_f32_32x32x16_bf16 v[52:67], v[104:107], v[88:91], v[52:67]
    s_add_u32 m0, s73, 40960
    s_nop 0
    buffer_load_dwordx4 v114, s[4:7], s78 offen lds
    s_waitcnt lgkmcnt(6)
    v_mfma_f32_32x32x16_bf16 v[4:19], v[72:75], v[68:71], v[4:19]
    ds_read_b128 v[88:91], v122 offset:0
    ds_read_b64_tr_b16 v[92:93], v133 offset:36864
    s_waitcnt lgkmcnt(6)
    v_mfma_f32_32x32x16_bf16 v[20:35], v[76:79], v[68:71], v[20:35]
    ds_read_b64_tr_b16 v[94:95], v133 offset:37888
    ds_read_b64_tr_b16 v[96:97], v134 offset:36864
    s_waitcnt lgkmcnt(6)
    v_mfma_f32_32x32x16_bf16 v[36:51], v[80:83], v[68:71], v[36:51]
    ds_read_b64_tr_b16 v[98:99], v134 offset:37888
    ds_read_b64_tr_b16 v[100:101], v135 offset:36864
    s_waitcnt lgkmcnt(6)
    v_mfma_f32_32x32x16_bf16 v[52:67], v[84:87], v[68:71], v[52:67]
    ds_read_b64_tr_b16 v[102:103], v135 offset:37888
    ds_read_b64_tr_b16 v[104:105], v136 offset:36864
    ds_read_b64_tr_b16 v[106:107], v136 offset:37888
    s_waitcnt lgkmcnt(6)
    v_mfma_f32_32x32x16_bf16 v[4:19], v[92:95], v[88:91], v[4:19]
    ds_read_b128 v[68:71], v123 offset:0
    ds_read_b64_tr_b16 v[72:73], v133 offset:40960
    s_waitcnt lgkmcnt(6)
    v_mfma_f32_32x32x16_bf16 v[20:35], v[96:99], v[88:91], v[20:35]
    ds_read_b64_tr_b16 v[74:75], v133 offset:41984
    ds_read_b64_tr_b16 v[76:77], v134 offset:40960
    s_waitcnt lgkmcnt(6)
    v_mfma_f32_32x32x16_bf16 v[36:51], v[100:103], v[88:91], v[36:51]
    ds_read_b64_tr_b16 v[78:79], v134 offset:41984
    ds_read_b64_tr_b16 v[80:81], v135 offset:40960
    s_waitcnt lgkmcnt(6)
    v_mfma_f32_32x32x16_bf16 v[52:67], v[104:107], v[88:91], v[52:67]
    ds_read_b64_tr_b16 v[82:83], v135 offset:41984
    ds_read_b64_tr_b16 v[84:85], v136 offset:40960
    ds_read_b64_tr_b16 v[86:87], v136 offset:41984
    s_waitcnt lgkmcnt(6)
    v_mfma_f32_32x32x16_bf16 v[4:19], v[72:75], v[68:71], v[4:19]
    ds_read_b128 v[88:91], v124 offset:0
    ds_read_b64_tr_b16 v[92:93], v133 offset:45056
    s_waitcnt lgkmcnt(6)
    v_mfma_f32_32x32x16_bf16 v[20:35], v[76:79], v[68:71], v[20:35]
    ds_read_b64_tr_b16 v[94:95], v133 offset:46080
    ds_read_b64_tr_b16 v[96:97], v134 offset:45056
    s_waitcnt lgkmcnt(6)
    v_mfma_f32_32x32x16_bf16 v[36:51], v[80:83], v[68:71], v[36:51]
    ds_read_b64_tr_b16 v[98:99], v134 offset:46080
    ds_read_b64_tr_b16 v[100:101], v135 offset:45056
    s_waitcnt lgkmcnt(6)
    v_mfma_f32_32x32x16_bf16 v[52:67], v[84:87], v[68:71], v[52:67]
    ds_read_b64_tr_b16 v[102:103], v135 offset:46080
    ds_read_b64_tr_b16 v[104:105], v136 offset:45056
    ds_read_b64_tr_b16 v[106:107], v136 offset:46080
    s_mul_i32 s79, s80, 524288
    s_add_u32 s79, s79, s55
    s_add_u32 s80, s80, 1
    s_cmp_eq_u32 s80, 8
    s_cselect_b32 s80, 0, s80
    s_add_u32 m0, s73, 49152
    s_nop 0
    buffer_load_dwordx4 v115, s[8:11], s79 offen lds
    s_add_u32 m0, s73, 57344
    s_nop 0
    buffer_load_dwordx4 v116, s[8:11], s79 offen lds
    s_waitcnt lgkmcnt(0)
    s_waitcnt vmcnt(6)
    s_barrier
    ds_read_b128 v[68:71], v121 offset:49152
    ds_read_b64_tr_b16 v[72:73], v137 offset:16384
    ds_read_b64_tr_b16 v[74:75], v137 offset:17408
    ds_read_b64_tr_b16 v[76:77], v138 offset:16384
    ds_read_b64_tr_b16 v[78:79], v138 offset:17408
    ds_read_b64_tr_b16 v[80:81], v139 offset:16384
    ds_read_b64_tr_b16 v[82:83], v139 offset:17408
    ds_read_b64_tr_b16 v[84:85], v140 offset:16384
    ds_read_b64_tr_b16 v[86:87], v140 offset:17408
    v_mfma_f32_32x32x16_bf16 v[4:19], v[92:95], v[88:91], v[4:19]
    s_lshl_b32 s78, s80, 7
    s_add_u32 s78, s78, s54
    s_add_u32 m0, s73, 65536
    s_nop 0
    buffer_load_dwordx4 v111, s[4:7], s78 offen lds
    v_mfma_f32_32x32x16_bf16 v[20:35], v[96:99], v[88:91], v[20:35]
    s_add_u32 m0, s73, 73728
    s_nop 0
    buffer_load_dwordx4 v112, s[4:7], s78 offen lds
    v_mfma_f32_32x32x16_bf16 v[36:51], v[100:103], v[88:91], v[36:51]
    s_add_u32 m0, s73, 81920
    s_nop 0
    buffer_load_dwordx4 v113, s[4:7], s78 offen lds
    v_mfma_f32_32x32x16_bf16 v[52:67], v[104:107], v[88:91], v[52:67]
    s_add_u32 m0, s73, 90112
    s_nop 0
    buffer_load_dwordx4 v114, s[4:7], s78 offen lds
    s_waitcnt lgkmcnt(6)
    v_mfma_f32_32x32x16_bf16 v[4:19], v[72:75], v[68:71], v[4:19]
    ds_read_b128 v[88:91], v122 offset:49152
    ds_read_b64_tr_b16 v[92:93], v137 offset:20480
    s_waitcnt lgkmcnt(6)
    v_mfma_f32_32x32x16_bf16 v[20:35], v[76:79], v[68:71], v[20:35]
    ds_read_b64_tr_b16 v[94:95], v137 offset:21504
    ds_read_b64_tr_b16 v[96:97], v138 offset:20480
    s_waitcnt lgkmcnt(6)
    v_mfma_f32_32x32x16_bf16 v[36:51], v[80:83], v[68:71], v[36:51]
    ds_read_b64_tr_b16 v[98:99], v138 offset:21504
    ds_read_b64_tr_b16 v[100:101], v139 offset:20480
    s_waitcnt lgkmcnt(6)
    v_mfma_f32_32x32x16_bf16 v[52:67], v[84:87], v[68:71], v[52:67]
    ds_read_b64_tr_b16 v[102:103], v139 offset:21504
    ds_read_b64_tr_b16 v[104:105], v140 offset:20480
    ds_read_b64_tr_b16 v[106:107], v140 offset:21504
    s_waitcnt lgkmcnt(6)
    v_mfma_f32_32x32x16_bf16 v[4:19], v[92:95], v[88:91], v[4:19]
    ds_read_b128 v[68:71], v123 offset:49152
    ds_read_b64_tr_b16 v[72:73], v137 offset:24576
    s_waitcnt lgkmcnt(6)
    v_mfma_f32_32x32x16_bf16 v[20:35], v[96:99], v[88:91], v[20:35]
    ds_read_b64_tr_b16 v[74:75], v137 offset:25600
    ds_read_b64_tr_b16 v[76:77], v138 offset:24576
    s_waitcnt lgkmcnt(6)
    v_mfma_f32_32x32x16_bf16 v[36:51], v[100:103], v[88:91], v[36:51]
    ds_read_b64_tr_b16 v[78:79], v138 offset:25600
    ds_read_b64_tr_b16 v[80:81], v139 offset:24576
    s_waitcnt lgkmcnt(6)
    v_mfma_f32_32x32x16_bf16 v[52:67], v[104:107], v[88:91], v[52:67]
    ds_read_b64_tr_b16 v[82:83], v139 offset:25600
    ds_read_b64_tr_b16 v[84:85], v140 offset:24576
    ds_read_b64_tr_b16 v[86:87], v140 offset:25600
    s_waitcnt lgkmcnt(6)
    v_mfma_f32_32x32x16_bf16 v[4:19], v[72:75], v[68:71], v[4:19]
    ds_read_b128 v[88:91], v124 offset:49152
    ds_read_b64_tr_b16 v[92:93], v137 offset:28672
    s_waitcnt lgkmcnt(6)
    v_mfma_f32_32x32x16_bf16 v[20:35], v[76:79], v[68:71], v[20:35]
    ds_read_b64_tr_b16 v[94:95], v137 offset:29696
    ds_read_b64_tr_b16 v[96:97], v138 offset:28672
    s_waitcnt lgkmcnt(6)
    v_mfma_f32_32x32x16_bf16 v[36:51], v[80:83], v[68:71], v[36:51]
    ds_read_b64_tr_b16 v[98:99], v138 offset:29696
    ds_read_b64_tr_b16 v[100:101], v139 offset:28672
    s_waitcnt lgkmcnt(6)
    v_mfma_f32_32x32x16_bf16 v[52:67], v[84:87], v[68:71], v[52:67]
    ds_read_b64_tr_b16 v[102:103], v139 offset:29696
    ds_read_b64_tr_b16 v[104:105], v140 offset:28672
    ds_read_b64_tr_b16 v[106:107], v140 offset:29696
    s_mul_i32 s79, s80, 524288
    s_add_u32 s79, s79, s55
    s_add_u32 s80, s80, 1
    s_cmp_eq_u32 s80, 8
    s_cselect_b32 s80, 0, s80
    s_add_u32 m0, s73, 98304
    s_nop 0
    buffer_load_dwordx4 v115, s[8:11], s79 offen lds
    s_add_u32 m0, s73, 106496
    s_nop 0
    buffer_load_dwordx4 v116, s[8:11], s79 offen lds
    s_waitcnt lgkmcnt(0)
    s_waitcnt vmcnt(6)
    s_barrier
    ds_read_b128 v[68:71], v117 offset:16384
    ds_read_b64_tr_b16 v[72:73], v129 offset:49152
    ds_read_b64_tr_b16 v[74:75], v129 offset:50176
    ds_read_b64_tr_b16 v[76:77], v130 offset:49152
    ds_read_b64_tr_b16 v[78:79], v130 offset:50176
    ds_read_b64_tr_b16 v[80:81], v131 offset:49152
    ds_read_b64_tr_b16 v[82:83], v131 offset:50176
    ds_read_b64_tr_b16 v[84:85], v132 offset:49152
    ds_read_b64_tr_b16 v[86:87], v132 offset:50176
    v_mfma_f32_32x32x16_bf16 v[4:19], v[92:95], v[88:91], v[4:19]
    s_lshl_b32 s78, s80, 7
    s_add_u32 s78, s78, s54
    s_add_u32 m0, s73, 114688
    s_nop 0
    buffer_load_dwordx4 v111, s[4:7], s78 offen lds
    v_mfma_f32_32x32x16_bf16 v[20:35], v[96:99], v[88:91], v[20:35]
    s_add_u32 m0, s73, 122880
    s_nop 0
    buffer_load_dwordx4 v112, s[4:7], s78 offen lds
    v_mfma_f32_32x32x16_bf16 v[36:51], v[100:103], v[88:91], v[36:51]
    s_add_u32 m0, s73, 131072
    s_nop 0
    buffer_load_dwordx4 v113, s[4:7], s78 offen lds
    v_mfma_f32_32x32x16_bf16 v[52:67], v[104:107], v[88:91], v[52:67]
    s_add_u32 m0, s73, 139264
    s_nop 0
    buffer_load_dwordx4 v114, s[4:7], s78 offen lds
    s_waitcnt lgkmcnt(6)
    v_mfma_f32_32x32x16_bf16 v[4:19], v[72:75], v[68:71], v[4:19]
    ds_read_b128 v[88:91], v118 offset:16384
    ds_read_b64_tr_b16 v[92:93], v129 offset:53248
    s_waitcnt lgkmcnt(6)
    v_mfma_f32_32x32x16_bf16 v[20:35], v[76:79], v[68:71], v[20:35]
    ds_read_b64_tr_b16 v[94:95], v129 offset:54272
    ds_read_b64_tr_b16 v[96:97], v130 offset:53248
    s_waitcnt lgkmcnt(6)
    v_mfma_f32_32x32x16_bf16 v[36:51], v[80:83], v[68:71], v[36:51]
    ds_read_b64_tr_b16 v[98:99], v130 offset:54272
    ds_read_b64_tr_b16 v[100:101], v131 offset:53248
    s_waitcnt lgkmcnt(6)
    v_mfma_f32_32x32x16_bf16 v[52:67], v[84:87], v[68:71], v[52:67]
    ds_read_b64_tr_b16 v[102:103], v131 offset:54272
    ds_read_b64_tr_b16 v[104:105], v132 offset:53248
    ds_read_b64_tr_b16 v[106:107], v132 offset:54272
    s_waitcnt lgkmcnt(6)
    v_mfma_f32_32x32x16_bf16 v[4:19], v[92:95], v[88:91], v[4:19]
    ds_read_b128 v[68:71], v119 offset:16384
    ds_read_b64_tr_b16 v[72:73], v129 offset:57344
    s_waitcnt lgkmcnt(6)
    v_mfma_f32_32x32x16_bf16 v[20:35], v[96:99], v[88:91], v[20:35]
    ds_read_b64_tr_b16 v[74:75], v129 offset:58368
    ds_read_b64_tr_b16 v[76:77], v130 offset:57344
    s_waitcnt lgkmcnt(6)
    v_mfma_f32_32x32x16_bf16 v[36:51], v[100:103], v[88:91], v[36:51]
    ds_read_b64_tr_b16 v[78:79], v130 offset:58368
    ds_read_b64_tr_b16 v[80:81], v131 offset:57344
    s_waitcnt lgkmcnt(6)
    v_mfma_f32_32x32x16_bf16 v[52:67], v[104:107], v[88:91], v[52:67]
    ds_read_b64_tr_b16 v[82:83], v131 offset:58368
    ds_read_b64_tr_b16 v[84:85], v132 offset:57344
    ds_read_b64_tr_b16 v[86:87], v132 offset:58368
    s_waitcnt lgkmcnt(6)
    v_mfma_f32_32x32x16_bf16 v[4:19], v[72:75], v[68:71], v[4:19]
    ds_read_b128 v[88:91], v120 offset:16384
    ds_read_b64_tr_b16 v[92:93], v129 offset:61440
    s_waitcnt lgkmcnt(6)
    v_mfma_f32_32x32x16_bf16 v[20:35], v[76:79], v[68:71], v[20:35]
    ds_read_b64_tr_b16 v[94:95], v129 offset:62464
    ds_read_b64_tr_b16 v[96:97], v130 offset:61440
    s_waitcnt lgkmcnt(6)
    v_mfma_f32_32x32x16_bf16 v[36:51], v[80:83], v[68:71], v[36:51]
    ds_read_b64_tr_b16 v[98:99], v130 offset:62464
    ds_read_b64_tr_b16 v[100:101], v131 offset:61440
    s_waitcnt lgkmcnt(6)
    v_mfma_f32_32x32x16_bf16 v[52:67], v[84:87], v[68:71], v[52:67]
    ds_read_b64_tr_b16 v[102:103], v131 offset:62464
    ds_read_b64_tr_b16 v[104:105], v132 offset:61440
    ds_read_b64_tr_b16 v[106:107], v132 offset:62464
    s_mul_i32 s79, s80, 524288
    s_add_u32 s79, s79, s55
    s_add_u32 s80, s80, 1
    s_cmp_eq_u32 s80, 8
    s_cselect_b32 s80, 0, s80
    s_add_u32 m0, s73, 147456
    s_nop 0
    buffer_load_dwordx4 v115, s[8:11], s79 offen lds
    s_add_u32 m0, s73, 155648
    s_nop 0
    buffer_load_dwordx4 v116, s[8:11], s79 offen lds
    s_waitcnt lgkmcnt(0)
    s_waitcnt vmcnt(6)
    s_barrier
    ds_read_b128 v[68:71], v121 offset:0
    ds_read_b64_tr_b16 v[72:73], v133 offset:32768
    ds_read_b64_tr_b16 v[74:75], v133 offset:33792
    ds_read_b64_tr_b16 v[76:77], v134 offset:32768
    ds_read_b64_tr_b16 v[78:79], v134 offset:33792
    ds_read_b64_tr_b16 v[80:81], v135 offset:32768
    ds_read_b64_tr_b16 v[82:83], v135 offset:33792
    ds_read_b64_tr_b16 v[84:85], v136 offset:32768
    ds_read_b64_tr_b16 v[86:87], v136 offset:33792
    v_mfma_f32_32x32x16_bf16 v[4:19], v[92:95], v[88:91], v[4:19]
    s_lshl_b32 s78, s80, 7
    s_add_u32 s78, s78, s54
    s_add_u32 m0, s73, 16384
    s_nop 0
    buffer_load_dwordx4 v111, s[4:7], s78 offen lds
    v_mfma_f32_32x32x16_bf16 v[20:35], v[96:99], v[88:91], v[20:35]
    s_add_u32 m0, s73, 24576
    s_nop 0
    buffer_load_dwordx4 v112, s[4:7], s78 offen lds
    v_mfma_f32_32x32x16_bf16 v[36:51], v[100:103], v[88:91], v[36:51]
    s_add_u32 m0, s73, 32768
    s_nop 0
    buffer_load_dwordx4 v113, s[4:7], s78 offen lds
    v_mfma_f32_32x32x16_bf16 v[52:67], v[104:107], v[88:91], v[52:67]
    s_add_u32 m0, s73, 40960
    s_nop 0
    buffer_load_dwordx4 v114, s[4:7], s78 offen lds
    s_waitcnt lgkmcnt(6)
    v_mfma_f32_32x32x16_bf16 v[4:19], v[72:75], v[68:71], v[4:19]
    ds_read_b128 v[88:91], v122 offset:0
    ds_read_b64_tr_b16 v[92:93], v133 offset:36864
    s_waitcnt lgkmcnt(6)
    v_mfma_f32_32x32x16_bf16 v[20:35], v[76:79], v[68:71], v[20:35]
    ds_read_b64_tr_b16 v[94:95], v133 offset:37888
    ds_read_b64_tr_b16 v[96:97], v134 offset:36864
    s_waitcnt lgkmcnt(6)
    v_mfma_f32_32x32x16_bf16 v[36:51], v[80:83], v[68:71], v[36:51]
    ds_read_b64_tr_b16 v[98:99], v134 offset:37888
    ds_read_b64_tr_b16 v[100:101], v135 offset:36864
    s_waitcnt lgkmcnt(6)
    v_mfma_f32_32x32x16_bf16 v[52:67], v[84:87], v[68:71], v[52:67]
    ds_read_b64_tr_b16 v[102:103], v135 offset:37888
    ds_read_b64_tr_b16 v[104:105], v136 offset:36864
    ds_read_b64_tr_b16 v[106:107], v136 offset:37888
    s_waitcnt lgkmcnt(6)
    v_mfma_f32_32x32x16_bf16 v[4:19], v[92:95], v[88:91], v[4:19]
    ds_read_b128 v[68:71], v123 offset:0
    ds_read_b64_tr_b16 v[72:73], v133 offset:40960
    s_waitcnt lgkmcnt(6)
    v_mfma_f32_32x32x16_bf16 v[20:35], v[96:99], v[88:91], v[20:35]
    ds_read_b64_tr_b16 v[74:75], v133 offset:41984
    ds_read_b64_tr_b16 v[76:77], v134 offset:40960
    s_waitcnt lgkmcnt(6)
    v_mfma_f32_32x32x16_bf16 v[36:51], v[100:103], v[88:91], v[36:51]
    ds_read_b64_tr_b16 v[78:79], v134 offset:41984
    ds_read_b64_tr_b16 v[80:81], v135 offset:40960
    s_waitcnt lgkmcnt(6)
    v_mfma_f32_32x32x16_bf16 v[52:67], v[104:107], v[88:91], v[52:67]
    ds_read_b64_tr_b16 v[82:83], v135 offset:41984
    ds_read_b64_tr_b16 v[84:85], v136 offset:40960
    ds_read_b64_tr_b16 v[86:87], v136 offset:41984
    s_waitcnt lgkmcnt(6)
    v_mfma_f32_32x32x16_bf16 v[4:19], v[72:75], v[68:71], v[4:19]
    ds_read_b128 v[88:91], v124 offset:0
    ds_read_b64_tr_b16 v[92:93], v133 offset:45056
    s_waitcnt lgkmcnt(6)
    v_mfma_f32_32x32x16_bf16 v[20:35], v[76:79], v[68:71], v[20:35]
    ds_read_b64_tr_b16 v[94:95], v133 offset:46080
    ds_read_b64_tr_b16 v[96:97], v134 offset:45056
    s_waitcnt lgkmcnt(6)
    v_mfma_f32_32x32x16_bf16 v[36:51], v[80:83], v[68:71], v[36:51]
    ds_read_b64_tr_b16 v[98:99], v134 offset:46080
    ds_read_b64_tr_b16 v[100:101], v135 offset:45056
    s_waitcnt lgkmcnt(6)
    v_mfma_f32_32x32x16_bf16 v[52:67], v[84:87], v[68:71], v[52:67]
    ds_read_b64_tr_b16 v[102:103], v135 offset:46080
    ds_read_b64_tr_b16 v[104:105], v136 offset:45056
    ds_read_b64_tr_b16 v[106:107], v136 offset:46080
    s_mul_i32 s79, s80, 524288
    s_add_u32 s79, s79, s55
    s_add_u32 s80, s80, 1
    s_cmp_eq_u32 s80, 8
    s_cselect_b32 s80, 0, s80
    s_add_u32 m0, s73, 49152
    s_nop 0
    buffer_load_dwordx4 v115, s[8:11], s79 offen lds
    s_add_u32 m0, s73, 57344
    s_nop 0
    buffer_load_dwordx4 v116, s[8:11], s79 offen lds
    s_waitcnt lgkmcnt(0)
    s_waitcnt vmcnt(6)
    s_barrier
    ds_read_b128 v[68:71], v121 offset:49152
    ds_read_b64_tr_b16 v[72:73], v137 offset:16384
    ds_read_b64_tr_b16 v[74:75], v137 offset:17408
    ds_read_b64_tr_b16 v[76:77], v138 offset:16384
    ds_read_b64_tr_b16 v[78:79], v138 offset:17408
    ds_read_b64_tr_b16 v[80:81], v139 offset:16384
    ds_read_b64_tr_b16 v[82:83], v139 offset:17408
    ds_read_b64_tr_b16 v[84:85], v140 offset:16384
    ds_read_b64_tr_b16 v[86:87], v140 offset:17408
    v_mfma_f32_32x32x16_bf16 v[4:19], v[92:95], v[88:91], v[4:19]
    s_lshl_b32 s78, s80, 7
    s_add_u32 s78, s78, s54
    s_add_u32 m0, s73, 65536
    s_nop 0
    buffer_load_dwordx4 v111, s[4:7], s78 offen lds
    v_mfma_f32_32x32x16_bf16 v[20:35], v[96:99], v[88:91], v[20:35]
    s_add_u32 m0, s73, 73728
    s_nop 0
    buffer_load_dwordx4 v112, s[4:7], s78 offen lds
    v_mfma_f32_32x32x16_bf16 v[36:51], v[100:103], v[88:91], v[36:51]
    s_add_u32 m0, s73, 81920
    s_nop 0
    buffer_load_dwordx4 v113, s[4:7], s78 offen lds
    v_mfma_f32_32x32x16_bf16 v[52:67], v[104:107], v[88:91], v[52:67]
    s_add_u32 m0, s73, 90112
    s_nop 0
    buffer_load_dwordx4 v114, s[4:7], s78 offen lds
    s_waitcnt lgkmcnt(6)
    v_mfma_f32_32x32x16_bf16 v[4:19], v[72:75], v[68:71], v[4:19]
    ds_read_b128 v[88:91], v122 offset:49152
    ds_read_b64_tr_b16 v[92:93], v137 offset:20480
    s_waitcnt lgkmcnt(6)
    v_mfma_f32_32x32x16_bf16 v[20:35], v[76:79], v[68:71], v[20:35]
    ds_read_b64_tr_b16 v[94:95], v137 offset:21504
    ds_read_b64_tr_b16 v[96:97], v138 offset:20480
    s_waitcnt lgkmcnt(6)
    v_mfma_f32_32x32x16_bf16 v[36:51], v[80:83], v[68:71], v[36:51]
    ds_read_b64_tr_b16 v[98:99], v138 offset:21504
    ds_read_b64_tr_b16 v[100:101], v139 offset:20480
    s_waitcnt lgkmcnt(6)
    v_mfma_f32_32x32x16_bf16 v[52:67], v[84:87], v[68:71], v[52:67]
    ds_read_b64_tr_b16 v[102:103], v139 offset:21504
    ds_read_b64_tr_b16 v[104:105], v140 offset:20480
    ds_read_b64_tr_b16 v[106:107], v140 offset:21504
    s_waitcnt lgkmcnt(6)
    v_mfma_f32_32x32x16_bf16 v[4:19], v[92:95], v[88:91], v[4:19]
    ds_read_b128 v[68:71], v123 offset:49152
    ds_read_b64_tr_b16 v[72:73], v137 offset:24576
    s_waitcnt lgkmcnt(6)
    v_mfma_f32_32x32x16_bf16 v[20:35], v[96:99], v[88:91], v[20:35]
    ds_read_b64_tr_b16 v[74:75], v137 offset:25600
    ds_read_b64_tr_b16 v[76:77], v138 offset:24576
    s_waitcnt lgkmcnt(6)
    v_mfma_f32_32x32x16_bf16 v[36:51], v[100:103], v[88:91], v[36:51]
    ds_read_b64_tr_b16 v[78:79], v138 offset:25600
    ds_read_b64_tr_b16 v[80:81], v139 offset:24576
    s_waitcnt lgkmcnt(6)
    v_mfma_f32_32x32x16_bf16 v[52:67], v[104:107], v[88:91], v[52:67]
    ds_read_b64_tr_b16 v[82:83], v139 offset:25600
    ds_read_b64_tr_b16 v[84:85], v140 offset:24576
    ds_read_b64_tr_b16 v[86:87], v140 offset:25600
    s_waitcnt lgkmcnt(6)
    v_mfma_f32_32x32x16_bf16 v[4:19], v[72:75], v[68:71], v[4:19]
    ds_read_b128 v[88:91], v124 offset:49152
    ds_read_b64_tr_b16 v[92:93], v137 offset:28672
    s_waitcnt lgkmcnt(6)
    v_mfma_f32_32x32x16_bf16 v[20:35], v[76:79], v[68:71], v[20:35]
    ds_read_b64_tr_b16 v[94:95], v137 offset:29696
    ds_read_b64_tr_b16 v[96:97], v138 offset:28672
    s_waitcnt lgkmcnt(6)
    v_mfma_f32_32x32x16_bf16 v[36:51], v[80:83], v[68:71], v[36:51]
    ds_read_b64_tr_b16 v[98:99], v138 offset:29696
    ds_read_b64_tr_b16 v[100:101], v139 offset:28672
    s_waitcnt lgkmcnt(6)
    v_mfma_f32_32x32x16_bf16 v[52:67], v[84:87], v[68:71], v[52:67]
    ds_read_b64_tr_b16 v[102:103], v139 offset:29696
    ds_read_b64_tr_b16 v[104:105], v140 offset:28672
    ds_read_b64_tr_b16 v[106:107], v140 offset:29696
    s_mul_i32 s79, s80, 524288
    s_add_u32 s79, s79, s55
    s_add_u32 s80, s80, 1
    s_cmp_eq_u32 s80, 8
    s_cselect_b32 s80, 0, s80
    s_add_u32 m0, s73, 98304
    s_nop 0
    buffer_load_dwordx4 v115, s[8:11], s79 offen lds
    s_add_u32 m0, s73, 106496
    s_nop 0
    buffer_load_dwordx4 v116, s[8:11], s79 offen lds
    s_waitcnt lgkmcnt(0)
    s_waitcnt vmcnt(6)
    s_barrier
    ds_read_b128 v[68:71], v117 offset:16384
    ds_read_b64_tr_b16 v[72:73], v129 offset:49152
    ds_read_b64_tr_b16 v[74:75], v129 offset:50176
    ds_read_b64_tr_b16 v[76:77], v130 offset:49152
    ds_read_b64_tr_b16 v[78:79], v130 offset:50176
    ds_read_b64_tr_b16 v[80:81], v131 offset:49152
    ds_read_b64_tr_b16 v[82:83], v131 offset:50176
    ds_read_b64_tr_b16 v[84:85], v132 offset:49152
    ds_read_b64_tr_b16 v[86:87], v132 offset:50176
    v_mfma_f32_32x32x16_bf16 v[4:19], v[92:95], v[88:91], v[4:19]
    v_mfma_f32_32x32x16_bf16 v[20:35], v[96:99], v[88:91], v[20:35]
    v_mfma_f32_32x32x16_bf16 v[36:51], v[100:103], v[88:91], v[36:51]
    v_mfma_f32_32x32x16_bf16 v[52:67], v[104:107], v[88:91], v[52:67]
    s_waitcnt lgkmcnt(6)
    v_mfma_f32_32x32x16_bf16 v[4:19], v[72:75], v[68:71], v[4:19]
    ds_read_b128 v[88:91], v118 offset:16384
    ds_read_b64_tr_b16 v[92:93], v129 offset:53248
    s_waitcnt lgkmcnt(6)
    v_mfma_f32_32x32x16_bf16 v[20:35], v[76:79], v[68:71], v[20:35]
    ds_read_b64_tr_b16 v[94:95], v129 offset:54272
    ds_read_b64_tr_b16 v[96:97], v130 offset:53248
    s_waitcnt lgkmcnt(6)
    v_mfma_f32_32x32x16_bf16 v[36:51], v[80:83], v[68:71], v[36:51]
    ds_read_b64_tr_b16 v[98:99], v130 offset:54272
    ds_read_b64_tr_b16 v[100:101], v131 offset:53248
    s_waitcnt lgkmcnt(6)
    v_mfma_f32_32x32x16_bf16 v[52:67], v[84:87], v[68:71], v[52:67]
    ds_read_b64_tr_b16 v[102:103], v131 offset:54272
    ds_read_b64_tr_b16 v[104:105], v132 offset:53248
    ds_read_b64_tr_b16 v[106:107], v132 offset:54272
    s_waitcnt lgkmcnt(6)
    v_mfma_f32_32x32x16_bf16 v[4:19], v[92:95], v[88:91], v[4:19]
    ds_read_b128 v[68:71], v119 offset:16384
    ds_read_b64_tr_b16 v[72:73], v129 offset:57344
    s_waitcnt lgkmcnt(6)
    v_mfma_f32_32x32x16_bf16 v[20:35], v[96:99], v[88:91], v[20:35]
    ds_read_b64_tr_b16 v[74:75], v129 offset:58368
    ds_read_b64_tr_b16 v[76:77], v130 offset:57344
    s_waitcnt lgkmcnt(6)
    v_mfma_f32_32x32x16_bf16 v[36:51], v[100:103], v[88:91], v[36:51]
    ds_read_b64_tr_b16 v[78:79], v130 offset:58368
    ds_read_b64_tr_b16 v[80:81], v131 offset:57344
    s_waitcnt lgkmcnt(6)
    v_mfma_f32_32x32x16_bf16 v[52:67], v[104:107], v[88:91], v[52:67]
    ds_read_b64_tr_b16 v[82:83], v131 offset:58368
    ds_read_b64_tr_b16 v[84:85], v132 offset:57344
    ds_read_b64_tr_b16 v[86:87], v132 offset:58368
    s_waitcnt lgkmcnt(6)
    v_mfma_f32_32x32x16_bf16 v[4:19], v[72:75], v[68:71], v[4:19]
    ds_read_b128 v[88:91], v120 offset:16384
    ds_read_b64_tr_b16 v[92:93], v129 offset:61440
    s_waitcnt lgkmcnt(6)
    v_mfma_f32_32x32x16_bf16 v[20:35], v[76:79], v[68:71], v[20:35]
    ds_read_b64_tr_b16 v[94:95], v129 offset:62464
    ds_read_b64_tr_b16 v[96:97], v130 offset:61440
    s_waitcnt lgkmcnt(6)
    v_mfma_f32_32x32x16_bf16 v[36:51], v[80:83], v[68:71], v[36:51]
    ds_read_b64_tr_b16 v[98:99], v130 offset:62464
    ds_read_b64_tr_b16 v[100:101], v131 offset:61440
    s_waitcnt lgkmcnt(6)
    v_mfma_f32_32x32x16_bf16 v[52:67], v[84:87], v[68:71], v[52:67]
    ds_read_b64_tr_b16 v[102:103], v131 offset:62464
    ds_read_b64_tr_b16 v[104:105], v132 offset:61440
    ds_read_b64_tr_b16 v[106:107], v132 offset:62464
    s_waitcnt lgkmcnt(0)
    s_waitcnt vmcnt(0)
    s_barrier
    ds_read_b128 v[68:71], v121 offset:0
    ds_read_b64_tr_b16 v[72:73], v133 offset:32768
    ds_read_b64_tr_b16 v[74:75], v133 offset:33792
    ds_read_b64_tr_b16 v[76:77], v134 offset:32768
    ds_read_b64_tr_b16 v[78:79], v134 offset:33792
    ds_read_b64_tr_b16 v[80:81], v135 offset:32768
    ds_read_b64_tr_b16 v[82:83], v135 offset:33792
    ds_read_b64_tr_b16 v[84:85], v136 offset:32768
    ds_read_b64_tr_b16 v[86:87], v136 offset:33792
    v_mfma_f32_32x32x16_bf16 v[4:19], v[92:95], v[88:91], v[4:19]
    s_add_u32 s53, s48, 0
    s_cmp_ge_u32 s53, s56
    s_cselect_b32 s82, s72, 0
    s_add_u32 s82, s82, s53
    s_lshl_b32 s82, s82, 14
    s_add_u32 m0, s50, 0
    s_add_u32 s82, s82, s49
    buffer_load_dwordx4 v240, s[12:15], s82 offen offset:0 lds
    buffer_load_dwordx4 v240, s[12:15], s82 offen offset:1024 lds
    buffer_load_dwordx4 v240, s[12:15], s82 offen offset:2048 lds
    buffer_load_dwordx4 v240, s[12:15], s82 offen offset:3072 lds
    v_mfma_f32_32x32x16_bf16 v[20:35], v[96:99], v[88:91], v[20:35]
    s_add_u32 s53, s48, 1
    s_cmp_ge_u32 s53, s56
    s_cselect_b32 s82, s72, 0
    s_add_u32 s82, s82, s53
    s_lshl_b32 s82, s82, 14
    s_add_u32 m0, s50, 32768
    s_add_u32 s82, s82, s49
    buffer_load_dwordx4 v240, s[12:15], s82 offen offset:0 lds
    buffer_load_dwordx4 v240, s[12:15], s82 offen offset:1024 lds
    buffer_load_dwordx4 v240, s[12:15], s82 offen offset:2048 lds
    buffer_load_dwordx4 v240, s[12:15], s82 offen offset:3072 lds
    v_mfma_f32_32x32x16_bf16 v[36:51], v[100:103], v[88:91], v[36:51]
    v_mfma_f32_32x32x16_bf16 v[52:67], v[104:107], v[88:91], v[52:67]
    s_waitcnt lgkmcnt(6)
    v_mfma_f32_32x32x16_bf16 v[4:19], v[72:75], v[68:71], v[4:19]
    ds_read_b128 v[88:91], v122 offset:0
    ds_read_b64_tr_b16 v[92:93], v133 offset:36864
    s_waitcnt lgkmcnt(6)
    v_mfma_f32_32x32x16_bf16 v[20:35], v[76:79], v[68:71], v[20:35]
    ds_read_b64_tr_b16 v[94:95], v133 offset:37888
    ds_read_b64_tr_b16 v[96:97], v134 offset:36864
    s_waitcnt lgkmcnt(6)
    v_mfma_f32_32x32x16_bf16 v[36:51], v[80:83], v[68:71], v[36:51]
    ds_read_b64_tr_b16 v[98:99], v134 offset:37888
    ds_read_b64_tr_b16 v[100:101], v135 offset:36864
    s_waitcnt lgkmcnt(6)
    v_mfma_f32_32x32x16_bf16 v[52:67], v[84:87], v[68:71], v[52:67]
    ds_read_b64_tr_b16 v[102:103], v135 offset:37888
    ds_read_b64_tr_b16 v[104:105], v136 offset:36864
    ds_read_b64_tr_b16 v[106:107], v136 offset:37888
    s_waitcnt lgkmcnt(6)
    v_mfma_f32_32x32x16_bf16 v[4:19], v[92:95], v[88:91], v[4:19]
    ds_read_b128 v[68:71], v123 offset:0
    ds_read_b64_tr_b16 v[72:73], v133 offset:40960
    s_waitcnt lgkmcnt(6)
    v_mfma_f32_32x32x16_bf16 v[20:35], v[96:99], v[88:91], v[20:35]
    ds_read_b64_tr_b16 v[74:75], v133 offset:41984
    ds_read_b64_tr_b16 v[76:77], v134 offset:40960
    s_waitcnt lgkmcnt(6)
    v_mfma_f32_32x32x16_bf16 v[36:51], v[100:103], v[88:91], v[36:51]
    ds_read_b64_tr_b16 v[78:79], v134 offset:41984
    ds_read_b64_tr_b16 v[80:81], v135 offset:40960
    s_waitcnt lgkmcnt(6)
    v_mfma_f32_32x32x16_bf16 v[52:67], v[104:107], v[88:91], v[52:67]
    ds_read_b64_tr_b16 v[82:83], v135 offset:41984
    ds_read_b64_tr_b16 v[84:85], v136 offset:40960
    ds_read_b64_tr_b16 v[86:87], v136 offset:41984
    s_waitcnt lgkmcnt(6)
    v_mfma_f32_32x32x16_bf16 v[4:19], v[72:75], v[68:71], v[4:19]
    ds_read_b128 v[88:91], v124 offset:0
    ds_read_b64_tr_b16 v[92:93], v133 offset:45056
    s_waitcnt lgkmcnt(6)
    v_mfma_f32_32x32x16_bf16 v[20:35], v[76:79], v[68:71], v[20:35]
    ds_read_b64_tr_b16 v[94:95], v133 offset:46080
    ds_read_b64_tr_b16 v[96:97], v134 offset:45056
    s_waitcnt lgkmcnt(6)
    v_mfma_f32_32x32x16_bf16 v[36:51], v[80:83], v[68:71], v[36:51]
    ds_read_b64_tr_b16 v[98:99], v134 offset:46080
    ds_read_b64_tr_b16 v[100:101], v135 offset:45056
    s_waitcnt lgkmcnt(6)
    v_mfma_f32_32x32x16_bf16 v[52:67], v[84:87], v[68:71], v[52:67]
    ds_read_b64_tr_b16 v[102:103], v135 offset:46080
    ds_read_b64_tr_b16 v[104:105], v136 offset:45056
    ds_read_b64_tr_b16 v[106:107], v136 offset:46080
    s_waitcnt lgkmcnt(6)
    v_mfma_f32_32x32x16_bf16 v[4:19], v[92:95], v[88:91], v[4:19]
    s_waitcnt lgkmcnt(4)
    v_mfma_f32_32x32x16_bf16 v[20:35], v[96:99], v[88:91], v[20:35]
    s_waitcnt lgkmcnt(2)
    v_mfma_f32_32x32x16_bf16 v[36:51], v[100:103], v[88:91], v[36:51]
    s_waitcnt lgkmcnt(0)
    v_mfma_f32_32x32x16_bf16 v[52:67], v[104:107], v[88:91], v[52:67]
    s_nop 15
    v_mul_f32 v4, s62, v4
    v_mul_f32 v5, s62, v5
    v_mul_f32 v6, s62, v6
    v_mul_f32 v7, s62, v7
    v_mul_f32 v8, s62, v8
    v_mul_f32 v9, s62, v9
    v_mul_f32 v10, s62, v10
    v_mul_f32 v11, s62, v11
    v_mul_f32 v12, s62, v12
    v_mul_f32 v13, s62, v13
    v_mul_f32 v14, s62, v14
    v_mul_f32 v15, s62, v15
    v_mul_f32 v16, s62, v16
    v_mul_f32 v17, s62, v17
    v_mul_f32 v18, s62, v18
    v_mul_f32 v19, s62, v19
    v_mul_f32 v20, s62, v20
    v_mul_f32 v21, s62, v21
    v_mul_f32 v22, s62, v22
    v_mul_f32 v23, s62, v23
    v_mul_f32 v24, s62, v24
    v_mul_f32 v25, s62, v25
    v_mul_f32 v26, s62, v26
    v_mul_f32 v27, s62, v27
    v_mul_f32 v28, s62, v28
    v_mul_f32 v29, s62, v29
    v_mul_f32 v30, s62, v30
    v_mul_f32 v31, s62, v31
    v_mul_f32 v32, s62, v32
    v_mul_f32 v33, s62, v33
    v_mul_f32 v34, s62, v34
    v_mul_f32 v35, s62, v35
    v_mul_f32 v36, s62, v36
    v_mul_f32 v37, s62, v37
    v_mul_f32 v38, s62, v38
    v_mul_f32 v39, s62, v39
    v_mul_f32 v40, s62, v40
    v_mul_f32 v41, s62, v41
    v_mul_f32 v42, s62, v42
    v_mul_f32 v43, s62, v43
    v_mul_f32 v44, s62, v44
    v_mul_f32 v45, s62, v45
    v_mul_f32 v46, s62, v46
    v_mul_f32 v47, s62, v47
    v_mul_f32 v48, s62, v48
    v_mul_f32 v49, s62, v49
    v_mul_f32 v50, s62, v50
    v_mul_f32 v51, s62, v51
    v_mul_f32 v52, s62, v52
    v_mul_f32 v53, s62, v53
    v_mul_f32 v54, s62, v54
    v_mul_f32 v55, s62, v55
    v_mul_f32 v56, s62, v56
    v_mul_f32 v57, s62, v57
    v_mul_f32 v58, s62, v58
    v_mul_f32 v59, s62, v59
    v_mul_f32 v60, s62, v60
    v_mul_f32 v61, s62, v61
    v_mul_f32 v62, s62, v62
    v_mul_f32 v63, s62, v63
    v_mul_f32 v64, s62, v64
    v_mul_f32 v65, s62, v65
    v_mul_f32 v66, s62, v66
    v_mul_f32 v67, s62, v67
    v_cvt_pk_bf16_f32 v148, v4, v5
    v_cvt_pk_bf16_f32 v149, v6, v7
    v_cvt_pk_bf16_f32 v150, v8, v9
    v_cvt_pk_bf16_f32 v151, v10, v11
    v_cvt_pk_bf16_f32 v152, v12, v13
    v_cvt_pk_bf16_f32 v153, v14, v15
    v_cvt_pk_bf16_f32 v154, v16, v17
    v_cvt_pk_bf16_f32 v155, v18, v19
    v_cvt_pk_bf16_f32 v156, v20, v21
    v_cvt_pk_bf16_f32 v157, v22, v23
    v_cvt_pk_bf16_f32 v158, v24, v25
    v_cvt_pk_bf16_f32 v159, v26, v27
    v_cvt_pk_bf16_f32 v160, v28, v29
    v_cvt_pk_bf16_f32 v161, v30, v31
    v_cvt_pk_bf16_f32 v162, v32, v33
    v_cvt_pk_bf16_f32 v163, v34, v35
    v_cvt_pk_bf16_f32 v164, v36, v37
    v_cvt_pk_bf16_f32 v165, v38, v39
    v_cvt_pk_bf16_f32 v166, v40, v41
    v_cvt_pk_bf16_f32 v167, v42, v43
    v_cvt_pk_bf16_f32 v168, v44, v45
    v_cvt_pk_bf16_f32 v169, v46, v47
    v_cvt_pk_bf16_f32 v170, v48, v49
    v_cvt_pk_bf16_f32 v171, v50, v51
    v_cvt_pk_bf16_f32 v172, v52, v53
    v_cvt_pk_bf16_f32 v173, v54, v55
    v_cvt_pk_bf16_f32 v174, v56, v57
    v_cvt_pk_bf16_f32 v175, v58, v59
    v_cvt_pk_bf16_f32 v176, v60, v61
    v_cvt_pk_bf16_f32 v177, v62, v63
    v_cvt_pk_bf16_f32 v178, v64, v65
    v_cvt_pk_bf16_f32 v179, v66, v67
    s_waitcnt vmcnt(0)
    s_barrier
    s_cmp_eq_u32 s51, 0
    s_cbranch_scc0 attn_kernel_L2
    ds_write_b128 v246, v[148:151] offset:0
    ds_write_b128 v246, v[152:155] offset:1024
    ds_write_b128 v246, v[156:159] offset:2048
    ds_write_b128 v246, v[160:163] offset:3072
    ds_write_b128 v246, v[164:167] offset:4096
    ds_write_b128 v246, v[168:171] offset:5120
    ds_write_b128 v246, v[172:175] offset:6144
    ds_write_b128 v246, v[176:179] offset:7168
attn_kernel_L2:
    s_cmp_eq_u32 s51, 1
    s_cbranch_scc0 attn_kernel_L3
    s_setprio 1
attn_kernel_L3:
    ds_read_b128 v[180:183], v228 offset:0
    ds_read_b128 v[184:187], v228 offset:8192
    ds_read_b128 v[188:191], v229 offset:0
    ds_read_b128 v[192:195], v229 offset:8192
    ds_read_b128 v[196:199], v230 offset:0
    ds_read_b128 v[200:203], v230 offset:8192
    ds_read_b128 v[204:207], v231 offset:0
    ds_read_b128 v[208:211], v231 offset:8192
    s_cmp_le_u32 s48, 16
    s_cbranch_scc0 attn_kernel_L7
    s_add_u32 s53, s48, 0
    s_cmp_ge_u32 s53, s56
    s_cselect_b32 s82, s72, 0
    s_add_u32 s82, s82, s53
    s_lshl_b32 s82, s82, 14
    s_add_u32 m0, s50, 65536
    s_add_u32 s82, s82, s49
    buffer_load_dwordx4 v240, s[16:19], s82 offen offset:0 lds
    buffer_load_dwordx4 v240, s[16:19], s82 offen offset:1024 lds
    buffer_load_dwordx4 v240, s[16:19], s82 offen offset:2048 lds
    buffer_load_dwordx4 v240, s[16:19], s82 offen offset:3072 lds
attn_kernel_L7:
    s_waitcnt lgkmcnt(7)
    v_mfma_f32_32x32x16_bf16 v[68:83], v[180:183], v[148:151], 0
    ds_read_b128 v[180:183], v232 offset:0
    v_mov_b32 v4, 0
    v_mov_b32 v5, 0
    v_mov_b32 v6, 0
    v_mov_b32 v7, 0
    s_waitcnt lgkmcnt(7)
    v_mfma_f32_32x32x16_bf16 v[84:99], v[184:187], v[148:151], 0
    ds_read_b128 v[184:187], v232 offset:8192
    v_mov_b32 v8, 0
    v_mov_b32 v9, 0
    v_mov_b32 v10, 0
    v_mov_b32 v11, 0
    s_waitcnt lgkmcnt(7)
    v_mfma_f32_32x32x16_bf16 v[68:83], v[188:191], v[152:155], v[68:83]
    ds_read_b128 v[188:191], v233 offset:0
    v_mov_b32 v12, 0
    v_mov_b32 v13, 0
    v_mov_b32 v14, 0
    v_mov_b32 v15, 0
    s_waitcnt lgkmcnt(7)
    v_mfma_f32_32x32x16_bf16 v[84:99], v[192:195], v[152:155], v[84:99]
    ds_read_b128 v[192:195], v233 offset:8192
    v_mov_b32 v16, 0
    v_mov_b32 v17, 0
    v_mov_b32 v18, 0
    v_mov_b32 v19, 0
    s_waitcnt lgkmcnt(7)
    v_mfma_f32_32x32x16_bf16 v[68:83], v[196:199], v[156:159], v[68:83]
    ds_read_b128 v[196:199], v234 offset:0
    v_mov_b32 v20, 0
    v_mov_b32 v21, 0
    v_mov_b32 v22, 0
    v_mov_b32 v23, 0
    s_waitcnt lgkmcnt(7)
    v_mfma_f32_32x32x16_bf16 v[84:99], v[200:203], v[156:159], v[84:99]
    ds_read_b128 v[200:203], v234 offset:8192
    v_mov_b32 v24, 0
    v_mov_b32 v25, 0
    v_mov_b32 v26, 0
    v_mov_b32 v27, 0
    s_waitcnt lgkmcnt(7)
    v_mfma_f32_32x32x16_bf16 v[68:83], v[204:207], v[160:163], v[68:83]
    ds_read_b128 v[204:207], v235 offset:0
    v_mov_b32 v28, 0
    v_mov_b32 v29, 0
    v_mov_b32 v30, 0
    v_mov_b32 v31, 0
    s_waitcnt lgkmcnt(7)
    v_mfma_f32_32x32x16_bf16 v[84:99], v[208:211], v[160:163], v[84:99]
    ds_read_b128 v[208:211], v235 offset:8192
    v_mov_b32 v32, 0
    v_mov_b32 v33, 0
    v_mov_b32 v34, 0
    v_mov_b32 v35, 0
    s_waitcnt lgkmcnt(7)
    v_mfma_f32_32x32x16_bf16 v[68:83], v[180:183], v[164:167], v[68:83]
    v_mov_b32 v36, 0
    v_mov_b32 v37, 0
    v_mov_b32 v38, 0
    v_mov_b32 v39, 0
    s_waitcnt lgkmcnt(6)
    v_mfma_f32_32x32x16_bf16 v[84:99], v[184:187], v[164:167], v[84:99]
    v_mov_b32 v40, 0
    v_mov_b32 v41, 0
    v_mov_b32 v42, 0
    v_mov_b32 v43, 0
    s_waitcnt lgkmcnt(5)
    v_mfma_f32_32x32x16_bf16 v[68:83], v[188:191], v[168:171], v[68:83]
    v_mov_b32 v44, 0
    v_mov_b32 v45, 0
    v_mov_b32 v46, 0
    v_mov_b32 v47, 0
    s_waitcnt lgkmcnt(4)
    v_mfma_f32_32x32x16_bf16 v[84:99], v[192:195], v[168:171], v[84:99]
    v_mov_b32 v48, 0
    v_mov_b32 v49, 0
    v_mov_b32 v50, 0
    v_mov_b32 v51, 0
    s_waitcnt lgkmcnt(3)
    v_mfma_f32_32x32x16_bf16 v[68:83], v[196:199], v[172:175], v[68:83]
    v_mov_b32 v52, 0
    v_mov_b32 v53, 0
    v_mov_b32 v54, 0
    v_mov_b32 v55, 0
    s_waitcnt lgkmcnt(2)
    v_mfma_f32_32x32x16_bf16 v[84:99], v[200:203], v[172:175], v[84:99]
    v_mov_b32 v56, 0
    v_mov_b32 v57, 0
    v_mov_b32 v58, 0
    v_mov_b32 v59, 0
    s_waitcnt lgkmcnt(1)
    v_mfma_f32_32x32x16_bf16 v[68:83], v[204:207], v[176:179], v[68:83]
    v_mov_b32 v60, 0
    v_mov_b32 v61, 0
    v_mov_b32 v62, 0
    v_mov_b32 v63, 0
    s_waitcnt lgkmcnt(0)
    v_mfma_f32_32x32x16_bf16 v[84:99], v[208:211], v[176:179], v[84:99]
    v_mov_b32 v64, 0
    v_mov_b32 v65, 0
    v_mov_b32 v66, 0
    v_mov_b32 v67, 0
    v_mov_b32 v250, 0
    v_mov_b32 v251, 0
    v_mov_b32 v242, 0
    s_barrier
    ds_read_b128 v[180:183], v228 offset:32768
    ds_read_b128 v[184:187], v228 offset:40960
    ds_read_b128 v[188:191], v229 offset:32768
    ds_read_b128 v[192:195], v229 offset:40960
    ds_read_b128 v[196:199], v230 offset:32768
    ds_read_b128 v[200:203], v230 offset:40960
    ds_read_b128 v[204:207], v231 offset:32768
    ds_read_b128 v[208:211], v231 offset:40960
    s_cmp_le_u32 s48, 14
    s_cbranch_scc0 attn_kernel_L8
    s_add_u32 s53, s48, 2
    s_cmp_ge_u32 s53, s56
    s_cselect_b32 s82, s72, 0
    s_add_u32 s82, s82, s53
    s_lshl_b32 s82, s82, 14
    s_add_u32 m0, s50, 0
    s_add_u32 s82, s82, s49
    buffer_load_dwordx4 v240, s[12:15], s82 offen offset:0 lds
    buffer_load_dwordx4 v240, s[12:15], s82 offen offset:1024 lds
    buffer_load_dwordx4 v240, s[12:15], s82 offen offset:2048 lds
    buffer_load_dwordx4 v240, s[12:15], s82 offen offset:3072 lds
attn_kernel_L8:
    s_cmp_le_u32 s48, 15
    s_cbranch_scc0 attn_kernel_L9
    s_add_u32 s53, s48, 1
    s_cmp_ge_u32 s53, s56
    s_cselect_b32 s82, s72, 0
    s_add_u32 s82, s82, s53
    s_lshl_b32 s82, s82, 14
    s_add_u32 m0, s50, 98304
    s_add_u32 s82, s82, s49
    buffer_load_dwordx4 v240, s[16:19], s82 offen offset:0 lds
    buffer_load_dwordx4 v240, s[16:19], s82 offen offset:1024 lds
    buffer_load_dwordx4 v240, s[16:19], s82 offen offset:2048 lds
    buffer_load_dwordx4 v240, s[16:19], s82 offen offset:3072 lds
attn_kernel_L9:
    s_add_u32 s53, s48, 0
    s_cmp_ge_u32 s53, s56
    s_cselect_b32 s82, s72, 0
    s_add_u32 s82, s82, s53
    s_cmp_ge_u32 s82, s81
    s_cbranch_scc0 attn_kernel_L10
    s_sub_u32 s82, s82, s81
    s_lshl_b32 s82, s82, 6
    v_subrev_u32 v244, s82, v241
    v_cmp_gt_i32 s[64:65], 0, v244
    v_cmp_gt_i32 s[66:67], 1, v244
    v_cmp_gt_i32 s[68:69], 2, v244
    v_cmp_gt_i32 s[70:71], 3, v244
    v_cndmask_b32 v68, v68, v245, s[64:65]
    v_cndmask_b32 v69, v69, v245, s[66:67]
    v_cndmask_b32 v70, v70, v245, s[68:69]
    v_cndmask_b32 v71, v71, v245, s[70:71]
    v_cmp_gt_i32 s[64:65], 8, v244
    v_cmp_gt_i32 s[66:67], 9, v244
    v_cmp_gt_i32 s[68:69], 10, v244
    v_cmp_gt_i32 s[70:71], 11, v244
    v_cndmask_b32 v72, v72, v245, s[64:65]
    v_cndmask_b32 v73, v73, v245, s[66:67]
    v_cndmask_b32 v74, v74, v245, s[68:69]
    v_cndmask_b32 v75, v75, v245, s[70:71]
    v_cmp_gt_i32 s[64:65], 16, v244
    v_cmp_gt_i32 s[66:67], 17, v244
    v_cmp_gt_i32 s[68:69], 18, v244
    v_cmp_gt_i32 s[70:71], 19, v244
    v_cndmask_b32 v76, v76, v245, s[64:65]
    v_cndmask_b32 v77, v77, v245, s[66:67]
    v_cndmask_b32 v78, v78, v245, s[68:69]
    v_cndmask_b32 v79, v79, v245, s[70:71]
    v_cmp_gt_i32 s[64:65], 24, v244
    v_cmp_gt_i32 s[66:67], 25, v244
    v_cmp_gt_i32 s[68:69], 26, v244
    v_cmp_gt_i32 s[70:71], 27, v244
    v_cndmask_b32 v80, v80, v245, s[64:65]
    v_cndmask_b32 v81, v81, v245, s[66:67]
    v_cndmask_b32 v82, v82, v245, s[68:69]
    v_cndmask_b32 v83, v83, v245, s[70:71]
    v_cmp_gt_i32 s[64:65], 32, v244
    v_cmp_gt_i32 s[66:67], 33, v244
    v_cmp_gt_i32 s[68:69], 34, v244
    v_cmp_gt_i32 s[70:71], 35, v244
    v_cndmask_b32 v84, v84, v245, s[64:65]
    v_cndmask_b32 v85, v85, v245, s[66:67]
    v_cndmask_b32 v86, v86, v245, s[68:69]
    v_cndmask_b32 v87, v87, v245, s[70:71]
    v_cmp_gt_i32 s[64:65], 40, v244
    v_cmp_gt_i32 s[66:67], 41, v244
    v_cmp_gt_i32 s[68:69], 42, v244
    v_cmp_gt_i32 s[70:71], 43, v244
    v_cndmask_b32 v88, v88, v245, s[64:65]
    v_cndmask_b32 v89, v89, v245, s[66:67]
    v_cndmask_b32 v90, v90, v245, s[68:69]
    v_cndmask_b32 v91, v91, v245, s[70:71]
    v_cmp_gt_i32 s[64:65], 48, v244
    v_cmp_gt_i32 s[66:67], 49, v244
    v_cmp_gt_i32 s[68:69], 50, v244
    v_cmp_gt_i32 s[70:71], 51, v244
    v_cndmask_b32 v92, v92, v245, s[64:65]
    v_cndmask_b32 v93, v93, v245, s[66:67]
    v_cndmask_b32 v94, v94, v245, s[68:69]
    v_cndmask_b32 v95, v95, v245, s[70:71]
    v_cmp_gt_i32 s[64:65], 56, v244
    v_cmp_gt_i32 s[66:67], 57, v244
    v_cmp_gt_i32 s[68:69], 58, v244
    v_cmp_gt_i32 s[70:71], 59, v244
    v_cndmask_b32 v96, v96, v245, s[64:65]
    v_cndmask_b32 v97, v97, v245, s[66:67]
    v_cndmask_b32 v98, v98, v245, s[68:69]
    v_cndmask_b32 v99, v99, v245, s[70:71]
    s_waitcnt lgkmcnt(0)
attn_kernel_L10:
    v_max3_f32 v243, v68, v69, v70
    v_max3_f32 v244, v71, v72, v73
    v_max3_f32 v243, v243, v74, v75
    v_max3_f32 v244, v244, v76, v77
    v_max3_f32 v243, v243, v78, v79
    v_max3_f32 v244, v244, v80, v81
    v_max3_f32 v243, v243, v82, v83
    v_max3_f32 v244, v244, v84, v85
    v_max3_f32 v243, v243, v86, v87
    v_max3_f32 v244, v244, v88, v89
    v_max3_f32 v243, v243, v90, v91
    v_max3_f32 v244, v244, v92, v93
    v_max3_f32 v243, v243, v94, v95
    v_max3_f32 v244, v244, v96, v97
    v_max3_f32 v243, v243, v98, v99
    v_max_f32 v243, v243, v244
    v_mov_b32 v244, v243
    s_nop 1
    v_permlane32_swap_b32 v244, v243
    s_nop 1
    v_max_f32 v243, v243, v244
    v_max_f32 v243, 0xf149f2ca, v243
    v_add_f32 v242, v242, v243
    v_sub_f32 v68, v68, v243
    v_sub_f32 v69, v69, v243
    v_sub_f32 v70, v70, v243
    v_sub_f32 v71, v71, v243
    v_sub_f32 v72, v72, v243
    v_sub_f32 v73, v73, v243
    v_sub_f32 v74, v74, v243
    v_sub_f32 v75, v75, v243
    v_sub_f32 v76, v76, v243
    v_sub_f32 v77, v77, v243
    v_sub_f32 v78, v78, v243
    v_sub_f32 v79, v79, v243
    v_sub_f32 v80, v80, v243
    v_sub_f32 v81, v81, v243
    v_sub_f32 v82, v82, v243
    v_sub_f32 v83, v83, v243
    v_sub_f32 v84, v84, v243
    v_sub_f32 v85, v85, v243
    v_sub_f32 v86, v86, v243
    v_sub_f32 v87, v87, v243
    v_sub_f32 v88, v88, v243
    v_sub_f32 v89, v89, v243
    v_sub_f32 v90, v90, v243
    v_sub_f32 v91, v91, v243
    v_sub_f32 v92, v92, v243
    v_sub_f32 v93, v93, v243
    v_sub_f32 v94, v94, v243
    v_sub_f32 v95, v95, v243
    v_sub_f32 v96, v96, v243
    v_sub_f32 v97, v97, v243
    v_sub_f32 v98, v98, v243
    v_sub_f32 v99, v99, v243
    v_sub_f32 v212, 0, v242
    v_sub_f32 v213, 0, v242
    v_sub_f32 v214, 0, v242
    v_sub_f32 v215, 0, v242
    v_sub_f32 v216, 0, v242
    v_sub_f32 v217, 0, v242
    v_sub_f32 v218, 0, v242
    v_sub_f32 v219, 0, v242
    v_sub_f32 v220, 0, v242
    v_sub_f32 v221, 0, v242
    v_sub_f32 v222, 0, v242
    v_sub_f32 v223, 0, v242
    v_sub_f32 v224, 0, v242
    v_sub_f32 v225, 0, v242
    v_sub_f32 v226, 0, v242
    v_sub_f32 v227, 0, v242
attn_kernel_loop4:
    s_cmp_eq_u32 s48, 16
    s_cbranch_scc1 attn_kernel_tail6
    s_waitcnt lgkmcnt(7)
    v_mfma_f32_32x32x16_bf16 v[100:115], v[180:183], v[148:151], v[212:227]
    ds_read_b128 v[180:183], v232 offset:32768
    v_exp_f32 v68, v68
    v_exp_f32 v69, v69
    v_exp_f32 v70, v70
    s_waitcnt lgkmcnt(7)
    v_mfma_f32_32x32x16_bf16 v[116:131], v[184:187], v[148:151], v[212:227]
    ds_read_b128 v[184:187], v232 offset:40960
    v_exp_f32 v71, v71
    v_exp_f32 v72, v72
    s_waitcnt lgkmcnt(7)
    v_mfma_f32_32x32x16_bf16 v[100:115], v[188:191], v[152:155], v[100:115]
    ds_read_b128 v[188:191], v233 offset:32768
    v_exp_f32 v73, v73
    v_exp_f32 v74, v74
    s_waitcnt lgkmcnt(7)
    v_mfma_f32_32x32x16_bf16 v[116:131], v[192:195], v[152:155], v[116:131]
    ds_read_b128 v[192:195], v233 offset:40960
    v_exp_f32 v75, v75
    v_cvt_pk_bf16_f32 v132, v68, v69
    v_cvt_pk_bf16_f32 v133, v70, v71
    s_waitcnt lgkmcnt(7)
    v_mfma_f32_32x32x16_bf16 v[100:115], v[196:199], v[156:159], v[100:115]
    ds_read_b128 v[196:199], v234 offset:32768
    v_cvt_pk_bf16_f32 v134, v72, v73
    v_cvt_pk_bf16_f32 v135, v74, v75
    v_add_f32 v250, v250, v68
    v_add_f32 v251, v251, v69
    s_waitcnt lgkmcnt(7)
    v_mfma_f32_32x32x16_bf16 v[116:131], v[200:203], v[156:159], v[116:131]
    ds_read_b128 v[200:203], v234 offset:40960
    v_add_f32 v250, v250, v70
    v_add_f32 v251, v251, v71
    v_add_f32 v250, v250, v72
    v_add_f32 v251, v251, v73
    s_waitcnt lgkmcnt(7)
    v_mfma_f32_32x32x16_bf16 v[100:115], v[204:207], v[160:163], v[100:115]
    ds_read_b128 v[204:207], v235 offset:32768
    v_add_f32 v250, v250, v74
    v_add_f32 v251, v251, v75
    v_exp_f32 v76, v76
    v_exp_f32 v77, v77
    s_waitcnt lgkmcnt(7)
    v_mfma_f32_32x32x16_bf16 v[116:131], v[208:211], v[160:163], v[116:131]
    ds_read_b128 v[208:211], v235 offset:40960
    v_exp_f32 v78, v78
    v_exp_f32 v79, v79
    s_waitcnt lgkmcnt(7)
    v_mfma_f32_32x32x16_bf16 v[100:115], v[180:183], v[164:167], v[100:115]
    v_exp_f32 v80, v80
    v_exp_f32 v81, v81
    s_waitcnt lgkmcnt(6)
    v_mfma_f32_32x32x16_bf16 v[116:131], v[184:187], v[164:167], v[116:131]
    v_exp_f32 v82, v82
    v_exp_f32 v83, v83
    s_waitcnt vmcnt(8) lgkmcnt(0)
    s_cmp_lt_u32 s48, 14
    s_cbranch_scc1 attn_kernel_L11
    s_waitcnt vmcnt(0)
attn_kernel_L11:
    s_barrier
    v_mfma_f32_32x32x16_bf16 v[100:115], v[188:191], v[168:171], v[100:115]
    ds_read_b128 v[180:183], v236 offset:0
    ds_read_b128 v[184:187], v236 offset:4096
    v_cvt_pk_bf16_f32 v136, v76, v77
    v_cvt_pk_bf16_f32 v137, v78, v79
    v_cvt_pk_bf16_f32 v138, v80, v81
    v_cvt_pk_bf16_f32 v139, v82, v83
    v_mfma_f32_32x32x16_bf16 v[116:131], v[192:195], v[168:171], v[116:131]
    ds_read_b128 v[188:191], v236 offset:8192
    ds_read_b128 v[192:195], v236 offset:12288
    s_cmp_le_u32 s48, 13
    s_cbranch_scc0 attn_kernel_L12
    s_add_u32 s53, s48, 3
    s_cmp_ge_u32 s53, s56
    s_cselect_b32 s82, s72, 0
    s_add_u32 s82, s82, s53
    s_lshl_b32 s82, s82, 14
    s_add_u32 m0, s50, 32768
    s_add_u32 s82, s82, s49
    buffer_load_dwordx4 v240, s[12:15], s82 offen offset:0 lds
    buffer_load_dwordx4 v240, s[12:15], s82 offen offset:1024 lds
    buffer_load_dwordx4 v240, s[12:15], s82 offen offset:2048 lds
    buffer_load_dwordx4 v240, s[12:15], s82 offen offset:3072 lds
attn_kernel_L12:
    v_add_f32 v250, v250, v76
    v_add_f32 v251, v251, v77
    v_add_f32 v250, v250, v78
    v_add_f32 v251, v251, v79
    v_mfma_f32_32x32x16_bf16 v[100:115], v[196:199], v[172:175], v[100:115]
    ds_read_b128 v[196:199], v237 offset:0
    v_add_f32 v250, v250, v80
    v_add_f32 v251, v251, v81
    v_add_f32 v250, v250, v82
    v_add_f32 v251, v251, v83
    v_mfma_f32_32x32x16_bf16 v[116:131], v[200:203], v[172:175], v[116:131]
    ds_read_b128 v[200:203], v237 offset:4096
    v_exp_f32 v84, v84
    v_exp_f32 v85, v85
    v_exp_f32 v86, v86
    v_mfma_f32_32x32x16_bf16 v[100:115], v[204:207], v[176:179], v[100:115]
    ds_read_b128 v[204:207], v237 offset:8192
    v_exp_f32 v87, v87
    v_exp_f32 v88, v88
    v_mfma_f32_32x32x16_bf16 v[116:131], v[208:211], v[176:179], v[116:131]
    ds_read_b128 v[208:211], v237 offset:12288
    v_exp_f32 v89, v89
    v_exp_f32 v90, v90
    s_waitcnt lgkmcnt(7)
    v_mfma_f32_32x32x16_bf16 v[4:19], v[180:183], v[132:135], v[4:19]
    ds_read_b128 v[180:183], v238 offset:0
    v_exp_f32 v91, v91
    v_cvt_pk_bf16_f32 v140, v84, v85
    s_waitcnt lgkmcnt(7)
    v_mfma_f32_32x32x16_bf16 v[20:35], v[184:187], v[132:135], v[20:35]
    ds_read_b128 v[184:187], v238 offset:4096
    v_cvt_pk_bf16_f32 v141, v86, v87
    v_cvt_pk_bf16_f32 v142, v88, v89
    v_cvt_pk_bf16_f32 v143, v90, v91
    v_add_f32 v250, v250, v84
    v_add_f32 v251, v251, v85
    s_waitcnt lgkmcnt(7)
    v_mfma_f32_32x32x16_bf16 v[36:51], v[188:191], v[132:135], v[36:51]
    ds_read_b128 v[188:191], v238 offset:8192
    v_add_f32 v250, v250, v86
    v_add_f32 v251, v251, v87
    v_add_f32 v250, v250, v88
    v_add_f32 v251, v251, v89
    s_waitcnt lgkmcnt(7)
    v_mfma_f32_32x32x16_bf16 v[52:67], v[192:195], v[132:135], v[52:67]
    ds_read_b128 v[192:195], v238 offset:12288
    v_add_f32 v250, v250, v90
    v_add_f32 v251, v251, v91
    v_exp_f32 v92, v92
    s_waitcnt lgkmcnt(7)
    v_mfma_f32_32x32x16_bf16 v[4:19], v[196:199], v[136:139], v[4:19]
    ds_read_b128 v[196:199], v239 offset:0
    v_exp_f32 v93, v93
    v_exp_f32 v94, v94
    v_exp_f32 v95, v95
    s_waitcnt lgkmcnt(7)
    v_mfma_f32_32x32x16_bf16 v[20:35], v[200:203], v[136:139], v[20:35]
    ds_read_b128 v[200:203], v239 offset:4096
    v_exp_f32 v96, v96
    v_exp_f32 v97, v97
    s_waitcnt lgkmcnt(7)
    v_mfma_f32_32x32x16_bf16 v[36:51], v[204:207], v[136:139], v[36:51]
    ds_read_b128 v[204:207], v239 offset:8192
    v_exp_f32 v98, v98
    v_exp_f32 v99, v99
    s_waitcnt lgkmcnt(7)
    v_mfma_f32_32x32x16_bf16 v[52:67], v[208:211], v[136:139], v[52:67]
    ds_read_b128 v[208:211], v239 offset:12288
    v_cvt_pk_bf16_f32 v144, v92, v93
    v_cvt_pk_bf16_f32 v145, v94, v95
    v_cvt_pk_bf16_f32 v146, v96, v97
    s_waitcnt lgkmcnt(7)
    v_mfma_f32_32x32x16_bf16 v[4:19], v[180:183], v[140:143], v[4:19]
    v_cvt_pk_bf16_f32 v147, v98, v99
    v_add_f32 v250, v250, v92
    v_add_f32 v251, v251, v93
    v_add_f32 v250, v250, v94
    v_add_f32 v251, v251, v95
    s_waitcnt lgkmcnt(6)
    v_mfma_f32_32x32x16_bf16 v[20:35], v[184:187], v[140:143], v[20:35]
    v_add_f32 v250, v250, v96
    v_add_f32 v251, v251, v97
    v_add_f32 v250, v250, v98
    v_add_f32 v251, v251, v99
    s_waitcnt vmcnt(8) lgkmcnt(0)
    s_cmp_lt_u32 s48, 14
    s_cbranch_scc1 attn_kernel_L13
    s_waitcnt vmcnt(0)
attn_kernel_L13:
    s_barrier
    v_mfma_f32_32x32x16_bf16 v[36:51], v[188:191], v[140:143], v[36:51]
    ds_read_b128 v[180:183], v228 offset:0
    ds_read_b128 v[184:187], v228 offset:8192
    s_add_u32 s53, s48, 1
    s_cmp_ge_u32 s53, s56
    s_cselect_b32 s82, s72, 0
    s_add_u32 s82, s82, s53
    s_cmp_ge_u32 s82, s81
    s_cbranch_scc0 attn_kernel_L14
    s_sub_u32 s82, s82, s81
    s_lshl_b32 s82, s82, 6
    v_subrev_u32 v244, s82, v241
    s_add_u32 s53, s48, 2
    s_cmp_eq_u32 s53, s56
    s_cbranch_scc0 attn_kernel_L15
    ds_read_b128 v[148:151], v246 offset:0
    ds_read_b128 v[152:155], v246 offset:1024
    ds_read_b128 v[156:159], v246 offset:2048
    ds_read_b128 v[160:163], v246 offset:3072
    ds_read_b128 v[164:167], v246 offset:4096
    ds_read_b128 v[168:171], v246 offset:5120
    ds_read_b128 v[172:175], v246 offset:6144
    ds_read_b128 v[176:179], v246 offset:7168
attn_kernel_L15:
    v_cmp_gt_i32 s[64:65], 0, v244
    v_cmp_gt_i32 s[66:67], 1, v244
    v_cmp_gt_i32 s[68:69], 2, v244
    v_cmp_gt_i32 s[70:71], 3, v244
    v_cndmask_b32 v100, v100, v245, s[64:65]
    v_cndmask_b32 v101, v101, v245, s[66:67]
    v_cndmask_b32 v102, v102, v245, s[68:69]
    v_cndmask_b32 v103, v103, v245, s[70:71]
    v_cmp_gt_i32 s[64:65], 8, v244
    v_cmp_gt_i32 s[66:67], 9, v244
    v_cmp_gt_i32 s[68:69], 10, v244
    v_cmp_gt_i32 s[70:71], 11, v244
    v_cndmask_b32 v104, v104, v245, s[64:65]
    v_cndmask_b32 v105, v105, v245, s[66:67]
    v_cndmask_b32 v106, v106, v245, s[68:69]
    v_cndmask_b32 v107, v107, v245, s[70:71]
    v_cmp_gt_i32 s[64:65], 16, v244
    v_cmp_gt_i32 s[66:67], 17, v244
    v_cmp_gt_i32 s[68:69], 18, v244
    v_cmp_gt_i32 s[70:71], 19, v244
    v_cndmask_b32 v108, v108, v245, s[64:65]
    v_cndmask_b32 v109, v109, v245, s[66:67]
    v_cndmask_b32 v110, v110, v245, s[68:69]
    v_cndmask_b32 v111, v111, v245, s[70:71]
    v_cmp_gt_i32 s[64:65], 24, v244
    v_cmp_gt_i32 s[66:67], 25, v244
    v_cmp_gt_i32 s[68:69], 26, v244
    v_cmp_gt_i32 s[70:71], 27, v244
    v_cndmask_b32 v112, v112, v245, s[64:65]
    v_cndmask_b32 v113, v113, v245, s[66:67]
    v_cndmask_b32 v114, v114, v245, s[68:69]
    v_cndmask_b32 v115, v115, v245, s[70:71]
    v_cmp_gt_i32 s[64:65], 32, v244
    v_cmp_gt_i32 s[66:67], 33, v244
    v_cmp_gt_i32 s[68:69], 34, v244
    v_cmp_gt_i32 s[70:71], 35, v244
    v_cndmask_b32 v116, v116, v245, s[64:65]
    v_cndmask_b32 v117, v117, v245, s[66:67]
    v_cndmask_b32 v118, v118, v245, s[68:69]
    v_cndmask_b32 v119, v119, v245, s[70:71]
    v_cmp_gt_i32 s[64:65], 40, v244
    v_cmp_gt_i32 s[66:67], 41, v244
    v_cmp_gt_i32 s[68:69], 42, v244
    v_cmp_gt_i32 s[70:71], 43, v244
    v_cndmask_b32 v120, v120, v245, s[64:65]
    v_cndmask_b32 v121, v121, v245, s[66:67]
    v_cndmask_b32 v122, v122, v245, s[68:69]
    v_cndmask_b32 v123, v123, v245, s[70:71]
    v_cmp_gt_i32 s[64:65], 48, v244
    v_cmp_gt_i32 s[66:67], 49, v244
    v_cmp_gt_i32 s[68:69], 50, v244
    v_cmp_gt_i32 s[70:71], 51, v244
    v_cndmask_b32 v124, v124, v245, s[64:65]
    v_cndmask_b32 v125, v125, v245, s[66:67]
    v_cndmask_b32 v126, v126, v245, s[68:69]
    v_cndmask_b32 v127, v127, v245, s[70:71]
    v_cmp_gt_i32 s[64:65], 56, v244
    v_cmp_gt_i32 s[66:67], 57, v244
    v_cmp_gt_i32 s[68:69], 58, v244
    v_cmp_gt_i32 s[70:71], 59, v244
    v_cndmask_b32 v128, v128, v245, s[64:65]
    v_cndmask_b32 v129, v129, v245, s[66:67]
    v_cndmask_b32 v130, v130, v245, s[68:69]
    v_cndmask_b32 v131, v131, v245, s[70:71]
    s_waitcnt lgkmcnt(0)
attn_kernel_L14:
    v_max3_f32 v243, v100, v101, v102
    v_max3_f32 v244, v103, v104, v105
    v_max3_f32 v243, v243, v106, v107
    v_max3_f32 v244, v244, v108, v109
    v_mfma_f32_32x32x16_bf16 v[52:67], v[192:195], v[140:143], v[52:67]
    ds_read_b128 v[188:191], v229 offset:0
    ds_read_b128 v[192:195], v229 offset:8192
    s_cmp_le_u32 s48, 14
    s_cbranch_scc0 attn_kernel_L16
    s_add_u32 s53, s48, 2
    s_cmp_ge_u32 s53, s56
    s_cselect_b32 s82, s72, 0
    s_add_u32 s82, s82, s53
    s_lshl_b32 s82, s82, 14
    s_add_u32 m0, s50, 65536
    s_add_u32 s82, s82, s49
    buffer_load_dwordx4 v240, s[16:19], s82 offen offset:0 lds
    buffer_load_dwordx4 v240, s[16:19], s82 offen offset:1024 lds
    buffer_load_dwordx4 v240, s[16:19], s82 offen offset:2048 lds
    buffer_load_dwordx4 v240, s[16:19], s82 offen offset:3072 lds
attn_kernel_L16:
    v_max3_f32 v243, v243, v110, v111
    v_max3_f32 v244, v244, v112, v113
    v_max3_f32 v243, v243, v114, v115
    v_max3_f32 v244, v244, v116, v117
    v_max3_f32 v243, v243, v118, v119
    v_mfma_f32_32x32x16_bf16 v[4:19], v[196:199], v[144:147], v[4:19]
    ds_read_b128 v[196:199], v230 offset:0
    v_max3_f32 v244, v244, v120, v121
    v_max3_f32 v243, v243, v122, v123
    v_max3_f32 v244, v244, v124, v125
    v_max3_f32 v243, v243, v126, v127
    v_mfma_f32_32x32x16_bf16 v[20:35], v[200:203], v[144:147], v[20:35]
    ds_read_b128 v[200:203], v230 offset:8192
    v_max3_f32 v244, v244, v128, v129
    v_max3_f32 v243, v243, v130, v131
    v_max_f32 v243, v243, v244
    v_mov_b32 v244, v243
    v_mfma_f32_32x32x16_bf16 v[36:51], v[204:207], v[144:147], v[36:51]
    ds_read_b128 v[204:207], v231 offset:0
    s_nop 1
    v_permlane32_swap_b32 v244, v243
    s_nop 1
    v_max_f32 v243, v243, v244
    v_mfma_f32_32x32x16_bf16 v[52:67], v[208:211], v[144:147], v[52:67]
    ds_read_b128 v[208:211], v231 offset:8192
    v_cmp_lt_f32 vcc, 0x41000000, v243
    s_add_u32 s48, s48, 1
    s_nop 0
    s_cbranch_vccz attn_kernel_L17
    v_max_f32 v243, 0, v243
    v_sub_f32 v2, 0, v243
    v_exp_f32 v2, v2
    v_add_f32 v242, v242, v243
    v_sub_f32 v100, v100, v243
    v_sub_f32 v101, v101, v243
    v_sub_f32 v102, v102, v243
    v_sub_f32 v103, v103, v243
    v_sub_f32 v104, v104, v243
    v_sub_f32 v105, v105, v243
    v_sub_f32 v106, v106, v243
    v_sub_f32 v107, v107, v243
    v_sub_f32 v108, v108, v243
    v_sub_f32 v109, v109, v243
    v_sub_f32 v110, v110, v243
    v_sub_f32 v111, v111, v243
    v_sub_f32 v112, v112, v243
    v_sub_f32 v113, v113, v243
    v_sub_f32 v114, v114, v243
    v_sub_f32 v115, v115, v243
    v_sub_f32 v116, v116, v243
    v_sub_f32 v117, v117, v243
    v_sub_f32 v118, v118, v243
    v_sub_f32 v119, v119, v243
    v_sub_f32 v120, v120, v243
    v_sub_f32 v121, v121, v243
    v_sub_f32 v122, v122, v243
    v_sub_f32 v123, v123, v243
    v_sub_f32 v124, v124, v243
    v_sub_f32 v125, v125, v243
    v_sub_f32 v126, v126, v243
    v_sub_f32 v127, v127, v243
    v_sub_f32 v128, v128, v243
    v_sub_f32 v129, v129, v243
    v_sub_f32 v130, v130, v243
    v_sub_f32 v131, v131, v243
    v_sub_f32 v212, 0, v242
    v_sub_f32 v213, 0, v242
    v_sub_f32 v214, 0, v242
    v_sub_f32 v215, 0, v242
    v_sub_f32 v216, 0, v242
    v_sub_f32 v217, 0, v242
    v_sub_f32 v218, 0, v242
    v_sub_f32 v219, 0, v242
    v_sub_f32 v220, 0, v242
    v_sub_f32 v221, 0, v242
    v_sub_f32 v222, 0, v242
    v_sub_f32 v223, 0, v242
    v_sub_f32 v224, 0, v242
    v_sub_f32 v225, 0, v242
    v_sub_f32 v226, 0, v242
    v_sub_f32 v227, 0, v242
    v_mul_f32 v250, v250, v2
    v_mul_f32 v251, v251, v2
    v_mul_f32 v4, v4, v2
    v_mul_f32 v5, v5, v2
    v_mul_f32 v6, v6, v2
    v_mul_f32 v7, v7, v2
    v_mul_f32 v8, v8, v2
    v_mul_f32 v9, v9, v2
    v_mul_f32 v10, v10, v2
    v_mul_f32 v11, v11, v2
    v_mul_f32 v12, v12, v2
    v_mul_f32 v13, v13, v2
    v_mul_f32 v14, v14, v2
    v_mul_f32 v15, v15, v2
    v_mul_f32 v16, v16, v2
    v_mul_f32 v17, v17, v2
    v_mul_f32 v18, v18, v2
    v_mul_f32 v19, v19, v2
    v_mul_f32 v20, v20, v2
    v_mul_f32 v21, v21, v2
    v_mul_f32 v22, v22, v2
    v_mul_f32 v23, v23, v2
    v_mul_f32 v24, v24, v2
    v_mul_f32 v25, v25, v2
    v_mul_f32 v26, v26, v2
    v_mul_f32 v27, v27, v2
    v_mul_f32 v28, v28, v2
    v_mul_f32 v29, v29, v2
    v_mul_f32 v30, v30, v2
    v_mul_f32 v31, v31, v2
    v_mul_f32 v32, v32, v2
    v_mul_f32 v33, v33, v2
    v_mul_f32 v34, v34, v2
    v_mul_f32 v35, v35, v2
    v_mul_f32 v36, v36, v2
    v_mul_f32 v37, v37, v2
    v_mul_f32 v38, v38, v2
    v_mul_f32 v39, v39, v2
    v_mul_f32 v40, v40, v2
    v_mul_f32 v41, v41, v2
    v_mul_f32 v42, v42, v2
    v_mul_f32 v43, v43, v2
    v_mul_f32 v44, v44, v2
    v_mul_f32 v45, v45, v2
    v_mul_f32 v46, v46, v2
    v_mul_f32 v47, v47, v2
    v_mul_f32 v48, v48, v2
    v_mul_f32 v49, v49, v2
    v_mul_f32 v50, v50, v2
    v_mul_f32 v51, v51, v2
    v_mul_f32 v52, v52, v2
    v_mul_f32 v53, v53, v2
    v_mul_f32 v54, v54, v2
    v_mul_f32 v55, v55, v2
    v_mul_f32 v56, v56, v2
    v_mul_f32 v57, v57, v2
    v_mul_f32 v58, v58, v2
    v_mul_f32 v59, v59, v2
    v_mul_f32 v60, v60, v2
    v_mul_f32 v61, v61, v2
    v_mul_f32 v62, v62, v2
    v_mul_f32 v63, v63, v2
    v_mul_f32 v64, v64, v2
    v_mul_f32 v65, v65, v2
    v_mul_f32 v66, v66, v2
    v_mul_f32 v67, v67, v2
attn_kernel_L17:
    s_add_u32 s53, s48, 1
    s_cmp_eq_u32 s53, s56
    s_cbranch_scc0 attn_kernel_loop5
    v_mov_b32 v212, 0
    v_mov_b32 v213, 0
    v_mov_b32 v214, 0
    v_mov_b32 v215, 0
    v_mov_b32 v216, 0
    v_mov_b32 v217, 0
    v_mov_b32 v218, 0
    v_mov_b32 v219, 0
    v_mov_b32 v220, 0
    v_mov_b32 v221, 0
    v_mov_b32 v222, 0
    v_mov_b32 v223, 0
    v_mov_b32 v224, 0
    v_mov_b32 v225, 0
    v_mov_b32 v226, 0
    v_mov_b32 v227, 0
    s_lshl_b32 s81, s46, 1
    s_nop 0
attn_kernel_loop5:
    s_waitcnt lgkmcnt(7)
    v_mfma_f32_32x32x16_bf16 v[68:83], v[180:183], v[148:151], v[212:227]
    ds_read_b128 v[180:183], v232 offset:0
    v_exp_f32 v100, v100
    v_exp_f32 v101, v101
    v_exp_f32 v102, v102
    s_waitcnt lgkmcnt(7)
    v_mfma_f32_32x32x16_bf16 v[84:99], v[184:187], v[148:151], v[212:227]
    ds_read_b128 v[184:187], v232 offset:8192
    v_exp_f32 v103, v103
    v_exp_f32 v104, v104
    s_waitcnt lgkmcnt(7)
    v_mfma_f32_32x32x16_bf16 v[68:83], v[188:191], v[152:155], v[68:83]
    ds_read_b128 v[188:191], v233 offset:0
    v_exp_f32 v105, v105
    v_exp_f32 v106, v106
    s_waitcnt lgkmcnt(7)
    v_mfma_f32_32x32x16_bf16 v[84:99], v[192:195], v[152:155], v[84:99]
    ds_read_b128 v[192:195], v233 offset:8192
    v_exp_f32 v107, v107
    v_cvt_pk_bf16_f32 v132, v100, v101
    v_cvt_pk_bf16_f32 v133, v102, v103
    s_waitcnt lgkmcnt(7)
    v_mfma_f32_32x32x16_bf16 v[68:83], v[196:199], v[156:159], v[68:83]
    ds_read_b128 v[196:199], v234 offset:0
    v_cvt_pk_bf16_f32 v134, v104, v105
    v_cvt_pk_bf16_f32 v135, v106, v107
    v_add_f32 v250, v250, v100
    v_add_f32 v251, v251, v101
    s_waitcnt lgkmcnt(7)
    v_mfma_f32_32x32x16_bf16 v[84:99], v[200:203], v[156:159], v[84:99]
    ds_read_b128 v[200:203], v234 offset:8192
    v_add_f32 v250, v250, v102
    v_add_f32 v251, v251, v103
    v_add_f32 v250, v250, v104
    v_add_f32 v251, v251, v105
    s_waitcnt lgkmcnt(7)
    v_mfma_f32_32x32x16_bf16 v[68:83], v[204:207], v[160:163], v[68:83]
    ds_read_b128 v[204:207], v235 offset:0
    v_add_f32 v250, v250, v106
    v_add_f32 v251, v251, v107
    v_exp_f32 v108, v108
    v_exp_f32 v109, v109
    s_waitcnt lgkmcnt(7)
    v_mfma_f32_32x32x16_bf16 v[84:99], v[208:211], v[160:163], v[84:99]
    ds_read_b128 v[208:211], v235 offset:8192
    v_exp_f32 v110, v110
    v_exp_f32 v111, v111
    s_waitcnt lgkmcnt(7)
    v_mfma_f32_32x32x16_bf16 v[68:83], v[180:183], v[164:167], v[68:83]
    v_exp_f32 v112, v112
    v_exp_f32 v113, v113
    s_waitcnt lgkmcnt(6)
    v_mfma_f32_32x32x16_bf16 v[84:99], v[184:187], v[164:167], v[84:99]
    v_exp_f32 v114, v114
    v_exp_f32 v115, v115
    s_waitcnt vmcnt(8) lgkmcnt(0)
    s_cmp_lt_u32 s48, 14
    s_cbranch_scc1 attn_kernel_L19
    s_waitcnt vmcnt(0)
attn_kernel_L19:
    s_barrier
    v_mfma_f32_32x32x16_bf16 v[68:83], v[188:191], v[168:171], v[68:83]
    ds_read_b128 v[180:183], v236 offset:32768
    ds_read_b128 v[184:187], v236 offset:36864
    v_cvt_pk_bf16_f32 v136, v108, v109
    v_cvt_pk_bf16_f32 v137, v110, v111
    v_cvt_pk_bf16_f32 v138, v112, v113
    v_cvt_pk_bf16_f32 v139, v114, v115
    v_mfma_f32_32x32x16_bf16 v[84:99], v[192:195], v[168:171], v[84:99]
    ds_read_b128 v[188:191], v236 offset:40960
    ds_read_b128 v[192:195], v236 offset:45056
    s_cmp_le_u32 s48, 13
    s_cbranch_scc0 attn_kernel_L20
    s_add_u32 s53, s48, 3
    s_cmp_ge_u32 s53, s56
    s_cselect_b32 s82, s72, 0
    s_add_u32 s82, s82, s53
    s_lshl_b32 s82, s82, 14
    s_add_u32 m0, s50, 0
    s_add_u32 s82, s82, s49
    buffer_load_dwordx4 v240, s[12:15], s82 offen offset:0 lds
    buffer_load_dwordx4 v240, s[12:15], s82 offen offset:1024 lds
    buffer_load_dwordx4 v240, s[12:15], s82 offen offset:2048 lds
    buffer_load_dwordx4 v240, s[12:15], s82 offen offset:3072 lds
attn_kernel_L20:
    v_add_f32 v250, v250, v108
    v_add_f32 v251, v251, v109
    v_add_f32 v250, v250, v110
    v_add_f32 v251, v251, v111
    v_mfma_f32_32x32x16_bf16 v[68:83], v[196:199], v[172:175], v[68:83]
    ds_read_b128 v[196:199], v237 offset:32768
    v_add_f32 v250, v250, v112
    v_add_f32 v251, v251, v113
    v_add_f32 v250, v250, v114
    v_add_f32 v251, v251, v115
    v_mfma_f32_32x32x16_bf16 v[84:99], v[200:203], v[172:175], v[84:99]
    ds_read_b128 v[200:203], v237 offset:36864
    v_exp_f32 v116, v116
    v_exp_f32 v117, v117
    v_exp_f32 v118, v118
    v_mfma_f32_32x32x16_bf16 v[68:83], v[204:207], v[176:179], v[68:83]
    ds_read_b128 v[204:207], v237 offset:40960
    v_exp_f32 v119, v119
    v_exp_f32 v120, v120
    v_mfma_f32_32x32x16_bf16 v[84:99], v[208:211], v[176:179], v[84:99]
    ds_read_b128 v[208:211], v237 offset:45056
    v_exp_f32 v121, v121
    v_exp_f32 v122, v122
    s_waitcnt lgkmcnt(7)
    v_mfma_f32_32x32x16_bf16 v[4:19], v[180:183], v[132:135], v[4:19]
    ds_read_b128 v[180:183], v238 offset:32768
    v_exp_f32 v123, v123
    v_cvt_pk_bf16_f32 v140, v116, v117
    s_waitcnt lgkmcnt(7)
    v_mfma_f32_32x32x16_bf16 v[20:35], v[184:187], v[132:135], v[20:35]
    ds_read_b128 v[184:187], v238 offset:36864
    v_cvt_pk_bf16_f32 v141, v118, v119
    v_cvt_pk_bf16_f32 v142, v120, v121
    v_cvt_pk_bf16_f32 v143, v122, v123
    v_add_f32 v250, v250, v116
    v_add_f32 v251, v251, v117
    s_waitcnt lgkmcnt(7)
    v_mfma_f32_32x32x16_bf16 v[36:51], v[188:191], v[132:135], v[36:51]
    ds_read_b128 v[188:191], v238 offset:40960
    v_add_f32 v250, v250, v118
    v_add_f32 v251, v251, v119
    v_add_f32 v250, v250, v120
    v_add_f32 v251, v251, v121
    s_waitcnt lgkmcnt(7)
    v_mfma_f32_32x32x16_bf16 v[52:67], v[192:195], v[132:135], v[52:67]
    ds_read_b128 v[192:195], v238 offset:45056
    v_add_f32 v250, v250, v122
    v_add_f32 v251, v251, v123
    v_exp_f32 v124, v124
    s_waitcnt lgkmcnt(7)
    v_mfma_f32_32x32x16_bf16 v[4:19], v[196:199], v[136:139], v[4:19]
    ds_read_b128 v[196:199], v239 offset:32768
    v_exp_f32 v125, v125
    v_exp_f32 v126, v126
    v_exp_f32 v127, v127
    s_waitcnt lgkmcnt(7)
    v_mfma_f32_32x32x16_bf16 v[20:35], v[200:203], v[136:139], v[20:35]
    ds_read_b128 v[200:203], v239 offset:36864
    v_exp_f32 v128, v128
    v_exp_f32 v129, v129
    s_waitcnt lgkmcnt(7)
    v_mfma_f32_32x32x16_bf16 v[36:51], v[204:207], v[136:139], v[36:51]
    ds_read_b128 v[204:207], v239 offset:40960
    v_exp_f32 v130, v130
    v_exp_f32 v131, v131
    s_waitcnt lgkmcnt(7)
    v_mfma_f32_32x32x16_bf16 v[52:67], v[208:211], v[136:139], v[52:67]
    ds_read_b128 v[208:211], v239 offset:45056
    v_cvt_pk_bf16_f32 v144, v124, v125
    v_cvt_pk_bf16_f32 v145, v126, v127
    v_cvt_pk_bf16_f32 v146, v128, v129
    s_waitcnt lgkmcnt(7)
    v_mfma_f32_32x32x16_bf16 v[4:19], v[180:183], v[140:143], v[4:19]
    v_cvt_pk_bf16_f32 v147, v130, v131
    v_add_f32 v250, v250, v124
    v_add_f32 v251, v251, v125
    v_add_f32 v250, v250, v126
    v_add_f32 v251, v251, v127
    s_waitcnt lgkmcnt(6)
    v_mfma_f32_32x32x16_bf16 v[20:35], v[184:187], v[140:143], v[20:35]
    v_add_f32 v250, v250, v128
    v_add_f32 v251, v251, v129
    v_add_f32 v250, v250, v130
    v_add_f32 v251, v251, v131
    s_waitcnt vmcnt(8) lgkmcnt(0)
    s_cmp_lt_u32 s48, 14
    s_cbranch_scc1 attn_kernel_L21
    s_waitcnt vmcnt(0)
attn_kernel_L21:
    s_barrier
    v_mfma_f32_32x32x16_bf16 v[36:51], v[188:191], v[140:143], v[36:51]
    ds_read_b128 v[180:183], v228 offset:32768
    ds_read_b128 v[184:187], v228 offset:40960
    s_add_u32 s53, s48, 1
    s_cmp_ge_u32 s53, s56
    s_cselect_b32 s82, s72, 0
    s_add_u32 s82, s82, s53
    s_cmp_ge_u32 s82, s81
    s_cbranch_scc0 attn_kernel_L22
    s_sub_u32 s82, s82, s81
    s_lshl_b32 s82, s82, 6
    v_subrev_u32 v244, s82, v241
    s_add_u32 s53, s48, 2
    s_cmp_eq_u32 s53, s56
    s_cbranch_scc0 attn_kernel_L23
    ds_read_b128 v[148:151], v246 offset:0
    ds_read_b128 v[152:155], v246 offset:1024
    ds_read_b128 v[156:159], v246 offset:2048
    ds_read_b128 v[160:163], v246 offset:3072
    ds_read_b128 v[164:167], v246 offset:4096
    ds_read_b128 v[168:171], v246 offset:5120
    ds_read_b128 v[172:175], v246 offset:6144
    ds_read_b128 v[176:179], v246 offset:7168
attn_kernel_L23:
    v_cmp_gt_i32 s[64:65], 0, v244
    v_cmp_gt_i32 s[66:67], 1, v244
    v_cmp_gt_i32 s[68:69], 2, v244
    v_cmp_gt_i32 s[70:71], 3, v244
    v_cndmask_b32 v68, v68, v245, s[64:65]
    v_cndmask_b32 v69, v69, v245, s[66:67]
    v_cndmask_b32 v70, v70, v245, s[68:69]
    v_cndmask_b32 v71, v71, v245, s[70:71]
    v_cmp_gt_i32 s[64:65], 8, v244
    v_cmp_gt_i32 s[66:67], 9, v244
    v_cmp_gt_i32 s[68:69], 10, v244
    v_cmp_gt_i32 s[70:71], 11, v244
    v_cndmask_b32 v72, v72, v245, s[64:65]
    v_cndmask_b32 v73, v73, v245, s[66:67]
    v_cndmask_b32 v74, v74, v245, s[68:69]
    v_cndmask_b32 v75, v75, v245, s[70:71]
    v_cmp_gt_i32 s[64:65], 16, v244
    v_cmp_gt_i32 s[66:67], 17, v244
    v_cmp_gt_i32 s[68:69], 18, v244
    v_cmp_gt_i32 s[70:71], 19, v244
    v_cndmask_b32 v76, v76, v245, s[64:65]
    v_cndmask_b32 v77, v77, v245, s[66:67]
    v_cndmask_b32 v78, v78, v245, s[68:69]
    v_cndmask_b32 v79, v79, v245, s[70:71]
    v_cmp_gt_i32 s[64:65], 24, v244
    v_cmp_gt_i32 s[66:67], 25, v244
    v_cmp_gt_i32 s[68:69], 26, v244
    v_cmp_gt_i32 s[70:71], 27, v244
    v_cndmask_b32 v80, v80, v245, s[64:65]
    v_cndmask_b32 v81, v81, v245, s[66:67]
    v_cndmask_b32 v82, v82, v245, s[68:69]
    v_cndmask_b32 v83, v83, v245, s[70:71]
    v_cmp_gt_i32 s[64:65], 32, v244
    v_cmp_gt_i32 s[66:67], 33, v244
    v_cmp_gt_i32 s[68:69], 34, v244
    v_cmp_gt_i32 s[70:71], 35, v244
    v_cndmask_b32 v84, v84, v245, s[64:65]
    v_cndmask_b32 v85, v85, v245, s[66:67]
    v_cndmask_b32 v86, v86, v245, s[68:69]
    v_cndmask_b32 v87, v87, v245, s[70:71]
    v_cmp_gt_i32 s[64:65], 40, v244
    v_cmp_gt_i32 s[66:67], 41, v244
    v_cmp_gt_i32 s[68:69], 42, v244
    v_cmp_gt_i32 s[70:71], 43, v244
    v_cndmask_b32 v88, v88, v245, s[64:65]
    v_cndmask_b32 v89, v89, v245, s[66:67]
    v_cndmask_b32 v90, v90, v245, s[68:69]
    v_cndmask_b32 v91, v91, v245, s[70:71]
    v_cmp_gt_i32 s[64:65], 48, v244
    v_cmp_gt_i32 s[66:67], 49, v244
    v_cmp_gt_i32 s[68:69], 50, v244
    v_cmp_gt_i32 s[70:71], 51, v244
    v_cndmask_b32 v92, v92, v245, s[64:65]
    v_cndmask_b32 v93, v93, v245, s[66:67]
    v_cndmask_b32 v94, v94, v245, s[68:69]
    v_cndmask_b32 v95, v95, v245, s[70:71]
    v_cmp_gt_i32 s[64:65], 56, v244
    v_cmp_gt_i32 s[66:67], 57, v244
    v_cmp_gt_i32 s[68:69], 58, v244
    v_cmp_gt_i32 s[70:71], 59, v244
    v_cndmask_b32 v96, v96, v245, s[64:65]
    v_cndmask_b32 v97, v97, v245, s[66:67]
    v_cndmask_b32 v98, v98, v245, s[68:69]
    v_cndmask_b32 v99, v99, v245, s[70:71]
    s_waitcnt lgkmcnt(0)
attn_kernel_L22:
    v_max3_f32 v243, v68, v69, v70
    v_max3_f32 v244, v71, v72, v73
    v_max3_f32 v243, v243, v74, v75
    v_max3_f32 v244, v244, v76, v77
    v_mfma_f32_32x32x16_bf16 v[52:67], v[192:195], v[140:143], v[52:67]
    ds_read_b128 v[188:191], v229 offset:32768
    ds_read_b128 v[192:195], v229 offset:40960
    s_cmp_le_u32 s48, 14
    s_cbranch_scc0 attn_kernel_L24
    s_add_u32 s53, s48, 2
    s_cmp_ge_u32 s53, s56
    s_cselect_b32 s82, s72, 0
    s_add_u32 s82, s82, s53
    s_lshl_b32 s82, s82, 14
    s_add_u32 m0, s50, 98304
    s_add_u32 s82, s82, s49
    buffer_load_dwordx4 v240, s[16:19], s82 offen offset:0 lds
    buffer_load_dwordx4 v240, s[16:19], s82 offen offset:1024 lds
    buffer_load_dwordx4 v240, s[16:19], s82 offen offset:2048 lds
    buffer_load_dwordx4 v240, s[16:19], s82 offen offset:3072 lds
attn_kernel_L24:
    v_max3_f32 v243, v243, v78, v79
    v_max3_f32 v244, v244, v80, v81
    v_max3_f32 v243, v243, v82, v83
    v_max3_f32 v244, v244, v84, v85
    v_max3_f32 v243, v243, v86, v87
    v_mfma_f32_32x32x16_bf16 v[4:19], v[196:199], v[144:147], v[4:19]
    ds_read_b128 v[196:199], v230 offset:32768
    v_max3_f32 v244, v244, v88, v89
    v_max3_f32 v243, v243, v90, v91
    v_max3_f32 v244, v244, v92, v93
    v_max3_f32 v243, v243, v94, v95
    v_mfma_f32_32x32x16_bf16 v[20:35], v[200:203], v[144:147], v[20:35]
    ds_read_b128 v[200:203], v230 offset:40960
    v_max3_f32 v244, v244, v96, v97
    v_max3_f32 v243, v243, v98, v99
    v_max_f32 v243, v243, v244
    v_mov_b32 v244, v243
    v_mfma_f32_32x32x16_bf16 v[36:51], v[204:207], v[144:147], v[36:51]
    ds_read_b128 v[204:207], v231 offset:32768
    s_cmp_eq_u32 s48, 7
    s_cbranch_scc0 attn_kernel_L25
    s_mov_b32 s53, 0x200000
    buffer_load_dwordx2 v[252:253], v0, s[28:31], 0 offen
    buffer_load_dwordx2 v[252:253], v0, s[32:35], 0 offen
    buffer_load_dwordx2 v[252:253], v0, s[36:39], 0 offen
    buffer_load_dwordx2 v[252:253], v0, s[40:43], 0 offen
    buffer_load_dwordx2 v[252:253], v0, s[28:31], s53 offen
attn_kernel_L25:
    s_nop 1
    v_permlane32_swap_b32 v244, v243
    s_nop 1
    v_max_f32 v243, v243, v244
    v_mfma_f32_32x32x16_bf16 v[52:67], v[208:211], v[144:147], v[52:67]
    ds_read_b128 v[208:211], v231 offset:40960
    v_cmp_lt_f32 vcc, 0x41000000, v243
    s_add_u32 s48, s48, 1
    s_cmp_eq_u32 s48, s56
    s_cbranch_scc1 attn_kernel_L27
    s_cbranch_vccz attn_kernel_loop4
    v_max_f32 v243, 0, v243
    v_sub_f32 v2, 0, v243
    v_exp_f32 v2, v2
    v_add_f32 v242, v242, v243
    v_sub_f32 v68, v68, v243
    v_sub_f32 v69, v69, v243
    v_sub_f32 v70, v70, v243
    v_sub_f32 v71, v71, v243
    v_sub_f32 v72, v72, v243
    v_sub_f32 v73, v73, v243
    v_sub_f32 v74, v74, v243
    v_sub_f32 v75, v75, v243
    v_sub_f32 v76, v76, v243
    v_sub_f32 v77, v77, v243
    v_sub_f32 v78, v78, v243
    v_sub_f32 v79, v79, v243
    v_sub_f32 v80, v80, v243
    v_sub_f32 v81, v81, v243
    v_sub_f32 v82, v82, v243
    v_sub_f32 v83, v83, v243
    v_sub_f32 v84, v84, v243
    v_sub_f32 v85, v85, v243
    v_sub_f32 v86, v86, v243
    v_sub_f32 v87, v87, v243
    v_sub_f32 v88, v88, v243
    v_sub_f32 v89, v89, v243
    v_sub_f32 v90, v90, v243
    v_sub_f32 v91, v91, v243
    v_sub_f32 v92, v92, v243
    v_sub_f32 v93, v93, v243
    v_sub_f32 v94, v94, v243
    v_sub_f32 v95, v95, v243
    v_sub_f32 v96, v96, v243
    v_sub_f32 v97, v97, v243
    v_sub_f32 v98, v98, v243
    v_sub_f32 v99, v99, v243
    v_sub_f32 v212, 0, v242
    v_sub_f32 v213, 0, v242
    v_sub_f32 v214, 0, v242
    v_sub_f32 v215, 0, v242
    v_sub_f32 v216, 0, v242
    v_sub_f32 v217, 0, v242
    v_sub_f32 v218, 0, v242
    v_sub_f32 v219, 0, v242
    v_sub_f32 v220, 0, v242
    v_sub_f32 v221, 0, v242
    v_sub_f32 v222, 0, v242
    v_sub_f32 v223, 0, v242
    v_sub_f32 v224, 0, v242
    v_sub_f32 v225, 0, v242
    v_sub_f32 v226, 0, v242
    v_sub_f32 v227, 0, v242
    v_mul_f32 v250, v250, v2
    v_mul_f32 v251, v251, v2
    v_mul_f32 v4, v4, v2
    v_mul_f32 v5, v5, v2
    v_mul_f32 v6, v6, v2
    v_mul_f32 v7, v7, v2
    v_mul_f32 v8, v8, v2
    v_mul_f32 v9, v9, v2
    v_mul_f32 v10, v10, v2
    v_mul_f32 v11, v11, v2
    v_mul_f32 v12, v12, v2
    v_mul_f32 v13, v13, v2
    v_mul_f32 v14, v14, v2
    v_mul_f32 v15, v15, v2
    v_mul_f32 v16, v16, v2
    v_mul_f32 v17, v17, v2
    v_mul_f32 v18, v18, v2
    v_mul_f32 v19, v19, v2
    v_mul_f32 v20, v20, v2
    v_mul_f32 v21, v21, v2
    v_mul_f32 v22, v22, v2
    v_mul_f32 v23, v23, v2
    v_mul_f32 v24, v24, v2
    v_mul_f32 v25, v25, v2
    v_mul_f32 v26, v26, v2
    v_mul_f32 v27, v27, v2
    v_mul_f32 v28, v28, v2
    v_mul_f32 v29, v29, v2
    v_mul_f32 v30, v30, v2
    v_mul_f32 v31, v31, v2
    v_mul_f32 v32, v32, v2
    v_mul_f32 v33, v33, v2
    v_mul_f32 v34, v34, v2
    v_mul_f32 v35, v35, v2
    v_mul_f32 v36, v36, v2
    v_mul_f32 v37, v37, v2
    v_mul_f32 v38, v38, v2
    v_mul_f32 v39, v39, v2
    v_mul_f32 v40, v40, v2
    v_mul_f32 v41, v41, v2
    v_mul_f32 v42, v42, v2
    v_mul_f32 v43, v43, v2
    v_mul_f32 v44, v44, v2
    v_mul_f32 v45, v45, v2
    v_mul_f32 v46, v46, v2
    v_mul_f32 v47, v47, v2
    v_mul_f32 v48, v48, v2
    v_mul_f32 v49, v49, v2
    v_mul_f32 v50, v50, v2
    v_mul_f32 v51, v51, v2
    v_mul_f32 v52, v52, v2
    v_mul_f32 v53, v53, v2
    v_mul_f32 v54, v54, v2
    v_mul_f32 v55, v55, v2
    v_mul_f32 v56, v56, v2
    v_mul_f32 v57, v57, v2
    v_mul_f32 v58, v58, v2
    v_mul_f32 v59, v59, v2
    v_mul_f32 v60, v60, v2
    v_mul_f32 v61, v61, v2
    v_mul_f32 v62, v62, v2
    v_mul_f32 v63, v63, v2
    v_mul_f32 v64, v64, v2
    v_mul_f32 v65, v65, v2
    v_mul_f32 v66, v66, v2
    v_mul_f32 v67, v67, v2
    s_branch attn_kernel_loop4
attn_kernel_L27:
    v_add_f32 v2, v250, v251
    v_mov_b32 v244, v2
    v_mov_b32 v242, 0
    v_max_f32 v243, 0xf149f2ca, v243
    v_permlane32_swap_b32 v244, v2
    v_add_f32 v242, v242, v243
    v_sub_f32 v68, v68, v243
    v_sub_f32 v69, v69, v243
    v_sub_f32 v70, v70, v243
    v_sub_f32 v71, v71, v243
    v_sub_f32 v72, v72, v243
    v_sub_f32 v73, v73, v243
    v_sub_f32 v74, v74, v243
    v_sub_f32 v75, v75, v243
    v_sub_f32 v76, v76, v243
    v_sub_f32 v77, v77, v243
    v_sub_f32 v78, v78, v243
    v_sub_f32 v79, v79, v243
    v_sub_f32 v80, v80, v243
    v_sub_f32 v81, v81, v243
    v_sub_f32 v82, v82, v243
    v_sub_f32 v83, v83, v243
    v_sub_f32 v84, v84, v243
    v_sub_f32 v85, v85, v243
    v_sub_f32 v86, v86, v243
    v_sub_f32 v87, v87, v243
    v_sub_f32 v88, v88, v243
    v_sub_f32 v89, v89, v243
    v_sub_f32 v90, v90, v243
    v_sub_f32 v91, v91, v243
    v_sub_f32 v92, v92, v243
    v_sub_f32 v93, v93, v243
    v_sub_f32 v94, v94, v243
    v_sub_f32 v95, v95, v243
    v_sub_f32 v96, v96, v243
    v_sub_f32 v97, v97, v243
    v_sub_f32 v98, v98, v243
    v_sub_f32 v99, v99, v243
    v_sub_f32 v212, 0, v242
    v_sub_f32 v213, 0, v242
    v_sub_f32 v214, 0, v242
    v_sub_f32 v215, 0, v242
    v_sub_f32 v216, 0, v242
    v_sub_f32 v217, 0, v242
    v_sub_f32 v218, 0, v242
    v_sub_f32 v219, 0, v242
    v_sub_f32 v220, 0, v242
    v_sub_f32 v221, 0, v242
    v_sub_f32 v222, 0, v242
    v_sub_f32 v223, 0, v242
    v_sub_f32 v224, 0, v242
    v_sub_f32 v225, 0, v242
    v_sub_f32 v226, 0, v242
    v_sub_f32 v227, 0, v242
    v_add_f32 v2, v2, v244
    v_rcp_f32 v2, v2
    v_mov_b32 v250, 0
    v_mov_b32 v251, 0
    s_lshl_b32 s53, s47, 20
    s_add_u32 s53, s53, s55
    v_mul_f32 v4, v4, v2
    v_mul_f32 v5, v5, v2
    v_mul_f32 v6, v6, v2
    v_mul_f32 v7, v7, v2
    v_mul_f32 v8, v8, v2
    v_mul_f32 v9, v9, v2
    v_mul_f32 v10, v10, v2
    v_mul_f32 v11, v11, v2
    v_cvt_pk_bf16_f32 v100, v4, v5
    v_cvt_pk_bf16_f32 v101, v6, v7
    v_cvt_pk_bf16_f32 v102, v8, v9
    v_cvt_pk_bf16_f32 v103, v10, v11
    buffer_store_dwordx4 v[100:103], v247, s[20:23], s53 offen offset:0
    v_mul_f32 v12, v12, v2
    v_mul_f32 v13, v13, v2
    v_mul_f32 v14, v14, v2
    v_mul_f32 v15, v15, v2
    v_mul_f32 v16, v16, v2
    v_mul_f32 v17, v17, v2
    v_mul_f32 v18, v18, v2
    v_mul_f32 v19, v19, v2
    v_cvt_pk_bf16_f32 v104, v12, v13
    v_cvt_pk_bf16_f32 v105, v14, v15
    v_cvt_pk_bf16_f32 v106, v16, v17
    v_cvt_pk_bf16_f32 v107, v18, v19
    buffer_store_dwordx4 v[104:107], v247, s[20:23], s53 offen offset:32
    v_mul_f32 v20, v20, v2
    v_mul_f32 v21, v21, v2
    v_mul_f32 v22, v22, v2
    v_mul_f32 v23, v23, v2
    v_mul_f32 v24, v24, v2
    v_mul_f32 v25, v25, v2
    v_mul_f32 v26, v26, v2
    v_mul_f32 v27, v27, v2
    v_cvt_pk_bf16_f32 v108, v20, v21
    v_cvt_pk_bf16_f32 v109, v22, v23
    v_cvt_pk_bf16_f32 v110, v24, v25
    v_cvt_pk_bf16_f32 v111, v26, v27
    buffer_store_dwordx4 v[108:111], v247, s[20:23], s53 offen offset:64
    v_mul_f32 v28, v28, v2
    v_mul_f32 v29, v29, v2
    v_mul_f32 v30, v30, v2
    v_mul_f32 v31, v31, v2
    v_mul_f32 v32, v32, v2
    v_mul_f32 v33, v33, v2
    v_mul_f32 v34, v34, v2
    v_mul_f32 v35, v35, v2
    v_cvt_pk_bf16_f32 v112, v28, v29
    v_cvt_pk_bf16_f32 v113, v30, v31
    v_cvt_pk_bf16_f32 v114, v32, v33
    v_cvt_pk_bf16_f32 v115, v34, v35
    buffer_store_dwordx4 v[112:115], v247, s[20:23], s53 offen offset:96
    v_mul_f32 v36, v36, v2
    v_mul_f32 v37, v37, v2
    v_mul_f32 v38, v38, v2
    v_mul_f32 v39, v39, v2
    v_mul_f32 v40, v40, v2
    v_mul_f32 v41, v41, v2
    v_mul_f32 v42, v42, v2
    v_mul_f32 v43, v43, v2
    v_cvt_pk_bf16_f32 v116, v36, v37
    v_cvt_pk_bf16_f32 v117, v38, v39
    v_cvt_pk_bf16_f32 v118, v40, v41
    v_cvt_pk_bf16_f32 v119, v42, v43
    buffer_store_dwordx4 v[116:119], v247, s[20:23], s53 offen offset:128
    v_mul_f32 v44, v44, v2
    v_mul_f32 v45, v45, v2
    v_mul_f32 v46, v46, v2
    v_mul_f32 v47, v47, v2
    v_mul_f32 v48, v48, v2
    v_mul_f32 v49, v49, v2
    v_mul_f32 v50, v50, v2
    v_mul_f32 v51, v51, v2
    v_cvt_pk_bf16_f32 v120, v44, v45
    v_cvt_pk_bf16_f32 v121, v46, v47
    v_cvt_pk_bf16_f32 v122, v48, v49
    v_cvt_pk_bf16_f32 v123, v50, v51
    buffer_store_dwordx4 v[120:123], v247, s[20:23], s53 offen offset:160
    v_mul_f32 v52, v52, v2
    v_mul_f32 v53, v53, v2
    v_mul_f32 v54, v54, v2
    v_mul_f32 v55, v55, v2
    v_mul_f32 v56, v56, v2
    v_mul_f32 v57, v57, v2
    v_mul_f32 v58, v58, v2
    v_mul_f32 v59, v59, v2
    v_cvt_pk_bf16_f32 v124, v52, v53
    v_cvt_pk_bf16_f32 v125, v54, v55
    v_cvt_pk_bf16_f32 v126, v56, v57
    v_cvt_pk_bf16_f32 v127, v58, v59
    buffer_store_dwordx4 v[124:127], v247, s[20:23], s53 offen offset:192
    v_mul_f32 v60, v60, v2
    v_mul_f32 v61, v61, v2
    v_mul_f32 v62, v62, v2
    v_mul_f32 v63, v63, v2
    v_mul_f32 v64, v64, v2
    v_mul_f32 v65, v65, v2
    v_mul_f32 v66, v66, v2
    v_mul_f32 v67, v67, v2
    v_cvt_pk_bf16_f32 v128, v60, v61
    v_cvt_pk_bf16_f32 v129, v62, v63
    v_cvt_pk_bf16_f32 v130, v64, v65
    v_cvt_pk_bf16_f32 v131, v66, v67
    buffer_store_dwordx4 v[128:131], v247, s[20:23], s53 offen offset:224
    v_mov_b32 v4, 0
    v_mov_b32 v5, 0
    v_mov_b32 v6, 0
    v_mov_b32 v7, 0
    v_mov_b32 v8, 0
    v_mov_b32 v9, 0
    v_mov_b32 v10, 0
    v_mov_b32 v11, 0
    v_mov_b32 v12, 0
    v_mov_b32 v13, 0
    v_mov_b32 v14, 0
    v_mov_b32 v15, 0
    v_mov_b32 v16, 0
    v_mov_b32 v17, 0
    v_mov_b32 v18, 0
    v_mov_b32 v19, 0
    v_mov_b32 v20, 0
    v_mov_b32 v21, 0
    v_mov_b32 v22, 0
    v_mov_b32 v23, 0
    v_mov_b32 v24, 0
    v_mov_b32 v25, 0
    v_mov_b32 v26, 0
    v_mov_b32 v27, 0
    v_mov_b32 v28, 0
    v_mov_b32 v29, 0
    v_mov_b32 v30, 0
    v_mov_b32 v31, 0
    v_mov_b32 v32, 0
    v_mov_b32 v33, 0
    v_mov_b32 v34, 0
    v_mov_b32 v35, 0
    v_mov_b32 v36, 0
    v_mov_b32 v37, 0
    v_mov_b32 v38, 0
    v_mov_b32 v39, 0
    v_mov_b32 v40, 0
    v_mov_b32 v41, 0
    v_mov_b32 v42, 0
    v_mov_b32 v43, 0
    v_mov_b32 v44, 0
    v_mov_b32 v45, 0
    v_mov_b32 v46, 0
    v_mov_b32 v47, 0
    v_mov_b32 v48, 0
    v_mov_b32 v49, 0
    v_mov_b32 v50, 0
    v_mov_b32 v51, 0
    v_mov_b32 v52, 0
    v_mov_b32 v53, 0
    v_mov_b32 v54, 0
    v_mov_b32 v55, 0
    v_mov_b32 v56, 0
    v_mov_b32 v57, 0
    v_mov_b32 v58, 0
    v_mov_b32 v59, 0
    v_mov_b32 v60, 0
    v_mov_b32 v61, 0
    v_mov_b32 v62, 0
    v_mov_b32 v63, 0
    v_mov_b32 v64, 0
    v_mov_b32 v65, 0
    v_mov_b32 v66, 0
    v_mov_b32 v67, 0
    s_branch attn_kernel_loop4
attn_kernel_tail6:
    ds_read_b128 v[180:183], v236 offset:0
    ds_read_b128 v[184:187], v236 offset:4096
    ds_read_b128 v[188:191], v236 offset:8192
    ds_read_b128 v[192:195], v236 offset:12288
    ds_read_b128 v[196:199], v237 offset:0
    ds_read_b128 v[200:203], v237 offset:4096
    ds_read_b128 v[204:207], v237 offset:8192
    ds_read_b128 v[208:211], v237 offset:12288
    v_exp_f32 v68, v68
    v_exp_f32 v69, v69
    v_exp_f32 v70, v70
    v_exp_f32 v71, v71
    v_exp_f32 v72, v72
    v_exp_f32 v73, v73
    v_exp_f32 v74, v74
    v_exp_f32 v75, v75
    v_cvt_pk_bf16_f32 v132, v68, v69
    v_cvt_pk_bf16_f32 v133, v70, v71
    v_cvt_pk_bf16_f32 v134, v72, v73
    v_cvt_pk_bf16_f32 v135, v74, v75
    v_add_f32 v250, v250, v68
    v_add_f32 v251, v251, v69
    v_add_f32 v250, v250, v70
    v_add_f32 v251, v251, v71
    v_add_f32 v250, v250, v72
    v_add_f32 v251, v251, v73
    v_add_f32 v250, v250, v74
    v_add_f32 v251, v251, v75
    s_waitcnt lgkmcnt(7)
    v_mfma_f32_32x32x16_bf16 v[4:19], v[180:183], v[132:135], v[4:19]
    ds_read_b128 v[180:183], v238 offset:0
    v_exp_f32 v76, v76
    v_exp_f32 v77, v77
    v_exp_f32 v78, v78
    v_exp_f32 v79, v79
    v_exp_f32 v80, v80
    s_waitcnt lgkmcnt(7)
    v_mfma_f32_32x32x16_bf16 v[20:35], v[184:187], v[132:135], v[20:35]
    ds_read_b128 v[184:187], v238 offset:4096
    v_exp_f32 v81, v81
    v_exp_f32 v82, v82
    v_exp_f32 v83, v83
    v_cvt_pk_bf16_f32 v136, v76, v77
    v_cvt_pk_bf16_f32 v137, v78, v79
    s_waitcnt lgkmcnt(7)
    v_mfma_f32_32x32x16_bf16 v[36:51], v[188:191], v[132:135], v[36:51]
    ds_read_b128 v[188:191], v238 offset:8192
    v_cvt_pk_bf16_f32 v138, v80, v81
    v_cvt_pk_bf16_f32 v139, v82, v83
    v_add_f32 v250, v250, v76
    v_add_f32 v251, v251, v77
    v_add_f32 v250, v250, v78
    s_waitcnt lgkmcnt(7)
    v_mfma_f32_32x32x16_bf16 v[52:67], v[192:195], v[132:135], v[52:67]
    ds_read_b128 v[192:195], v238 offset:12288
    v_add_f32 v251, v251, v79
    v_add_f32 v250, v250, v80
    v_add_f32 v251, v251, v81
    v_add_f32 v250, v250, v82
    v_add_f32 v251, v251, v83
    s_waitcnt lgkmcnt(7)
    v_mfma_f32_32x32x16_bf16 v[4:19], v[196:199], v[136:139], v[4:19]
    ds_read_b128 v[196:199], v239 offset:0
    v_exp_f32 v84, v84
    v_exp_f32 v85, v85
    v_exp_f32 v86, v86
    v_exp_f32 v87, v87
    v_exp_f32 v88, v88
    s_waitcnt lgkmcnt(7)
    v_mfma_f32_32x32x16_bf16 v[20:35], v[200:203], v[136:139], v[20:35]
    ds_read_b128 v[200:203], v239 offset:4096
    v_exp_f32 v89, v89
    v_exp_f32 v90, v90
    v_exp_f32 v91, v91
    v_cvt_pk_bf16_f32 v140, v84, v85
    v_cvt_pk_bf16_f32 v141, v86, v87
    s_waitcnt lgkmcnt(7)
    v_mfma_f32_32x32x16_bf16 v[36:51], v[204:207], v[136:139], v[36:51]
    ds_read_b128 v[204:207], v239 offset:8192
    v_cvt_pk_bf16_f32 v142, v88, v89
    v_cvt_pk_bf16_f32 v143, v90, v91
    v_add_f32 v250, v250, v84
    v_add_f32 v251, v251, v85
    v_add_f32 v250, v250, v86
    s_waitcnt lgkmcnt(7)
    v_mfma_f32_32x32x16_bf16 v[52:67], v[208:211], v[136:139], v[52:67]
    ds_read_b128 v[208:211], v239 offset:12288
    v_add_f32 v251, v251, v87
    v_add_f32 v250, v250, v88
    v_add_f32 v251, v251, v89
    v_add_f32 v250, v250, v90
    v_add_f32 v251, v251, v91
    s_waitcnt lgkmcnt(7)
    v_mfma_f32_32x32x16_bf16 v[4:19], v[180:183], v[140:143], v[4:19]
    v_exp_f32 v92, v92
    v_exp_f32 v93, v93
    v_exp_f32 v94, v94
    v_exp_f32 v95, v95
    v_exp_f32 v96, v96
    s_waitcnt lgkmcnt(6)
    v_mfma_f32_32x32x16_bf16 v[20:35], v[184:187], v[140:143], v[20:35]
    v_exp_f32 v97, v97
    v_exp_f32 v98, v98
    v_exp_f32 v99, v99
    v_cvt_pk_bf16_f32 v144, v92, v93
    v_cvt_pk_bf16_f32 v145, v94, v95
    s_waitcnt lgkmcnt(5)
    v_mfma_f32_32x32x16_bf16 v[36:51], v[188:191], v[140:143], v[36:51]
    v_cvt_pk_bf16_f32 v146, v96, v97
    v_cvt_pk_bf16_f32 v147, v98, v99
    v_add_f32 v250, v250, v92
    v_add_f32 v251, v251, v93
    v_add_f32 v250, v250, v94
    s_waitcnt lgkmcnt(4)
    v_mfma_f32_32x32x16_bf16 v[52:67], v[192:195], v[140:143], v[52:67]
    v_add_f32 v251, v251, v95
    v_add_f32 v250, v250, v96
    v_add_f32 v251, v251, v97
    v_add_f32 v250, v250, v98
    v_add_f32 v251, v251, v99
    s_waitcnt lgkmcnt(3)
    v_mfma_f32_32x32x16_bf16 v[4:19], v[196:199], v[144:147], v[4:19]
    s_waitcnt lgkmcnt(2)
    v_mfma_f32_32x32x16_bf16 v[20:35], v[200:203], v[144:147], v[20:35]
    s_waitcnt lgkmcnt(1)
    v_mfma_f32_32x32x16_bf16 v[36:51], v[204:207], v[144:147], v[36:51]
    s_waitcnt lgkmcnt(0)
    v_mfma_f32_32x32x16_bf16 v[52:67], v[208:211], v[144:147], v[52:67]
    v_add_f32 v253, v250, v251
    v_mov_b32 v244, v253
    v_mov_b32 v252, v242
    s_nop 0
    v_permlane32_swap_b32 v244, v253
    s_nop 1
    v_add_f32 v253, v253, v244
    s_lshl_b32 s53, s44, 13
    s_add_u32 s53, s53, 98304
    v_lshlrev_b32 v212, 4, v1
    v_add_u32 v212, s53, v212
    s_lshl_b32 s53, s44, 9
    s_add_u32 s53, s53, 32768
    v_lshlrev_b32 v213, 3, v1
    v_add_u32 v213, s53, v213
    ds_write_b64 v213, v[252:253]
    s_cmp_eq_u32 s51, 0
    s_cbranch_scc1 attn_kernel_L28
    ds_write_b128 v212, v[4:7] offset:0
    ds_write_b128 v212, v[8:11] offset:1024
    ds_write_b128 v212, v[12:15] offset:2048
    ds_write_b128 v212, v[16:19] offset:3072
    ds_write_b128 v212, v[20:23] offset:4096
    ds_write_b128 v212, v[24:27] offset:5120
    ds_write_b128 v212, v[28:31] offset:6144
    ds_write_b128 v212, v[32:35] offset:7168
    s_nop 1
    v_mov_b32 v4, v36
    v_mov_b32 v5, v37
    v_mov_b32 v6, v38
    v_mov_b32 v7, v39
    v_mov_b32 v8, v40
    v_mov_b32 v9, v41
    v_mov_b32 v10, v42
    v_mov_b32 v11, v43
    v_mov_b32 v12, v44
    v_mov_b32 v13, v45
    v_mov_b32 v14, v46
    v_mov_b32 v15, v47
    v_mov_b32 v16, v48
    v_mov_b32 v17, v49
    v_mov_b32 v18, v50
    v_mov_b32 v19, v51
    v_mov_b32 v20, v52
    v_mov_b32 v21, v53
    v_mov_b32 v22, v54
    v_mov_b32 v23, v55
    v_mov_b32 v24, v56
    v_mov_b32 v25, v57
    v_mov_b32 v26, v58
    v_mov_b32 v27, v59
    v_mov_b32 v28, v60
    v_mov_b32 v29, v61
    v_mov_b32 v30, v62
    v_mov_b32 v31, v63
    v_mov_b32 v32, v64
    v_mov_b32 v33, v65
    v_mov_b32 v34, v66
    v_mov_b32 v35, v67
    s_branch attn_kernel_L29
attn_kernel_L28:
    ds_write_b128 v212, v[36:39] offset:0
    ds_write_b128 v212, v[40:43] offset:1024
    ds_write_b128 v212, v[44:47] offset:2048
    ds_write_b128 v212, v[48:51] offset:3072
    ds_write_b128 v212, v[52:55] offset:4096
    ds_write_b128 v212, v[56:59] offset:5120
    ds_write_b128 v212, v[60:63] offset:6144
    ds_write_b128 v212, v[64:67] offset:7168
attn_kernel_L29:
    v_xor_b32 v212, 0x38000, v212
    v_xor_b32 v213, 0x800, v213
    s_waitcnt lgkmcnt(0)
    s_barrier
    ds_read_b64 v[250:251], v213
    ds_read_b128 v[68:71], v212 offset:0
    ds_read_b128 v[72:75], v212 offset:1024
    ds_read_b128 v[76:79], v212 offset:2048
    ds_read_b128 v[80:83], v212 offset:3072
    ds_read_b128 v[84:87], v212 offset:4096
    ds_read_b128 v[88:91], v212 offset:5120
    ds_read_b128 v[92:95], v212 offset:6144
    ds_read_b128 v[96:99], v212 offset:7168
    s_lshl_b32 s48, s44, 13
    s_add_u32 s48, s48, 98304
    s_xor_b32 s48, s48, 0x38000
    v_lshrrev_b32 v42, 5, v1
    v_and_b32 v43, 7, v1
    v_xor_b32 v42, v42, v43
    v_lshlrev_b32 v42, 4, v42
    v_and_b32 v40, 31, v1
    v_lshl_add_u32 v42, v40, 7, v42
    v_add_u32 v42, s48, v42
    v_xor_b32 v36, 0, v42
    v_xor_b32 v37, 32, v42
    v_xor_b32 v38, 64, v42
    v_xor_b32 v39, 96, v42
    v_lshrrev_b32 v42, 3, v1
    v_xor_b32 v40, v42, v43
    v_lshlrev_b32 v40, 4, v40
    v_lshl_add_u32 v40, v42, 7, v40
    v_add_u32 v40, s48, v40
    s_lshl_b32 s48, s52, 5
    v_add_u32 v41, s48, v42
    v_lshlrev_b32 v41, 13, v41
    v_lshl_add_u32 v41, v43, 4, v41
    s_waitcnt lgkmcnt(8)
    v_max_f32 v243, v252, v250
    v_sub_f32 v2, v252, v243
    v_sub_f32 v214, v250, v243
    v_exp_f32 v2, v2
    v_exp_f32 v214, v214
    s_nop 0
    v_mul_f32 v244, v2, v253
    v_fmac_f32 v244, v214, v251
    v_rcp_f32 v244, v244
    s_nop 0
    v_mul_f32 v2, v2, v244
    v_mul_f32 v214, v214, v244
    v_mov_b32 v3, v2
    v_mov_b32 v215, v214
    s_lshl_b32 s53, s46, 20
    s_add_u32 s53, s53, s55
    s_lshl_b32 s48, s51, 7
    s_add_u32 s53, s53, s48
    s_waitcnt lgkmcnt(0)
    v_pk_mul_f32 v[4:5], v[4:5], v[2:3]
    v_pk_fma_f32 v[4:5], v[68:69], v[214:215], v[4:5]
    v_cvt_pk_bf16_f32 v132, v4, v5
    v_pk_mul_f32 v[6:7], v[6:7], v[2:3]
    v_pk_fma_f32 v[6:7], v[70:71], v[214:215], v[6:7]
    v_cvt_pk_bf16_f32 v133, v6, v7
    v_pk_mul_f32 v[8:9], v[8:9], v[2:3]
    v_pk_fma_f32 v[8:9], v[72:73], v[214:215], v[8:9]
    v_cvt_pk_bf16_f32 v134, v8, v9
    v_pk_mul_f32 v[10:11], v[10:11], v[2:3]
    v_pk_fma_f32 v[10:11], v[74:75], v[214:215], v[10:11]
    v_cvt_pk_bf16_f32 v135, v10, v11
    ds_write_b128 v36, v[132:135]
    v_pk_mul_f32 v[12:13], v[12:13], v[2:3]
    v_pk_fma_f32 v[12:13], v[76:77], v[214:215], v[12:13]
    v_cvt_pk_bf16_f32 v136, v12, v13
    v_pk_mul_f32 v[14:15], v[14:15], v[2:3]
    v_pk_fma_f32 v[14:15], v[78:79], v[214:215], v[14:15]
    v_cvt_pk_bf16_f32 v137, v14, v15
    v_pk_mul_f32 v[16:17], v[16:17], v[2:3]
    v_pk_fma_f32 v[16:17], v[80:81], v[214:215], v[16:17]
    v_cvt_pk_bf16_f32 v138, v16, v17
    v_pk_mul_f32 v[18:19], v[18:19], v[2:3]
    v_pk_fma_f32 v[18:19], v[82:83], v[214:215], v[18:19]
    v_cvt_pk_bf16_f32 v139, v18, v19
    ds_write_b128 v37, v[136:139]
    v_pk_mul_f32 v[20:21], v[20:21], v[2:3]
    v_pk_fma_f32 v[20:21], v[84:85], v[214:215], v[20:21]
    v_cvt_pk_bf16_f32 v140, v20, v21
    v_pk_mul_f32 v[22:23], v[22:23], v[2:3]
    v_pk_fma_f32 v[22:23], v[86:87], v[214:215], v[22:23]
    v_cvt_pk_bf16_f32 v141, v22, v23
    v_pk_mul_f32 v[24:25], v[24:25], v[2:3]
    v_pk_fma_f32 v[24:25], v[88:89], v[214:215], v[24:25]
    v_cvt_pk_bf16_f32 v142, v24, v25
    v_pk_mul_f32 v[26:27], v[26:27], v[2:3]
    v_pk_fma_f32 v[26:27], v[90:91], v[214:215], v[26:27]
    v_cvt_pk_bf16_f32 v143, v26, v27
    ds_write_b128 v38, v[140:143]
    v_pk_mul_f32 v[28:29], v[28:29], v[2:3]
    v_pk_fma_f32 v[28:29], v[92:93], v[214:215], v[28:29]
    v_cvt_pk_bf16_f32 v144, v28, v29
    v_pk_mul_f32 v[30:31], v[30:31], v[2:3]
    v_pk_fma_f32 v[30:31], v[94:95], v[214:215], v[30:31]
    v_cvt_pk_bf16_f32 v145, v30, v31
    v_pk_mul_f32 v[32:33], v[32:33], v[2:3]
    v_pk_fma_f32 v[32:33], v[96:97], v[214:215], v[32:33]
    v_cvt_pk_bf16_f32 v146, v32, v33
    v_pk_mul_f32 v[34:35], v[34:35], v[2:3]
    v_pk_fma_f32 v[34:35], v[98:99], v[214:215], v[34:35]
    v_cvt_pk_bf16_f32 v147, v34, v35
    ds_write_b128 v39, v[144:147]
    ds_read_b128 v[44:47], v40 offset:0
    ds_read_b128 v[48:51], v40 offset:1024
    ds_read_b128 v[52:55], v40 offset:2048
    ds_read_b128 v[56:59], v40 offset:3072
    s_waitcnt lgkmcnt(3)
    buffer_store_dwordx4 v[44:47], v41, s[20:23], s53 offen sc1
    s_add_u32 s53, s53, 65536
    s_waitcnt lgkmcnt(2)
    buffer_store_dwordx4 v[48:51], v41, s[20:23], s53 offen sc1
    s_add_u32 s53, s53, 65536
    s_waitcnt lgkmcnt(1)
    buffer_store_dwordx4 v[52:55], v41, s[20:23], s53 offen sc1
    s_add_u32 s53, s53, 65536
    s_waitcnt lgkmcnt(0)
    buffer_store_dwordx4 v[56:59], v41, s[20:23], s53 offen sc1
    s_add_u32 s53, s53, 65536
    s_endpgm
.globl op_kernel
.p2align 8
.type op_kernel,@function
op_kernel:
    s_cmp_lt_u32 s2, 256
    s_cbranch_scc1 op_kernel_L1
    s_endpgm
op_kernel_L1:
    s_load_dwordx2 s[4:5], s[0:1], 112
    s_load_dwordx2 s[8:9], s[0:1], 40
    s_load_dwordx2 s[12:13], s[0:1], 112
    v_lshrrev_b32 v1, 6, v0
    s_nop 0
    v_readfirstlane_b32 s16, v1
    v_and_b32 v1, 63, v0
    s_waitcnt lgkmcnt(0)
    s_add_u32 s4, s4, 0x2400000
    s_addc_u32 s5, s5, 0
    s_and_b32 s5, s5, 0xffff
    s_mov_b32 s6, 0x1000000
    s_mov_b32 s7, 0x20000
    s_and_b32 s9, s9, 0xffff
    s_mov_b32 s10, 0x400000
    s_mov_b32 s11, 0x20000
    s_add_u32 s12, s12, 0x400000
    s_addc_u32 s13, s13, 0
    s_and_b32 s13, s13, 0xffff
    s_mov_b32 s14, 0x800000
    s_mov_b32 s15, 0x20000
    s_lshl_b32 s17, s16, 10
    s_lshr_b32 s18, s16, 1
    s_and_b32 s19, s16, 1
    s_lshl_b32 s20, s16, 2
    v_lshrrev_b32 v2, 4, v1
    v_add_u32 v2, s20, v2
    v_xor_b32 v2, v2, v1
    v_and_b32 v2, 7, v2
    v_lshlrev_b32 v2, 4, v2
    s_lshl_b32 s20, s16, 3
    v_lshrrev_b32 v3, 3, v1
    v_add_u32 v3, s20, v3
    s_mov_b32 s20, 8192
    v_mul_lo_u32 v3, v3, s20
    v_add_u32 v5, v2, v3
    v_add_u32 v8, 786432, v5
    v_add_u32 v7, 524288, v5
    v_add_u32 v6, 262144, v5
    v_lshrrev_b32 v3, 4, v1
    v_lshlrev_b32 v2, 2, v3
    v_xor_b32 v2, v2, v1
    v_and_b32 v2, 15, v2
    v_lshlrev_b32 v2, 4, v2
    s_mul_i32 s20, s16, 4
    v_add_u32 v3, s20, v3
    s_mov_b32 s20, 1024
    v_mul_lo_u32 v3, v3, s20
    v_add_u32 v9, v2, v3
    v_add_u32 v12, 49152, v9
    v_add_u32 v11, 32768, v9
    v_add_u32 v10, 16384, v9
    v_lshrrev_b32 v2, 5, v1
    v_bfe_u32 v3, v1, 1, 3
    v_xor_b32 v2, v2, v3
    v_lshlrev_b32 v2, 4, v2
    v_and_b32 v3, 31, v1
    v_lshl_add_u32 v2, v3, 7, v2
    s_mul_i32 s20, s18, 8192
    v_add_u32 v2, s20, v2
    v_xor_b32 v13, 0, v2
    v_xor_b32 v14, 32, v2
    v_xor_b32 v15, 64, v2
    v_xor_b32 v16, 96, v2
    v_xor_b32 v17, 0, v2
    v_add_u32 v17, 65536, v17
    v_xor_b32 v18, 32, v2
    v_add_u32 v18, 65536, v18
    v_xor_b32 v19, 64, v2
    v_add_u32 v19, 65536, v19
    v_xor_b32 v20, 96, v2
    v_add_u32 v20, 65536, v20
    v_lshrrev_b32 v2, 5, v1
    v_lshlrev_b32 v2, 2, v2
    v_bfe_u32 v3, v1, 2, 2
    v_add_u32 v2, v2, v3
    v_mul_u32_u24 v2, 256, v2
    v_bfe_u32 v4, v1, 4, 1
    v_lshl_add_u32 v2, v4, 5, v2
    v_and_b32 v4, 3, v1
    v_lshl_add_u32 v2, v4, 3, v2
    s_mul_i32 s20, s19, 2
    s_add_u32 s20, s20, 0
    s_and_b32 s21, s20, 3
    v_xor_b32 v4, s21, v3
    v_lshl_add_u32 v4, v4, 6, v2
    s_lshr_b32 s20, s20, 2
    s_mul_i32 s20, s20, 16384
    v_add_u32 v21, s20, v4
    v_add_u32 v23, s20, v4
    v_add_u32 v23, 65536, v23
    s_mul_i32 s20, s19, 2
    s_add_u32 s20, s20, 1
    s_and_b32 s21, s20, 3
    v_xor_b32 v4, s21, v3
    v_lshl_add_u32 v4, v4, 6, v2
    s_lshr_b32 s20, s20, 2
    s_mul_i32 s20, s20, 16384
    v_add_u32 v22, s20, v4
    v_add_u32 v24, s20, v4
    v_add_u32 v24, 65536, v24
    s_lshr_b32 s24, s2, 3
    s_mov_b32 s24, 0
    s_and_b32 s24, s24, 15
    s_bfe_u32 s25, s2, 0x20001
    s_and_b32 s26, s2, 1
    s_lshl_b32 s26, s26, 3
    s_bfe_u32 s31, s2, 0x30003
    s_add_u32 s26, s26, s31
    s_lshr_b32 s27, s2, 6
    s_lshl_b32 s28, s26, 20
    s_lshl_b32 s31, s25, 11
    s_add_u32 s28, s28, s31
    s_lshl_b32 s29, s25, 20
    s_lshl_b32 s31, s27, 8
    s_add_u32 s29, s29, s31
    s_lshl_b32 s22, s24, 7
    s_add_u32 s22, s22, s28
    s_add_u32 m0, s17, 0
    s_nop 0
    buffer_load_dwordx4 v5, s[4:7], s22 offen lds
    s_add_u32 m0, s17, 4096
    s_nop 0
    buffer_load_dwordx4 v6, s[4:7], s22 offen lds
    s_add_u32 m0, s17, 8192
    s_nop 0
    buffer_load_dwordx4 v7, s[4:7], s22 offen lds
    s_add_u32 m0, s17, 12288
    s_nop 0
    buffer_load_dwordx4 v8, s[4:7], s22 offen lds
    s_mul_i32 s23, s24, 65536
    s_add_u32 s23, s23, s29
    s_add_u32 s24, s24, 1
    s_cmp_eq_u32 s24, 16
    s_cselect_b32 s24, 0, s24
    s_add_u32 m0, s17, 16384
    s_nop 0
    buffer_load_dwordx4 v9, s[8:11], s23 offen lds
    s_add_u32 m0, s17, 20480
    s_nop 0
    buffer_load_dwordx4 v10, s[8:11], s23 offen lds
    s_add_u32 m0, s17, 24576
    s_nop 0
    buffer_load_dwordx4 v11, s[8:11], s23 offen lds
    s_add_u32 m0, s17, 28672
    s_nop 0
    buffer_load_dwordx4 v12, s[8:11], s23 offen lds
    s_lshl_b32 s22, s24, 7
    s_add_u32 s22, s22, s28
    s_add_u32 m0, s17, 32768
    s_nop 0
    buffer_load_dwordx4 v5, s[4:7], s22 offen lds
    s_add_u32 m0, s17, 36864
    s_nop 0
    buffer_load_dwordx4 v6, s[4:7], s22 offen lds
    s_add_u32 m0, s17, 40960
    s_nop 0
    buffer_load_dwordx4 v7, s[4:7], s22 offen lds
    s_add_u32 m0, s17, 45056
    s_nop 0
    buffer_load_dwordx4 v8, s[4:7], s22 offen lds
    s_mul_i32 s23, s24, 65536
    s_add_u32 s23, s23, s29
    s_add_u32 s24, s24, 1
    s_cmp_eq_u32 s24, 16
    s_cselect_b32 s24, 0, s24
    s_add_u32 m0, s17, 49152
    s_nop 0
    buffer_load_dwordx4 v9, s[8:11], s23 offen lds
    s_add_u32 m0, s17, 53248
    s_nop 0
    buffer_load_dwordx4 v10, s[8:11], s23 offen lds
    s_add_u32 m0, s17, 57344
    s_nop 0
    buffer_load_dwordx4 v11, s[8:11], s23 offen lds
    s_add_u32 m0, s17, 61440
    s_nop 0
    buffer_load_dwordx4 v12, s[8:11], s23 offen lds
    s_lshl_b32 s22, s24, 7
    s_add_u32 s22, s22, s28
    s_add_u32 m0, s17, 65536
    s_nop 0
    buffer_load_dwordx4 v5, s[4:7], s22 offen lds
    s_add_u32 m0, s17, 69632
    s_nop 0
    buffer_load_dwordx4 v6, s[4:7], s22 offen lds
    s_add_u32 m0, s17, 73728
    s_nop 0
    buffer_load_dwordx4 v7, s[4:7], s22 offen lds
    s_add_u32 m0, s17, 77824
    s_nop 0
    buffer_load_dwordx4 v8, s[4:7], s22 offen lds
    s_mul_i32 s23, s24, 65536
    s_add_u32 s23, s23, s29
    s_add_u32 s24, s24, 1
    s_cmp_eq_u32 s24, 16
    s_cselect_b32 s24, 0, s24
    s_add_u32 m0, s17, 81920
    s_nop 0
    buffer_load_dwordx4 v9, s[8:11], s23 offen lds
    s_add_u32 m0, s17, 86016
    s_nop 0
    buffer_load_dwordx4 v10, s[8:11], s23 offen lds
    s_add_u32 m0, s17, 90112
    s_nop 0
    buffer_load_dwordx4 v11, s[8:11], s23 offen lds
    s_add_u32 m0, s17, 94208
    s_nop 0
    buffer_load_dwordx4 v12, s[8:11], s23 offen lds
    s_waitcnt vmcnt(16)
    s_barrier
    ds_read_b128 v[26:29], v13 offset:0
    ds_read_b64_tr_b16 v[34:35], v21 offset:16384
    ds_read_b64_tr_b16 v[36:37], v21 offset:18432
    ds_read_b128 v[30:33], v13 offset:4096
    ds_read_b64_tr_b16 v[38:39], v22 offset:16384
    ds_read_b64_tr_b16 v[40:41], v22 offset:18432
    ds_read_b128 v[42:45], v14 offset:0
    ds_read_b64_tr_b16 v[50:51], v21 offset:20480
    ds_read_b64_tr_b16 v[52:53], v21 offset:22528
    ds_read_b128 v[46:49], v14 offset:4096
    ds_read_b64_tr_b16 v[54:55], v22 offset:20480
    ds_read_b64_tr_b16 v[56:57], v22 offset:22528
    s_waitcnt lgkmcnt(9)
    v_mfma_f32_32x32x16_bf16 v[92:107], v[34:37], v[26:29], 0
    ds_read_b128 v[58:61], v15 offset:0
    ds_read_b64_tr_b16 v[66:67], v21 offset:24576
    s_waitcnt lgkmcnt(8)
    v_mfma_f32_32x32x16_bf16 v[108:123], v[38:41], v[26:29], 0
    ds_read_b64_tr_b16 v[68:69], v21 offset:26624
    ds_read_b128 v[62:65], v15 offset:4096
    v_mfma_f32_32x32x16_bf16 v[124:139], v[34:37], v[30:33], 0
    ds_read_b64_tr_b16 v[70:71], v22 offset:24576
    ds_read_b64_tr_b16 v[72:73], v22 offset:26624
    v_mfma_f32_32x32x16_bf16 v[140:155], v[38:41], v[30:33], 0
    ds_read_b128 v[74:77], v16 offset:0
    ds_read_b64_tr_b16 v[82:83], v21 offset:28672
    s_waitcnt lgkmcnt(11)
    v_mfma_f32_32x32x16_bf16 v[92:107], v[50:53], v[42:45], v[92:107]
    ds_read_b64_tr_b16 v[84:85], v21 offset:30720
    ds_read_b128 v[78:81], v16 offset:4096
    s_waitcnt lgkmcnt(10)
    v_mfma_f32_32x32x16_bf16 v[108:123], v[54:57], v[42:45], v[108:123]
    ds_read_b64_tr_b16 v[86:87], v22 offset:28672
    ds_read_b64_tr_b16 v[88:89], v22 offset:30720
    v_mfma_f32_32x32x16_bf16 v[124:139], v[50:53], v[46:49], v[124:139]
    v_mfma_f32_32x32x16_bf16 v[140:155], v[54:57], v[46:49], v[140:155]
    s_waitcnt lgkmcnt(0)
    s_waitcnt vmcnt(8)
    s_barrier
    ds_read_b128 v[26:29], v13 offset:32768
    ds_read_b64_tr_b16 v[34:35], v21 offset:49152
    ds_read_b64_tr_b16 v[36:37], v21 offset:51200
    ds_read_b128 v[30:33], v13 offset:36864
    ds_read_b64_tr_b16 v[38:39], v22 offset:49152
    ds_read_b64_tr_b16 v[40:41], v22 offset:51200
    ds_read_b128 v[42:45], v14 offset:32768
    ds_read_b64_tr_b16 v[50:51], v21 offset:53248
    ds_read_b64_tr_b16 v[52:53], v21 offset:55296
    ds_read_b128 v[46:49], v14 offset:36864
    ds_read_b64_tr_b16 v[54:55], v22 offset:53248
    ds_read_b64_tr_b16 v[56:57], v22 offset:55296
    v_mfma_f32_32x32x16_bf16 v[92:107], v[66:69], v[58:61], v[92:107]
    s_lshl_b32 s22, s24, 7
    s_add_u32 s22, s22, s28
    s_add_u32 m0, s17, 0
    s_nop 0
    buffer_load_dwordx4 v5, s[4:7], s22 offen lds
    v_mfma_f32_32x32x16_bf16 v[108:123], v[70:73], v[58:61], v[108:123]
    s_add_u32 m0, s17, 4096
    s_nop 0
    buffer_load_dwordx4 v6, s[4:7], s22 offen lds
    v_mfma_f32_32x32x16_bf16 v[124:139], v[66:69], v[62:65], v[124:139]
    s_add_u32 m0, s17, 8192
    s_nop 0
    buffer_load_dwordx4 v7, s[4:7], s22 offen lds
    v_mfma_f32_32x32x16_bf16 v[140:155], v[70:73], v[62:65], v[140:155]
    s_add_u32 m0, s17, 12288
    s_nop 0
    buffer_load_dwordx4 v8, s[4:7], s22 offen lds
    v_mfma_f32_32x32x16_bf16 v[92:107], v[82:85], v[74:77], v[92:107]
    s_mul_i32 s23, s24, 65536
    s_add_u32 s23, s23, s29
    s_add_u32 s24, s24, 1
    s_cmp_eq_u32 s24, 16
    s_cselect_b32 s24, 0, s24
    s_add_u32 m0, s17, 16384
    s_nop 0
    buffer_load_dwordx4 v9, s[8:11], s23 offen lds
    v_mfma_f32_32x32x16_bf16 v[108:123], v[86:89], v[74:77], v[108:123]
    s_add_u32 m0, s17, 20480
    s_nop 0
    buffer_load_dwordx4 v10, s[8:11], s23 offen lds
    v_mfma_f32_32x32x16_bf16 v[124:139], v[82:85], v[78:81], v[124:139]
    s_add_u32 m0, s17, 24576
    s_nop 0
    buffer_load_dwordx4 v11, s[8:11], s23 offen lds
    v_mfma_f32_32x32x16_bf16 v[140:155], v[86:89], v[78:81], v[140:155]
    s_add_u32 m0, s17, 28672
    s_nop 0
    buffer_load_dwordx4 v12, s[8:11], s23 offen lds
    s_waitcnt lgkmcnt(9)
    v_mfma_f32_32x32x16_bf16 v[92:107], v[34:37], v[26:29], v[92:107]
    ds_read_b128 v[58:61], v15 offset:32768
    ds_read_b64_tr_b16 v[66:67], v21 offset:57344
    s_waitcnt lgkmcnt(8)
    v_mfma_f32_32x32x16_bf16 v[108:123], v[38:41], v[26:29], v[108:123]
    ds_read_b64_tr_b16 v[68:69], v21 offset:59392
    ds_read_b128 v[62:65], v15 offset:36864
    v_mfma_f32_32x32x16_bf16 v[124:139], v[34:37], v[30:33], v[124:139]
    ds_read_b64_tr_b16 v[70:71], v22 offset:57344
    ds_read_b64_tr_b16 v[72:73], v22 offset:59392
    v_mfma_f32_32x32x16_bf16 v[140:155], v[38:41], v[30:33], v[140:155]
    ds_read_b128 v[74:77], v16 offset:32768
    ds_read_b64_tr_b16 v[82:83], v21 offset:61440
    s_waitcnt lgkmcnt(11)
    v_mfma_f32_32x32x16_bf16 v[92:107], v[50:53], v[42:45], v[92:107]
    ds_read_b64_tr_b16 v[84:85], v21 offset:63488
    ds_read_b128 v[78:81], v16 offset:36864
    s_waitcnt lgkmcnt(10)
    v_mfma_f32_32x32x16_bf16 v[108:123], v[54:57], v[42:45], v[108:123]
    ds_read_b64_tr_b16 v[86:87], v22 offset:61440
    ds_read_b64_tr_b16 v[88:89], v22 offset:63488
    v_mfma_f32_32x32x16_bf16 v[124:139], v[50:53], v[46:49], v[124:139]
    v_mfma_f32_32x32x16_bf16 v[140:155], v[54:57], v[46:49], v[140:155]
    s_waitcnt lgkmcnt(0)
    s_waitcnt vmcnt(8)
    s_barrier
    ds_read_b128 v[26:29], v17 offset:0
    ds_read_b64_tr_b16 v[34:35], v23 offset:16384
    ds_read_b64_tr_b16 v[36:37], v23 offset:18432
    ds_read_b128 v[30:33], v17 offset:4096
    ds_read_b64_tr_b16 v[38:39], v24 offset:16384
    ds_read_b64_tr_b16 v[40:41], v24 offset:18432
    ds_read_b128 v[42:45], v18 offset:0
    ds_read_b64_tr_b16 v[50:51], v23 offset:20480
    ds_read_b64_tr_b16 v[52:53], v23 offset:22528
    ds_read_b128 v[46:49], v18 offset:4096
    ds_read_b64_tr_b16 v[54:55], v24 offset:20480
    ds_read_b64_tr_b16 v[56:57], v24 offset:22528
    v_mfma_f32_32x32x16_bf16 v[92:107], v[66:69], v[58:61], v[92:107]
    s_lshl_b32 s22, s24, 7
    s_add_u32 s22, s22, s28
    s_add_u32 m0, s17, 32768
    s_nop 0
    buffer_load_dwordx4 v5, s[4:7], s22 offen lds
    v_mfma_f32_32x32x16_bf16 v[108:123], v[70:73], v[58:61], v[108:123]
    s_add_u32 m0, s17, 36864
    s_nop 0
    buffer_load_dwordx4 v6, s[4:7], s22 offen lds
    v_mfma_f32_32x32x16_bf16 v[124:139], v[66:69], v[62:65], v[124:139]
    s_add_u32 m0, s17, 40960
    s_nop 0
    buffer_load_dwordx4 v7, s[4:7], s22 offen lds
    v_mfma_f32_32x32x16_bf16 v[140:155], v[70:73], v[62:65], v[140:155]
    s_add_u32 m0, s17, 45056
    s_nop 0
    buffer_load_dwordx4 v8, s[4:7], s22 offen lds
    v_mfma_f32_32x32x16_bf16 v[92:107], v[82:85], v[74:77], v[92:107]
    s_mul_i32 s23, s24, 65536
    s_add_u32 s23, s23, s29
    s_add_u32 s24, s24, 1
    s_cmp_eq_u32 s24, 16
    s_cselect_b32 s24, 0, s24
    s_add_u32 m0, s17, 49152
    s_nop 0
    buffer_load_dwordx4 v9, s[8:11], s23 offen lds
    v_mfma_f32_32x32x16_bf16 v[108:123], v[86:89], v[74:77], v[108:123]
    s_add_u32 m0, s17, 53248
    s_nop 0
    buffer_load_dwordx4 v10, s[8:11], s23 offen lds
    v_mfma_f32_32x32x16_bf16 v[124:139], v[82:85], v[78:81], v[124:139]
    s_add_u32 m0, s17, 57344
    s_nop 0
    buffer_load_dwordx4 v11, s[8:11], s23 offen lds
    v_mfma_f32_32x32x16_bf16 v[140:155], v[86:89], v[78:81], v[140:155]
    s_add_u32 m0, s17, 61440
    s_nop 0
    buffer_load_dwordx4 v12, s[8:11], s23 offen lds
    s_waitcnt lgkmcnt(9)
    v_mfma_f32_32x32x16_bf16 v[92:107], v[34:37], v[26:29], v[92:107]
    ds_read_b128 v[58:61], v19 offset:0
    ds_read_b64_tr_b16 v[66:67], v23 offset:24576
    s_waitcnt lgkmcnt(8)
    v_mfma_f32_32x32x16_bf16 v[108:123], v[38:41], v[26:29], v[108:123]
    ds_read_b64_tr_b16 v[68:69], v23 offset:26624
    ds_read_b128 v[62:65], v19 offset:4096
    v_mfma_f32_32x32x16_bf16 v[124:139], v[34:37], v[30:33], v[124:139]
    ds_read_b64_tr_b16 v[70:71], v24 offset:24576
    ds_read_b64_tr_b16 v[72:73], v24 offset:26624
    v_mfma_f32_32x32x16_bf16 v[140:155], v[38:41], v[30:33], v[140:155]
    ds_read_b128 v[74:77], v20 offset:0
    ds_read_b64_tr_b16 v[82:83], v23 offset:28672
    s_waitcnt lgkmcnt(11)
    v_mfma_f32_32x32x16_bf16 v[92:107], v[50:53], v[42:45], v[92:107]
    ds_read_b64_tr_b16 v[84:85], v23 offset:30720
    ds_read_b128 v[78:81], v20 offset:4096
    s_waitcnt lgkmcnt(10)
    v_mfma_f32_32x32x16_bf16 v[108:123], v[54:57], v[42:45], v[108:123]
    ds_read_b64_tr_b16 v[86:87], v24 offset:28672
    ds_read_b64_tr_b16 v[88:89], v24 offset:30720
    v_mfma_f32_32x32x16_bf16 v[124:139], v[50:53], v[46:49], v[124:139]
    v_mfma_f32_32x32x16_bf16 v[140:155], v[54:57], v[46:49], v[140:155]
    s_waitcnt lgkmcnt(0)
    s_waitcnt vmcnt(8)
    s_barrier
    ds_read_b128 v[26:29], v13 offset:0
    ds_read_b64_tr_b16 v[34:35], v21 offset:16384
    ds_read_b64_tr_b16 v[36:37], v21 offset:18432
    ds_read_b128 v[30:33], v13 offset:4096
    ds_read_b64_tr_b16 v[38:39], v22 offset:16384
    ds_read_b64_tr_b16 v[40:41], v22 offset:18432
    ds_read_b128 v[42:45], v14 offset:0
    ds_read_b64_tr_b16 v[50:51], v21 offset:20480
    ds_read_b64_tr_b16 v[52:53], v21 offset:22528
    ds_read_b128 v[46:49], v14 offset:4096
    ds_read_b64_tr_b16 v[54:55], v22 offset:20480
    ds_read_b64_tr_b16 v[56:57], v22 offset:22528
    v_mfma_f32_32x32x16_bf16 v[92:107], v[66:69], v[58:61], v[92:107]
    s_lshl_b32 s22, s24, 7
    s_add_u32 s22, s22, s28
    s_add_u32 m0, s17, 65536
    s_nop 0
    buffer_load_dwordx4 v5, s[4:7], s22 offen lds
    v_mfma_f32_32x32x16_bf16 v[108:123], v[70:73], v[58:61], v[108:123]
    s_add_u32 m0, s17, 69632
    s_nop 0
    buffer_load_dwordx4 v6, s[4:7], s22 offen lds
    v_mfma_f32_32x32x16_bf16 v[124:139], v[66:69], v[62:65], v[124:139]
    s_add_u32 m0, s17, 73728
    s_nop 0
    buffer_load_dwordx4 v7, s[4:7], s22 offen lds
    v_mfma_f32_32x32x16_bf16 v[140:155], v[70:73], v[62:65], v[140:155]
    s_add_u32 m0, s17, 77824
    s_nop 0
    buffer_load_dwordx4 v8, s[4:7], s22 offen lds
    v_mfma_f32_32x32x16_bf16 v[92:107], v[82:85], v[74:77], v[92:107]
    s_mul_i32 s23, s24, 65536
    s_add_u32 s23, s23, s29
    s_add_u32 s24, s24, 1
    s_cmp_eq_u32 s24, 16
    s_cselect_b32 s24, 0, s24
    s_add_u32 m0, s17, 81920
    s_nop 0
    buffer_load_dwordx4 v9, s[8:11], s23 offen lds
    v_mfma_f32_32x32x16_bf16 v[108:123], v[86:89], v[74:77], v[108:123]
    s_add_u32 m0, s17, 86016
    s_nop 0
    buffer_load_dwordx4 v10, s[8:11], s23 offen lds
    v_mfma_f32_32x32x16_bf16 v[124:139], v[82:85], v[78:81], v[124:139]
    s_add_u32 m0, s17, 90112
    s_nop 0
    buffer_load_dwordx4 v11, s[8:11], s23 offen lds
    v_mfma_f32_32x32x16_bf16 v[140:155], v[86:89], v[78:81], v[140:155]
    s_add_u32 m0, s17, 94208
    s_nop 0
    buffer_load_dwordx4 v12, s[8:11], s23 offen lds
    s_waitcnt lgkmcnt(9)
    v_mfma_f32_32x32x16_bf16 v[92:107], v[34:37], v[26:29], v[92:107]
    ds_read_b128 v[58:61], v15 offset:0
    ds_read_b64_tr_b16 v[66:67], v21 offset:24576
    s_waitcnt lgkmcnt(8)
    v_mfma_f32_32x32x16_bf16 v[108:123], v[38:41], v[26:29], v[108:123]
    ds_read_b64_tr_b16 v[68:69], v21 offset:26624
    ds_read_b128 v[62:65], v15 offset:4096
    v_mfma_f32_32x32x16_bf16 v[124:139], v[34:37], v[30:33], v[124:139]
    ds_read_b64_tr_b16 v[70:71], v22 offset:24576
    ds_read_b64_tr_b16 v[72:73], v22 offset:26624
    v_mfma_f32_32x32x16_bf16 v[140:155], v[38:41], v[30:33], v[140:155]
    ds_read_b128 v[74:77], v16 offset:0
    ds_read_b64_tr_b16 v[82:83], v21 offset:28672
    s_waitcnt lgkmcnt(11)
    v_mfma_f32_32x32x16_bf16 v[92:107], v[50:53], v[42:45], v[92:107]
    ds_read_b64_tr_b16 v[84:85], v21 offset:30720
    ds_read_b128 v[78:81], v16 offset:4096
    s_waitcnt lgkmcnt(10)
    v_mfma_f32_32x32x16_bf16 v[108:123], v[54:57], v[42:45], v[108:123]
    ds_read_b64_tr_b16 v[86:87], v22 offset:28672
    ds_read_b64_tr_b16 v[88:89], v22 offset:30720
    v_mfma_f32_32x32x16_bf16 v[124:139], v[50:53], v[46:49], v[124:139]
    v_mfma_f32_32x32x16_bf16 v[140:155], v[54:57], v[46:49], v[140:155]
    s_waitcnt lgkmcnt(0)
    s_waitcnt vmcnt(8)
    s_barrier
    ds_read_b128 v[26:29], v13 offset:32768
    ds_read_b64_tr_b16 v[34:35], v21 offset:49152
    ds_read_b64_tr_b16 v[36:37], v21 offset:51200
    ds_read_b128 v[30:33], v13 offset:36864
    ds_read_b64_tr_b16 v[38:39], v22 offset:49152
    ds_read_b64_tr_b16 v[40:41], v22 offset:51200
    ds_read_b128 v[42:45], v14 offset:32768
    ds_read_b64_tr_b16 v[50:51], v21 offset:53248
    ds_read_b64_tr_b16 v[52:53], v21 offset:55296
    ds_read_b128 v[46:49], v14 offset:36864
    ds_read_b64_tr_b16 v[54:55], v22 offset:53248
    ds_read_b64_tr_b16 v[56:57], v22 offset:55296
    v_mfma_f32_32x32x16_bf16 v[92:107], v[66:69], v[58:61], v[92:107]
    s_lshl_b32 s22, s24, 7
    s_add_u32 s22, s22, s28
    s_add_u32 m0, s17, 0
    s_nop 0
    buffer_load_dwordx4 v5, s[4:7], s22 offen lds
    v_mfma_f32_32x32x16_bf16 v[108:123], v[70:73], v[58:61], v[108:123]
    s_add_u32 m0, s17, 4096
    s_nop 0
    buffer_load_dwordx4 v6, s[4:7], s22 offen lds
    v_mfma_f32_32x32x16_bf16 v[124:139], v[66:69], v[62:65], v[124:139]
    s_add_u32 m0, s17, 8192
    s_nop 0
    buffer_load_dwordx4 v7, s[4:7], s22 offen lds
    v_mfma_f32_32x32x16_bf16 v[140:155], v[70:73], v[62:65], v[140:155]
    s_add_u32 m0, s17, 12288
    s_nop 0
    buffer_load_dwordx4 v8, s[4:7], s22 offen lds
    v_mfma_f32_32x32x16_bf16 v[92:107], v[82:85], v[74:77], v[92:107]
    s_mul_i32 s23, s24, 65536
    s_add_u32 s23, s23, s29
    s_add_u32 s24, s24, 1
    s_cmp_eq_u32 s24, 16
    s_cselect_b32 s24, 0, s24
    s_add_u32 m0, s17, 16384
    s_nop 0
    buffer_load_dwordx4 v9, s[8:11], s23 offen lds
    v_mfma_f32_32x32x16_bf16 v[108:123], v[86:89], v[74:77], v[108:123]
    s_add_u32 m0, s17, 20480
    s_nop 0
    buffer_load_dwordx4 v10, s[8:11], s23 offen lds
    v_mfma_f32_32x32x16_bf16 v[124:139], v[82:85], v[78:81], v[124:139]
    s_add_u32 m0, s17, 24576
    s_nop 0
    buffer_load_dwordx4 v11, s[8:11], s23 offen lds
    v_mfma_f32_32x32x16_bf16 v[140:155], v[86:89], v[78:81], v[140:155]
    s_add_u32 m0, s17, 28672
    s_nop 0
    buffer_load_dwordx4 v12, s[8:11], s23 offen lds
    s_waitcnt lgkmcnt(9)
    v_mfma_f32_32x32x16_bf16 v[92:107], v[34:37], v[26:29], v[92:107]
    ds_read_b128 v[58:61], v15 offset:32768
    ds_read_b64_tr_b16 v[66:67], v21 offset:57344
    s_waitcnt lgkmcnt(8)
    v_mfma_f32_32x32x16_bf16 v[108:123], v[38:41], v[26:29], v[108:123]
    ds_read_b64_tr_b16 v[68:69], v21 offset:59392
    ds_read_b128 v[62:65], v15 offset:36864
    v_mfma_f32_32x32x16_bf16 v[124:139], v[34:37], v[30:33], v[124:139]
    ds_read_b64_tr_b16 v[70:71], v22 offset:57344
    ds_read_b64_tr_b16 v[72:73], v22 offset:59392
    v_mfma_f32_32x32x16_bf16 v[140:155], v[38:41], v[30:33], v[140:155]
    ds_read_b128 v[74:77], v16 offset:32768
    ds_read_b64_tr_b16 v[82:83], v21 offset:61440
    s_waitcnt lgkmcnt(11)
    v_mfma_f32_32x32x16_bf16 v[92:107], v[50:53], v[42:45], v[92:107]
    ds_read_b64_tr_b16 v[84:85], v21 offset:63488
    ds_read_b128 v[78:81], v16 offset:36864
    s_waitcnt lgkmcnt(10)
    v_mfma_f32_32x32x16_bf16 v[108:123], v[54:57], v[42:45], v[108:123]
    ds_read_b64_tr_b16 v[86:87], v22 offset:61440
    ds_read_b64_tr_b16 v[88:89], v22 offset:63488
    v_mfma_f32_32x32x16_bf16 v[124:139], v[50:53], v[46:49], v[124:139]
    v_mfma_f32_32x32x16_bf16 v[140:155], v[54:57], v[46:49], v[140:155]
    s_waitcnt lgkmcnt(0)
    s_waitcnt vmcnt(8)
    s_barrier
    ds_read_b128 v[26:29], v17 offset:0
    ds_read_b64_tr_b16 v[34:35], v23 offset:16384
    ds_read_b64_tr_b16 v[36:37], v23 offset:18432
    ds_read_b128 v[30:33], v17 offset:4096
    ds_read_b64_tr_b16 v[38:39], v24 offset:16384
    ds_read_b64_tr_b16 v[40:41], v24 offset:18432
    ds_read_b128 v[42:45], v18 offset:0
    ds_read_b64_tr_b16 v[50:51], v23 offset:20480
    ds_read_b64_tr_b16 v[52:53], v23 offset:22528
    ds_read_b128 v[46:49], v18 offset:4096
    ds_read_b64_tr_b16 v[54:55], v24 offset:20480
    ds_read_b64_tr_b16 v[56:57], v24 offset:22528
    v_mfma_f32_32x32x16_bf16 v[92:107], v[66:69], v[58:61], v[92:107]
    s_lshl_b32 s22, s24, 7
    s_add_u32 s22, s22, s28
    s_add_u32 m0, s17, 32768
    s_nop 0
    buffer_load_dwordx4 v5, s[4:7], s22 offen lds
    v_mfma_f32_32x32x16_bf16 v[108:123], v[70:73], v[58:61], v[108:123]
    s_add_u32 m0, s17, 36864
    s_nop 0
    buffer_load_dwordx4 v6, s[4:7], s22 offen lds
    v_mfma_f32_32x32x16_bf16 v[124:139], v[66:69], v[62:65], v[124:139]
    s_add_u32 m0, s17, 40960
    s_nop 0
    buffer_load_dwordx4 v7, s[4:7], s22 offen lds
    v_mfma_f32_32x32x16_bf16 v[140:155], v[70:73], v[62:65], v[140:155]
    s_add_u32 m0, s17, 45056
    s_nop 0
    buffer_load_dwordx4 v8, s[4:7], s22 offen lds
    v_mfma_f32_32x32x16_bf16 v[92:107], v[82:85], v[74:77], v[92:107]
    s_mul_i32 s23, s24, 65536
    s_add_u32 s23, s23, s29
    s_add_u32 s24, s24, 1
    s_cmp_eq_u32 s24, 16
    s_cselect_b32 s24, 0, s24
    s_add_u32 m0, s17, 49152
    s_nop 0
    buffer_load_dwordx4 v9, s[8:11], s23 offen lds
    v_mfma_f32_32x32x16_bf16 v[108:123], v[86:89], v[74:77], v[108:123]
    s_add_u32 m0, s17, 53248
    s_nop 0
    buffer_load_dwordx4 v10, s[8:11], s23 offen lds
    v_mfma_f32_32x32x16_bf16 v[124:139], v[82:85], v[78:81], v[124:139]
    s_add_u32 m0, s17, 57344
    s_nop 0
    buffer_load_dwordx4 v11, s[8:11], s23 offen lds
    v_mfma_f32_32x32x16_bf16 v[140:155], v[86:89], v[78:81], v[140:155]
    s_add_u32 m0, s17, 61440
    s_nop 0
    buffer_load_dwordx4 v12, s[8:11], s23 offen lds
    s_waitcnt lgkmcnt(9)
    v_mfma_f32_32x32x16_bf16 v[92:107], v[34:37], v[26:29], v[92:107]
    ds_read_b128 v[58:61], v19 offset:0
    ds_read_b64_tr_b16 v[66:67], v23 offset:24576
    s_waitcnt lgkmcnt(8)
    v_mfma_f32_32x32x16_bf16 v[108:123], v[38:41], v[26:29], v[108:123]
    ds_read_b64_tr_b16 v[68:69], v23 offset:26624
    ds_read_b128 v[62:65], v19 offset:4096
    v_mfma_f32_32x32x16_bf16 v[124:139], v[34:37], v[30:33], v[124:139]
    ds_read_b64_tr_b16 v[70:71], v24 offset:24576
    ds_read_b64_tr_b16 v[72:73], v24 offset:26624
    v_mfma_f32_32x32x16_bf16 v[140:155], v[38:41], v[30:33], v[140:155]
    ds_read_b128 v[74:77], v20 offset:0
    ds_read_b64_tr_b16 v[82:83], v23 offset:28672
    s_waitcnt lgkmcnt(11)
    v_mfma_f32_32x32x16_bf16 v[92:107], v[50:53], v[42:45], v[92:107]
    ds_read_b64_tr_b16 v[84:85], v23 offset:30720
    ds_read_b128 v[78:81], v20 offset:4096
    s_waitcnt lgkmcnt(10)
    v_mfma_f32_32x32x16_bf16 v[108:123], v[54:57], v[42:45], v[108:123]
    ds_read_b64_tr_b16 v[86:87], v24 offset:28672
    ds_read_b64_tr_b16 v[88:89], v24 offset:30720
    v_mfma_f32_32x32x16_bf16 v[124:139], v[50:53], v[46:49], v[124:139]
    v_mfma_f32_32x32x16_bf16 v[140:155], v[54:57], v[46:49], v[140:155]
    s_waitcnt lgkmcnt(0)
    s_waitcnt vmcnt(8)
    s_barrier
    ds_read_b128 v[26:29], v13 offset:0
    ds_read_b64_tr_b16 v[34:35], v21 offset:16384
    ds_read_b64_tr_b16 v[36:37], v21 offset:18432
    ds_read_b128 v[30:33], v13 offset:4096
    ds_read_b64_tr_b16 v[38:39], v22 offset:16384
    ds_read_b64_tr_b16 v[40:41], v22 offset:18432
    ds_read_b128 v[42:45], v14 offset:0
    ds_read_b64_tr_b16 v[50:51], v21 offset:20480
    ds_read_b64_tr_b16 v[52:53], v21 offset:22528
    ds_read_b128 v[46:49], v14 offset:4096
    ds_read_b64_tr_b16 v[54:55], v22 offset:20480
    ds_read_b64_tr_b16 v[56:57], v22 offset:22528
    v_mfma_f32_32x32x16_bf16 v[92:107], v[66:69], v[58:61], v[92:107]
    s_lshl_b32 s22, s24, 7
    s_add_u32 s22, s22, s28
    s_add_u32 m0, s17, 65536
    s_nop 0
    buffer_load_dwordx4 v5, s[4:7], s22 offen lds
    v_mfma_f32_32x32x16_bf16 v[108:123], v[70:73], v[58:61], v[108:123]
    s_add_u32 m0, s17, 69632
    s_nop 0
    buffer_load_dwordx4 v6, s[4:7], s22 offen lds
    v_mfma_f32_32x32x16_bf16 v[124:139], v[66:69], v[62:65], v[124:139]
    s_add_u32 m0, s17, 73728
    s_nop 0
    buffer_load_dwordx4 v7, s[4:7], s22 offen lds
    v_mfma_f32_32x32x16_bf16 v[140:155], v[70:73], v[62:65], v[140:155]
    s_add_u32 m0, s17, 77824
    s_nop 0
    buffer_load_dwordx4 v8, s[4:7], s22 offen lds
    v_mfma_f32_32x32x16_bf16 v[92:107], v[82:85], v[74:77], v[92:107]
    s_mul_i32 s23, s24, 65536
    s_add_u32 s23, s23, s29
    s_add_u32 s24, s24, 1
    s_cmp_eq_u32 s24, 16
    s_cselect_b32 s24, 0, s24
    s_add_u32 m0, s17, 81920
    s_nop 0
    buffer_load_dwordx4 v9, s[8:11], s23 offen lds
    v_mfma_f32_32x32x16_bf16 v[108:123], v[86:89], v[74:77], v[108:123]
    s_add_u32 m0, s17, 86016
    s_nop 0
    buffer_load_dwordx4 v10, s[8:11], s23 offen lds
    v_mfma_f32_32x32x16_bf16 v[124:139], v[82:85], v[78:81], v[124:139]
    s_add_u32 m0, s17, 90112
    s_nop 0
    buffer_load_dwordx4 v11, s[8:11], s23 offen lds
    v_mfma_f32_32x32x16_bf16 v[140:155], v[86:89], v[78:81], v[140:155]
    s_add_u32 m0, s17, 94208
    s_nop 0
    buffer_load_dwordx4 v12, s[8:11], s23 offen lds
    s_waitcnt lgkmcnt(9)
    v_mfma_f32_32x32x16_bf16 v[92:107], v[34:37], v[26:29], v[92:107]
    ds_read_b128 v[58:61], v15 offset:0
    ds_read_b64_tr_b16 v[66:67], v21 offset:24576
    s_waitcnt lgkmcnt(8)
    v_mfma_f32_32x32x16_bf16 v[108:123], v[38:41], v[26:29], v[108:123]
    ds_read_b64_tr_b16 v[68:69], v21 offset:26624
    ds_read_b128 v[62:65], v15 offset:4096
    v_mfma_f32_32x32x16_bf16 v[124:139], v[34:37], v[30:33], v[124:139]
    ds_read_b64_tr_b16 v[70:71], v22 offset:24576
    ds_read_b64_tr_b16 v[72:73], v22 offset:26624
    v_mfma_f32_32x32x16_bf16 v[140:155], v[38:41], v[30:33], v[140:155]
    ds_read_b128 v[74:77], v16 offset:0
    ds_read_b64_tr_b16 v[82:83], v21 offset:28672
    s_waitcnt lgkmcnt(11)
    v_mfma_f32_32x32x16_bf16 v[92:107], v[50:53], v[42:45], v[92:107]
    ds_read_b64_tr_b16 v[84:85], v21 offset:30720
    ds_read_b128 v[78:81], v16 offset:4096
    s_waitcnt lgkmcnt(10)
    v_mfma_f32_32x32x16_bf16 v[108:123], v[54:57], v[42:45], v[108:123]
    ds_read_b64_tr_b16 v[86:87], v22 offset:28672
    ds_read_b64_tr_b16 v[88:89], v22 offset:30720
    v_mfma_f32_32x32x16_bf16 v[124:139], v[50:53], v[46:49], v[124:139]
    v_mfma_f32_32x32x16_bf16 v[140:155], v[54:57], v[46:49], v[140:155]
    s_waitcnt lgkmcnt(0)
    s_waitcnt vmcnt(8)
    s_barrier
    ds_read_b128 v[26:29], v13 offset:32768
    ds_read_b64_tr_b16 v[34:35], v21 offset:49152
    ds_read_b64_tr_b16 v[36:37], v21 offset:51200
    ds_read_b128 v[30:33], v13 offset:36864
    ds_read_b64_tr_b16 v[38:39], v22 offset:49152
    ds_read_b64_tr_b16 v[40:41], v22 offset:51200
    ds_read_b128 v[42:45], v14 offset:32768
    ds_read_b64_tr_b16 v[50:51], v21 offset:53248
    ds_read_b64_tr_b16 v[52:53], v21 offset:55296
    ds_read_b128 v[46:49], v14 offset:36864
    ds_read_b64_tr_b16 v[54:55], v22 offset:53248
    ds_read_b64_tr_b16 v[56:57], v22 offset:55296
    v_mfma_f32_32x32x16_bf16 v[92:107], v[66:69], v[58:61], v[92:107]
    s_lshl_b32 s22, s24, 7
    s_add_u32 s22, s22, s28
    s_add_u32 m0, s17, 0
    s_nop 0
    buffer_load_dwordx4 v5, s[4:7], s22 offen lds
    v_mfma_f32_32x32x16_bf16 v[108:123], v[70:73], v[58:61], v[108:123]
    s_add_u32 m0, s17, 4096
    s_nop 0
    buffer_load_dwordx4 v6, s[4:7], s22 offen lds
    v_mfma_f32_32x32x16_bf16 v[124:139], v[66:69], v[62:65], v[124:139]
    s_add_u32 m0, s17, 8192
    s_nop 0
    buffer_load_dwordx4 v7, s[4:7], s22 offen lds
    v_mfma_f32_32x32x16_bf16 v[140:155], v[70:73], v[62:65], v[140:155]
    s_add_u32 m0, s17, 12288
    s_nop 0
    buffer_load_dwordx4 v8, s[4:7], s22 offen lds
    v_mfma_f32_32x32x16_bf16 v[92:107], v[82:85], v[74:77], v[92:107]
    s_mul_i32 s23, s24, 65536
    s_add_u32 s23, s23, s29
    s_add_u32 s24, s24, 1
    s_cmp_eq_u32 s24, 16
    s_cselect_b32 s24, 0, s24
    s_add_u32 m0, s17, 16384
    s_nop 0
    buffer_load_dwordx4 v9, s[8:11], s23 offen lds
    v_mfma_f32_32x32x16_bf16 v[108:123], v[86:89], v[74:77], v[108:123]
    s_add_u32 m0, s17, 20480
    s_nop 0
    buffer_load_dwordx4 v10, s[8:11], s23 offen lds
    v_mfma_f32_32x32x16_bf16 v[124:139], v[82:85], v[78:81], v[124:139]
    s_add_u32 m0, s17, 24576
    s_nop 0
    buffer_load_dwordx4 v11, s[8:11], s23 offen lds
    v_mfma_f32_32x32x16_bf16 v[140:155], v[86:89], v[78:81], v[140:155]
    s_add_u32 m0, s17, 28672
    s_nop 0
    buffer_load_dwordx4 v12, s[8:11], s23 offen lds
    s_waitcnt lgkmcnt(9)
    v_mfma_f32_32x32x16_bf16 v[92:107], v[34:37], v[26:29], v[92:107]
    ds_read_b128 v[58:61], v15 offset:32768
    ds_read_b64_tr_b16 v[66:67], v21 offset:57344
    s_waitcnt lgkmcnt(8)
    v_mfma_f32_32x32x16_bf16 v[108:123], v[38:41], v[26:29], v[108:123]
    ds_read_b64_tr_b16 v[68:69], v21 offset:59392
    ds_read_b128 v[62:65], v15 offset:36864
    v_mfma_f32_32x32x16_bf16 v[124:139], v[34:37], v[30:33], v[124:139]
    ds_read_b64_tr_b16 v[70:71], v22 offset:57344
    ds_read_b64_tr_b16 v[72:73], v22 offset:59392
    v_mfma_f32_32x32x16_bf16 v[140:155], v[38:41], v[30:33], v[140:155]
    ds_read_b128 v[74:77], v16 offset:32768
    ds_read_b64_tr_b16 v[82:83], v21 offset:61440
    s_waitcnt lgkmcnt(11)
    v_mfma_f32_32x32x16_bf16 v[92:107], v[50:53], v[42:45], v[92:107]
    ds_read_b64_tr_b16 v[84:85], v21 offset:63488
    ds_read_b128 v[78:81], v16 offset:36864
    s_waitcnt lgkmcnt(10)
    v_mfma_f32_32x32x16_bf16 v[108:123], v[54:57], v[42:45], v[108:123]
    ds_read_b64_tr_b16 v[86:87], v22 offset:61440
    ds_read_b64_tr_b16 v[88:89], v22 offset:63488
    v_mfma_f32_32x32x16_bf16 v[124:139], v[50:53], v[46:49], v[124:139]
    v_mfma_f32_32x32x16_bf16 v[140:155], v[54:57], v[46:49], v[140:155]
    s_waitcnt lgkmcnt(0)
    s_waitcnt vmcnt(8)
    s_barrier
    ds_read_b128 v[26:29], v17 offset:0
    ds_read_b64_tr_b16 v[34:35], v23 offset:16384
    ds_read_b64_tr_b16 v[36:37], v23 offset:18432
    ds_read_b128 v[30:33], v17 offset:4096
    ds_read_b64_tr_b16 v[38:39], v24 offset:16384
    ds_read_b64_tr_b16 v[40:41], v24 offset:18432
    ds_read_b128 v[42:45], v18 offset:0
    ds_read_b64_tr_b16 v[50:51], v23 offset:20480
    ds_read_b64_tr_b16 v[52:53], v23 offset:22528
    ds_read_b128 v[46:49], v18 offset:4096
    ds_read_b64_tr_b16 v[54:55], v24 offset:20480
    ds_read_b64_tr_b16 v[56:57], v24 offset:22528
    v_mfma_f32_32x32x16_bf16 v[92:107], v[66:69], v[58:61], v[92:107]
    s_lshl_b32 s22, s24, 7
    s_add_u32 s22, s22, s28
    s_add_u32 m0, s17, 32768
    s_nop 0
    buffer_load_dwordx4 v5, s[4:7], s22 offen lds
    v_mfma_f32_32x32x16_bf16 v[108:123], v[70:73], v[58:61], v[108:123]
    s_add_u32 m0, s17, 36864
    s_nop 0
    buffer_load_dwordx4 v6, s[4:7], s22 offen lds
    v_mfma_f32_32x32x16_bf16 v[124:139], v[66:69], v[62:65], v[124:139]
    s_add_u32 m0, s17, 40960
    s_nop 0
    buffer_load_dwordx4 v7, s[4:7], s22 offen lds
    v_mfma_f32_32x32x16_bf16 v[140:155], v[70:73], v[62:65], v[140:155]
    s_add_u32 m0, s17, 45056
    s_nop 0
    buffer_load_dwordx4 v8, s[4:7], s22 offen lds
    v_mfma_f32_32x32x16_bf16 v[92:107], v[82:85], v[74:77], v[92:107]
    s_mul_i32 s23, s24, 65536
    s_add_u32 s23, s23, s29
    s_add_u32 s24, s24, 1
    s_cmp_eq_u32 s24, 16
    s_cselect_b32 s24, 0, s24
    s_add_u32 m0, s17, 49152
    s_nop 0
    buffer_load_dwordx4 v9, s[8:11], s23 offen lds
    v_mfma_f32_32x32x16_bf16 v[108:123], v[86:89], v[74:77], v[108:123]
    s_add_u32 m0, s17, 53248
    s_nop 0
    buffer_load_dwordx4 v10, s[8:11], s23 offen lds
    v_mfma_f32_32x32x16_bf16 v[124:139], v[82:85], v[78:81], v[124:139]
    s_add_u32 m0, s17, 57344
    s_nop 0
    buffer_load_dwordx4 v11, s[8:11], s23 offen lds
    v_mfma_f32_32x32x16_bf16 v[140:155], v[86:89], v[78:81], v[140:155]
    s_add_u32 m0, s17, 61440
    s_nop 0
    buffer_load_dwordx4 v12, s[8:11], s23 offen lds
    s_waitcnt lgkmcnt(9)
    v_mfma_f32_32x32x16_bf16 v[92:107], v[34:37], v[26:29], v[92:107]
    ds_read_b128 v[58:61], v19 offset:0
    ds_read_b64_tr_b16 v[66:67], v23 offset:24576
    s_waitcnt lgkmcnt(8)
    v_mfma_f32_32x32x16_bf16 v[108:123], v[38:41], v[26:29], v[108:123]
    ds_read_b64_tr_b16 v[68:69], v23 offset:26624
    ds_read_b128 v[62:65], v19 offset:4096
    v_mfma_f32_32x32x16_bf16 v[124:139], v[34:37], v[30:33], v[124:139]
    ds_read_b64_tr_b16 v[70:71], v24 offset:24576
    ds_read_b64_tr_b16 v[72:73], v24 offset:26624
    v_mfma_f32_32x32x16_bf16 v[140:155], v[38:41], v[30:33], v[140:155]
    ds_read_b128 v[74:77], v20 offset:0
    ds_read_b64_tr_b16 v[82:83], v23 offset:28672
    s_waitcnt lgkmcnt(11)
    v_mfma_f32_32x32x16_bf16 v[92:107], v[50:53], v[42:45], v[92:107]
    ds_read_b64_tr_b16 v[84:85], v23 offset:30720
    ds_read_b128 v[78:81], v20 offset:4096
    s_waitcnt lgkmcnt(10)
    v_mfma_f32_32x32x16_bf16 v[108:123], v[54:57], v[42:45], v[108:123]
    ds_read_b64_tr_b16 v[86:87], v24 offset:28672
    ds_read_b64_tr_b16 v[88:89], v24 offset:30720
    v_mfma_f32_32x32x16_bf16 v[124:139], v[50:53], v[46:49], v[124:139]
    v_mfma_f32_32x32x16_bf16 v[140:155], v[54:57], v[46:49], v[140:155]
    s_waitcnt lgkmcnt(0)
    s_waitcnt vmcnt(8)
    s_barrier
    ds_read_b128 v[26:29], v13 offset:0
    ds_read_b64_tr_b16 v[34:35], v21 offset:16384
    ds_read_b64_tr_b16 v[36:37], v21 offset:18432
    ds_read_b128 v[30:33], v13 offset:4096
    ds_read_b64_tr_b16 v[38:39], v22 offset:16384
    ds_read_b64_tr_b16 v[40:41], v22 offset:18432
    ds_read_b128 v[42:45], v14 offset:0
    ds_read_b64_tr_b16 v[50:51], v21 offset:20480
    ds_read_b64_tr_b16 v[52:53], v21 offset:22528
    ds_read_b128 v[46:49], v14 offset:4096
    ds_read_b64_tr_b16 v[54:55], v22 offset:20480
    ds_read_b64_tr_b16 v[56:57], v22 offset:22528
    v_mfma_f32_32x32x16_bf16 v[92:107], v[66:69], v[58:61], v[92:107]
    s_lshl_b32 s22, s24, 7
    s_add_u32 s22, s22, s28
    s_add_u32 m0, s17, 65536
    s_nop 0
    buffer_load_dwordx4 v5, s[4:7], s22 offen lds
    v_mfma_f32_32x32x16_bf16 v[108:123], v[70:73], v[58:61], v[108:123]
    s_add_u32 m0, s17, 69632
    s_nop 0
    buffer_load_dwordx4 v6, s[4:7], s22 offen lds
    v_mfma_f32_32x32x16_bf16 v[124:139], v[66:69], v[62:65], v[124:139]
    s_add_u32 m0, s17, 73728
    s_nop 0
    buffer_load_dwordx4 v7, s[4:7], s22 offen lds
    v_mfma_f32_32x32x16_bf16 v[140:155], v[70:73], v[62:65], v[140:155]
    s_add_u32 m0, s17, 77824
    s_nop 0
    buffer_load_dwordx4 v8, s[4:7], s22 offen lds
    v_mfma_f32_32x32x16_bf16 v[92:107], v[82:85], v[74:77], v[92:107]
    s_mul_i32 s23, s24, 65536
    s_add_u32 s23, s23, s29
    s_add_u32 s24, s24, 1
    s_cmp_eq_u32 s24, 16
    s_cselect_b32 s24, 0, s24
    s_add_u32 m0, s17, 81920
    s_nop 0
    buffer_load_dwordx4 v9, s[8:11], s23 offen lds
    v_mfma_f32_32x32x16_bf16 v[108:123], v[86:89], v[74:77], v[108:123]
    s_add_u32 m0, s17, 86016
    s_nop 0
    buffer_load_dwordx4 v10, s[8:11], s23 offen lds
    v_mfma_f32_32x32x16_bf16 v[124:139], v[82:85], v[78:81], v[124:139]
    s_add_u32 m0, s17, 90112
    s_nop 0
    buffer_load_dwordx4 v11, s[8:11], s23 offen lds
    v_mfma_f32_32x32x16_bf16 v[140:155], v[86:89], v[78:81], v[140:155]
    s_add_u32 m0, s17, 94208
    s_nop 0
    buffer_load_dwordx4 v12, s[8:11], s23 offen lds
    s_waitcnt lgkmcnt(9)
    v_mfma_f32_32x32x16_bf16 v[92:107], v[34:37], v[26:29], v[92:107]
    ds_read_b128 v[58:61], v15 offset:0
    ds_read_b64_tr_b16 v[66:67], v21 offset:24576
    s_waitcnt lgkmcnt(8)
    v_mfma_f32_32x32x16_bf16 v[108:123], v[38:41], v[26:29], v[108:123]
    ds_read_b64_tr_b16 v[68:69], v21 offset:26624
    ds_read_b128 v[62:65], v15 offset:4096
    v_mfma_f32_32x32x16_bf16 v[124:139], v[34:37], v[30:33], v[124:139]
    ds_read_b64_tr_b16 v[70:71], v22 offset:24576
    ds_read_b64_tr_b16 v[72:73], v22 offset:26624
    v_mfma_f32_32x32x16_bf16 v[140:155], v[38:41], v[30:33], v[140:155]
    ds_read_b128 v[74:77], v16 offset:0
    ds_read_b64_tr_b16 v[82:83], v21 offset:28672
    s_waitcnt lgkmcnt(11)
    v_mfma_f32_32x32x16_bf16 v[92:107], v[50:53], v[42:45], v[92:107]
    ds_read_b64_tr_b16 v[84:85], v21 offset:30720
    ds_read_b128 v[78:81], v16 offset:4096
    s_waitcnt lgkmcnt(10)
    v_mfma_f32_32x32x16_bf16 v[108:123], v[54:57], v[42:45], v[108:123]
    ds_read_b64_tr_b16 v[86:87], v22 offset:28672
    ds_read_b64_tr_b16 v[88:89], v22 offset:30720
    v_mfma_f32_32x32x16_bf16 v[124:139], v[50:53], v[46:49], v[124:139]
    v_mfma_f32_32x32x16_bf16 v[140:155], v[54:57], v[46:49], v[140:155]
    s_waitcnt lgkmcnt(0)
    s_waitcnt vmcnt(8)
    s_barrier
    ds_read_b128 v[26:29], v13 offset:32768
    ds_read_b64_tr_b16 v[34:35], v21 offset:49152
    ds_read_b64_tr_b16 v[36:37], v21 offset:51200
    ds_read_b128 v[30:33], v13 offset:36864
    ds_read_b64_tr_b16 v[38:39], v22 offset:49152
    ds_read_b64_tr_b16 v[40:41], v22 offset:51200
    ds_read_b128 v[42:45], v14 offset:32768
    ds_read_b64_tr_b16 v[50:51], v21 offset:53248
    ds_read_b64_tr_b16 v[52:53], v21 offset:55296
    ds_read_b128 v[46:49], v14 offset:36864
    ds_read_b64_tr_b16 v[54:55], v22 offset:53248
    ds_read_b64_tr_b16 v[56:57], v22 offset:55296
    v_mfma_f32_32x32x16_bf16 v[92:107], v[66:69], v[58:61], v[92:107]
    s_lshl_b32 s22, s24, 7
    s_add_u32 s22, s22, s28
    s_add_u32 m0, s17, 0
    s_nop 0
    buffer_load_dwordx4 v5, s[4:7], s22 offen lds
    v_mfma_f32_32x32x16_bf16 v[108:123], v[70:73], v[58:61], v[108:123]
    s_add_u32 m0, s17, 4096
    s_nop 0
    buffer_load_dwordx4 v6, s[4:7], s22 offen lds
    v_mfma_f32_32x32x16_bf16 v[124:139], v[66:69], v[62:65], v[124:139]
    s_add_u32 m0, s17, 8192
    s_nop 0
    buffer_load_dwordx4 v7, s[4:7], s22 offen lds
    v_mfma_f32_32x32x16_bf16 v[140:155], v[70:73], v[62:65], v[140:155]
    s_add_u32 m0, s17, 12288
    s_nop 0
    buffer_load_dwordx4 v8, s[4:7], s22 offen lds
    v_mfma_f32_32x32x16_bf16 v[92:107], v[82:85], v[74:77], v[92:107]
    s_mul_i32 s23, s24, 65536
    s_add_u32 s23, s23, s29
    s_add_u32 s24, s24, 1
    s_cmp_eq_u32 s24, 16
    s_cselect_b32 s24, 0, s24
    s_add_u32 m0, s17, 16384
    s_nop 0
    buffer_load_dwordx4 v9, s[8:11], s23 offen lds
    v_mfma_f32_32x32x16_bf16 v[108:123], v[86:89], v[74:77], v[108:123]
    s_add_u32 m0, s17, 20480
    s_nop 0
    buffer_load_dwordx4 v10, s[8:11], s23 offen lds
    v_mfma_f32_32x32x16_bf16 v[124:139], v[82:85], v[78:81], v[124:139]
    s_add_u32 m0, s17, 24576
    s_nop 0
    buffer_load_dwordx4 v11, s[8:11], s23 offen lds
    v_mfma_f32_32x32x16_bf16 v[140:155], v[86:89], v[78:81], v[140:155]
    s_add_u32 m0, s17, 28672
    s_nop 0
    buffer_load_dwordx4 v12, s[8:11], s23 offen lds
    s_waitcnt lgkmcnt(9)
    v_mfma_f32_32x32x16_bf16 v[92:107], v[34:37], v[26:29], v[92:107]
    ds_read_b128 v[58:61], v15 offset:32768
    ds_read_b64_tr_b16 v[66:67], v21 offset:57344
    s_waitcnt lgkmcnt(8)
    v_mfma_f32_32x32x16_bf16 v[108:123], v[38:41], v[26:29], v[108:123]
    ds_read_b64_tr_b16 v[68:69], v21 offset:59392
    ds_read_b128 v[62:65], v15 offset:36864
    v_mfma_f32_32x32x16_bf16 v[124:139], v[34:37], v[30:33], v[124:139]
    ds_read_b64_tr_b16 v[70:71], v22 offset:57344
    ds_read_b64_tr_b16 v[72:73], v22 offset:59392
    v_mfma_f32_32x32x16_bf16 v[140:155], v[38:41], v[30:33], v[140:155]
    ds_read_b128 v[74:77], v16 offset:32768
    ds_read_b64_tr_b16 v[82:83], v21 offset:61440
    s_waitcnt lgkmcnt(11)
    v_mfma_f32_32x32x16_bf16 v[92:107], v[50:53], v[42:45], v[92:107]
    ds_read_b64_tr_b16 v[84:85], v21 offset:63488
    ds_read_b128 v[78:81], v16 offset:36864
    s_waitcnt lgkmcnt(10)
    v_mfma_f32_32x32x16_bf16 v[108:123], v[54:57], v[42:45], v[108:123]
    ds_read_b64_tr_b16 v[86:87], v22 offset:61440
    ds_read_b64_tr_b16 v[88:89], v22 offset:63488
    v_mfma_f32_32x32x16_bf16 v[124:139], v[50:53], v[46:49], v[124:139]
    v_mfma_f32_32x32x16_bf16 v[140:155], v[54:57], v[46:49], v[140:155]
    s_waitcnt lgkmcnt(0)
    s_waitcnt vmcnt(8)
    s_barrier
    ds_read_b128 v[26:29], v17 offset:0
    ds_read_b64_tr_b16 v[34:35], v23 offset:16384
    ds_read_b64_tr_b16 v[36:37], v23 offset:18432
    ds_read_b128 v[30:33], v17 offset:4096
    ds_read_b64_tr_b16 v[38:39], v24 offset:16384
    ds_read_b64_tr_b16 v[40:41], v24 offset:18432
    ds_read_b128 v[42:45], v18 offset:0
    ds_read_b64_tr_b16 v[50:51], v23 offset:20480
    ds_read_b64_tr_b16 v[52:53], v23 offset:22528
    ds_read_b128 v[46:49], v18 offset:4096
    ds_read_b64_tr_b16 v[54:55], v24 offset:20480
    ds_read_b64_tr_b16 v[56:57], v24 offset:22528
    v_mfma_f32_32x32x16_bf16 v[92:107], v[66:69], v[58:61], v[92:107]
    s_lshl_b32 s22, s24, 7
    s_add_u32 s22, s22, s28
    s_add_u32 m0, s17, 32768
    s_nop 0
    buffer_load_dwordx4 v5, s[4:7], s22 offen lds
    v_mfma_f32_32x32x16_bf16 v[108:123], v[70:73], v[58:61], v[108:123]
    s_add_u32 m0, s17, 36864
    s_nop 0
    buffer_load_dwordx4 v6, s[4:7], s22 offen lds
    v_mfma_f32_32x32x16_bf16 v[124:139], v[66:69], v[62:65], v[124:139]
    s_add_u32 m0, s17, 40960
    s_nop 0
    buffer_load_dwordx4 v7, s[4:7], s22 offen lds
    v_mfma_f32_32x32x16_bf16 v[140:155], v[70:73], v[62:65], v[140:155]
    s_add_u32 m0, s17, 45056
    s_nop 0
    buffer_load_dwordx4 v8, s[4:7], s22 offen lds
    v_mfma_f32_32x32x16_bf16 v[92:107], v[82:85], v[74:77], v[92:107]
    s_mul_i32 s23, s24, 65536
    s_add_u32 s23, s23, s29
    s_add_u32 s24, s24, 1
    s_cmp_eq_u32 s24, 16
    s_cselect_b32 s24, 0, s24
    s_add_u32 m0, s17, 49152
    s_nop 0
    buffer_load_dwordx4 v9, s[8:11], s23 offen lds
    v_mfma_f32_32x32x16_bf16 v[108:123], v[86:89], v[74:77], v[108:123]
    s_add_u32 m0, s17, 53248
    s_nop 0
    buffer_load_dwordx4 v10, s[8:11], s23 offen lds
    v_mfma_f32_32x32x16_bf16 v[124:139], v[82:85], v[78:81], v[124:139]
    s_add_u32 m0, s17, 57344
    s_nop 0
    buffer_load_dwordx4 v11, s[8:11], s23 offen lds
    v_mfma_f32_32x32x16_bf16 v[140:155], v[86:89], v[78:81], v[140:155]
    s_add_u32 m0, s17, 61440
    s_nop 0
    buffer_load_dwordx4 v12, s[8:11], s23 offen lds
    s_waitcnt lgkmcnt(9)
    v_mfma_f32_32x32x16_bf16 v[92:107], v[34:37], v[26:29], v[92:107]
    ds_read_b128 v[58:61], v19 offset:0
    ds_read_b64_tr_b16 v[66:67], v23 offset:24576
    s_waitcnt lgkmcnt(8)
    v_mfma_f32_32x32x16_bf16 v[108:123], v[38:41], v[26:29], v[108:123]
    ds_read_b64_tr_b16 v[68:69], v23 offset:26624
    ds_read_b128 v[62:65], v19 offset:4096
    v_mfma_f32_32x32x16_bf16 v[124:139], v[34:37], v[30:33], v[124:139]
    ds_read_b64_tr_b16 v[70:71], v24 offset:24576
    ds_read_b64_tr_b16 v[72:73], v24 offset:26624
    v_mfma_f32_32x32x16_bf16 v[140:155], v[38:41], v[30:33], v[140:155]
    ds_read_b128 v[74:77], v20 offset:0
    ds_read_b64_tr_b16 v[82:83], v23 offset:28672
    s_waitcnt lgkmcnt(11)
    v_mfma_f32_32x32x16_bf16 v[92:107], v[50:53], v[42:45], v[92:107]
    ds_read_b64_tr_b16 v[84:85], v23 offset:30720
    ds_read_b128 v[78:81], v20 offset:4096
    s_waitcnt lgkmcnt(10)
    v_mfma_f32_32x32x16_bf16 v[108:123], v[54:57], v[42:45], v[108:123]
    ds_read_b64_tr_b16 v[86:87], v24 offset:28672
    ds_read_b64_tr_b16 v[88:89], v24 offset:30720
    v_mfma_f32_32x32x16_bf16 v[124:139], v[50:53], v[46:49], v[124:139]
    v_mfma_f32_32x32x16_bf16 v[140:155], v[54:57], v[46:49], v[140:155]
    s_waitcnt lgkmcnt(0)
    s_waitcnt vmcnt(8)
    s_barrier
    ds_read_b128 v[26:29], v13 offset:0
    ds_read_b64_tr_b16 v[34:35], v21 offset:16384
    ds_read_b64_tr_b16 v[36:37], v21 offset:18432
    ds_read_b128 v[30:33], v13 offset:4096
    ds_read_b64_tr_b16 v[38:39], v22 offset:16384
    ds_read_b64_tr_b16 v[40:41], v22 offset:18432
    ds_read_b128 v[42:45], v14 offset:0
    ds_read_b64_tr_b16 v[50:51], v21 offset:20480
    ds_read_b64_tr_b16 v[52:53], v21 offset:22528
    ds_read_b128 v[46:49], v14 offset:4096
    ds_read_b64_tr_b16 v[54:55], v22 offset:20480
    ds_read_b64_tr_b16 v[56:57], v22 offset:22528
    v_mfma_f32_32x32x16_bf16 v[92:107], v[66:69], v[58:61], v[92:107]
    s_lshl_b32 s22, s24, 7
    s_add_u32 s22, s22, s28
    s_add_u32 m0, s17, 65536
    s_nop 0
    buffer_load_dwordx4 v5, s[4:7], s22 offen lds
    v_mfma_f32_32x32x16_bf16 v[108:123], v[70:73], v[58:61], v[108:123]
    s_add_u32 m0, s17, 69632
    s_nop 0
    buffer_load_dwordx4 v6, s[4:7], s22 offen lds
    v_mfma_f32_32x32x16_bf16 v[124:139], v[66:69], v[62:65], v[124:139]
    s_add_u32 m0, s17, 73728
    s_nop 0
    buffer_load_dwordx4 v7, s[4:7], s22 offen lds
    v_mfma_f32_32x32x16_bf16 v[140:155], v[70:73], v[62:65], v[140:155]
    s_add_u32 m0, s17, 77824
    s_nop 0
    buffer_load_dwordx4 v8, s[4:7], s22 offen lds
    v_mfma_f32_32x32x16_bf16 v[92:107], v[82:85], v[74:77], v[92:107]
    s_mul_i32 s23, s24, 65536
    s_add_u32 s23, s23, s29
    s_add_u32 s24, s24, 1
    s_cmp_eq_u32 s24, 16
    s_cselect_b32 s24, 0, s24
    s_add_u32 m0, s17, 81920
    s_nop 0
    buffer_load_dwordx4 v9, s[8:11], s23 offen lds
    v_mfma_f32_32x32x16_bf16 v[108:123], v[86:89], v[74:77], v[108:123]
    s_add_u32 m0, s17, 86016
    s_nop 0
    buffer_load_dwordx4 v10, s[8:11], s23 offen lds
    v_mfma_f32_32x32x16_bf16 v[124:139], v[82:85], v[78:81], v[124:139]
    s_add_u32 m0, s17, 90112
    s_nop 0
    buffer_load_dwordx4 v11, s[8:11], s23 offen lds
    v_mfma_f32_32x32x16_bf16 v[140:155], v[86:89], v[78:81], v[140:155]
    s_add_u32 m0, s17, 94208
    s_nop 0
    buffer_load_dwordx4 v12, s[8:11], s23 offen lds
    s_waitcnt lgkmcnt(9)
    v_mfma_f32_32x32x16_bf16 v[92:107], v[34:37], v[26:29], v[92:107]
    ds_read_b128 v[58:61], v15 offset:0
    ds_read_b64_tr_b16 v[66:67], v21 offset:24576
    s_waitcnt lgkmcnt(8)
    v_mfma_f32_32x32x16_bf16 v[108:123], v[38:41], v[26:29], v[108:123]
    ds_read_b64_tr_b16 v[68:69], v21 offset:26624
    ds_read_b128 v[62:65], v15 offset:4096
    v_mfma_f32_32x32x16_bf16 v[124:139], v[34:37], v[30:33], v[124:139]
    ds_read_b64_tr_b16 v[70:71], v22 offset:24576
    ds_read_b64_tr_b16 v[72:73], v22 offset:26624
    v_mfma_f32_32x32x16_bf16 v[140:155], v[38:41], v[30:33], v[140:155]
    ds_read_b128 v[74:77], v16 offset:0
    ds_read_b64_tr_b16 v[82:83], v21 offset:28672
    s_waitcnt lgkmcnt(11)
    v_mfma_f32_32x32x16_bf16 v[92:107], v[50:53], v[42:45], v[92:107]
    ds_read_b64_tr_b16 v[84:85], v21 offset:30720
    ds_read_b128 v[78:81], v16 offset:4096
    s_waitcnt lgkmcnt(10)
    v_mfma_f32_32x32x16_bf16 v[108:123], v[54:57], v[42:45], v[108:123]
    ds_read_b64_tr_b16 v[86:87], v22 offset:28672
    ds_read_b64_tr_b16 v[88:89], v22 offset:30720
    v_mfma_f32_32x32x16_bf16 v[124:139], v[50:53], v[46:49], v[124:139]
    v_mfma_f32_32x32x16_bf16 v[140:155], v[54:57], v[46:49], v[140:155]
    s_waitcnt lgkmcnt(0)
    s_waitcnt vmcnt(8)
    s_barrier
    ds_read_b128 v[26:29], v13 offset:32768
    ds_read_b64_tr_b16 v[34:35], v21 offset:49152
    ds_read_b64_tr_b16 v[36:37], v21 offset:51200
    ds_read_b128 v[30:33], v13 offset:36864
    ds_read_b64_tr_b16 v[38:39], v22 offset:49152
    ds_read_b64_tr_b16 v[40:41], v22 offset:51200
    ds_read_b128 v[42:45], v14 offset:32768
    ds_read_b64_tr_b16 v[50:51], v21 offset:53248
    ds_read_b64_tr_b16 v[52:53], v21 offset:55296
    ds_read_b128 v[46:49], v14 offset:36864
    ds_read_b64_tr_b16 v[54:55], v22 offset:53248
    ds_read_b64_tr_b16 v[56:57], v22 offset:55296
    v_mfma_f32_32x32x16_bf16 v[92:107], v[66:69], v[58:61], v[92:107]
    s_lshl_b32 s22, s24, 7
    s_add_u32 s22, s22, s28
    s_add_u32 m0, s17, 0
    s_nop 0
    buffer_load_dwordx4 v5, s[4:7], s22 offen lds
    v_mfma_f32_32x32x16_bf16 v[108:123], v[70:73], v[58:61], v[108:123]
    s_add_u32 m0, s17, 4096
    s_nop 0
    buffer_load_dwordx4 v6, s[4:7], s22 offen lds
    v_mfma_f32_32x32x16_bf16 v[124:139], v[66:69], v[62:65], v[124:139]
    s_add_u32 m0, s17, 8192
    s_nop 0
    buffer_load_dwordx4 v7, s[4:7], s22 offen lds
    v_mfma_f32_32x32x16_bf16 v[140:155], v[70:73], v[62:65], v[140:155]
    s_add_u32 m0, s17, 12288
    s_nop 0
    buffer_load_dwordx4 v8, s[4:7], s22 offen lds
    v_mfma_f32_32x32x16_bf16 v[92:107], v[82:85], v[74:77], v[92:107]
    s_mul_i32 s23, s24, 65536
    s_add_u32 s23, s23, s29
    s_add_u32 s24, s24, 1
    s_cmp_eq_u32 s24, 16
    s_cselect_b32 s24, 0, s24
    s_add_u32 m0, s17, 16384
    s_nop 0
    buffer_load_dwordx4 v9, s[8:11], s23 offen lds
    v_mfma_f32_32x32x16_bf16 v[108:123], v[86:89], v[74:77], v[108:123]
    s_add_u32 m0, s17, 20480
    s_nop 0
    buffer_load_dwordx4 v10, s[8:11], s23 offen lds
    v_mfma_f32_32x32x16_bf16 v[124:139], v[82:85], v[78:81], v[124:139]
    s_add_u32 m0, s17, 24576
    s_nop 0
    buffer_load_dwordx4 v11, s[8:11], s23 offen lds
    v_mfma_f32_32x32x16_bf16 v[140:155], v[86:89], v[78:81], v[140:155]
    s_add_u32 m0, s17, 28672
    s_nop 0
    buffer_load_dwordx4 v12, s[8:11], s23 offen lds
    s_waitcnt lgkmcnt(9)
    v_mfma_f32_32x32x16_bf16 v[92:107], v[34:37], v[26:29], v[92:107]
    ds_read_b128 v[58:61], v15 offset:32768
    ds_read_b64_tr_b16 v[66:67], v21 offset:57344
    s_waitcnt lgkmcnt(8)
    v_mfma_f32_32x32x16_bf16 v[108:123], v[38:41], v[26:29], v[108:123]
    ds_read_b64_tr_b16 v[68:69], v21 offset:59392
    ds_read_b128 v[62:65], v15 offset:36864
    v_mfma_f32_32x32x16_bf16 v[124:139], v[34:37], v[30:33], v[124:139]
    ds_read_b64_tr_b16 v[70:71], v22 offset:57344
    ds_read_b64_tr_b16 v[72:73], v22 offset:59392
    v_mfma_f32_32x32x16_bf16 v[140:155], v[38:41], v[30:33], v[140:155]
    ds_read_b128 v[74:77], v16 offset:32768
    ds_read_b64_tr_b16 v[82:83], v21 offset:61440
    s_waitcnt lgkmcnt(11)
    v_mfma_f32_32x32x16_bf16 v[92:107], v[50:53], v[42:45], v[92:107]
    ds_read_b64_tr_b16 v[84:85], v21 offset:63488
    ds_read_b128 v[78:81], v16 offset:36864
    s_waitcnt lgkmcnt(10)
    v_mfma_f32_32x32x16_bf16 v[108:123], v[54:57], v[42:45], v[108:123]
    ds_read_b64_tr_b16 v[86:87], v22 offset:61440
    ds_read_b64_tr_b16 v[88:89], v22 offset:63488
    v_mfma_f32_32x32x16_bf16 v[124:139], v[50:53], v[46:49], v[124:139]
    v_mfma_f32_32x32x16_bf16 v[140:155], v[54:57], v[46:49], v[140:155]
    s_waitcnt lgkmcnt(0)
    s_waitcnt vmcnt(8)
    s_barrier
    ds_read_b128 v[26:29], v17 offset:0
    ds_read_b64_tr_b16 v[34:35], v23 offset:16384
    ds_read_b64_tr_b16 v[36:37], v23 offset:18432
    ds_read_b128 v[30:33], v17 offset:4096
    ds_read_b64_tr_b16 v[38:39], v24 offset:16384
    ds_read_b64_tr_b16 v[40:41], v24 offset:18432
    ds_read_b128 v[42:45], v18 offset:0
    ds_read_b64_tr_b16 v[50:51], v23 offset:20480
    ds_read_b64_tr_b16 v[52:53], v23 offset:22528
    ds_read_b128 v[46:49], v18 offset:4096
    ds_read_b64_tr_b16 v[54:55], v24 offset:20480
    ds_read_b64_tr_b16 v[56:57], v24 offset:22528
    v_mfma_f32_32x32x16_bf16 v[92:107], v[66:69], v[58:61], v[92:107]
    v_mfma_f32_32x32x16_bf16 v[108:123], v[70:73], v[58:61], v[108:123]
    v_mfma_f32_32x32x16_bf16 v[124:139], v[66:69], v[62:65], v[124:139]
    v_mfma_f32_32x32x16_bf16 v[140:155], v[70:73], v[62:65], v[140:155]
    v_mfma_f32_32x32x16_bf16 v[92:107], v[82:85], v[74:77], v[92:107]
    v_mfma_f32_32x32x16_bf16 v[108:123], v[86:89], v[74:77], v[108:123]
    v_mfma_f32_32x32x16_bf16 v[124:139], v[82:85], v[78:81], v[124:139]
    v_mfma_f32_32x32x16_bf16 v[140:155], v[86:89], v[78:81], v[140:155]
    s_waitcnt lgkmcnt(9)
    v_mfma_f32_32x32x16_bf16 v[92:107], v[34:37], v[26:29], v[92:107]
    ds_read_b128 v[58:61], v19 offset:0
    ds_read_b64_tr_b16 v[66:67], v23 offset:24576
    s_waitcnt lgkmcnt(8)
    v_mfma_f32_32x32x16_bf16 v[108:123], v[38:41], v[26:29], v[108:123]
    ds_read_b64_tr_b16 v[68:69], v23 offset:26624
    ds_read_b128 v[62:65], v19 offset:4096
    v_mfma_f32_32x32x16_bf16 v[124:139], v[34:37], v[30:33], v[124:139]
    ds_read_b64_tr_b16 v[70:71], v24 offset:24576
    ds_read_b64_tr_b16 v[72:73], v24 offset:26624
    v_mfma_f32_32x32x16_bf16 v[140:155], v[38:41], v[30:33], v[140:155]
    ds_read_b128 v[74:77], v20 offset:0
    ds_read_b64_tr_b16 v[82:83], v23 offset:28672
    s_waitcnt lgkmcnt(11)
    v_mfma_f32_32x32x16_bf16 v[92:107], v[50:53], v[42:45], v[92:107]
    ds_read_b64_tr_b16 v[84:85], v23 offset:30720
    ds_read_b128 v[78:81], v20 offset:4096
    s_waitcnt lgkmcnt(10)
    v_mfma_f32_32x32x16_bf16 v[108:123], v[54:57], v[42:45], v[108:123]
    ds_read_b64_tr_b16 v[86:87], v24 offset:28672
    ds_read_b64_tr_b16 v[88:89], v24 offset:30720
    v_mfma_f32_32x32x16_bf16 v[124:139], v[50:53], v[46:49], v[124:139]
    v_mfma_f32_32x32x16_bf16 v[140:155], v[54:57], v[46:49], v[140:155]
    s_waitcnt lgkmcnt(0)
    s_waitcnt vmcnt(0)
    s_barrier
    ds_read_b128 v[26:29], v13 offset:0
    ds_read_b64_tr_b16 v[34:35], v21 offset:16384
    ds_read_b64_tr_b16 v[36:37], v21 offset:18432
    ds_read_b128 v[30:33], v13 offset:4096
    ds_read_b64_tr_b16 v[38:39], v22 offset:16384
    ds_read_b64_tr_b16 v[40:41], v22 offset:18432
    ds_read_b128 v[42:45], v14 offset:0
    ds_read_b64_tr_b16 v[50:51], v21 offset:20480
    ds_read_b64_tr_b16 v[52:53], v21 offset:22528
    ds_read_b128 v[46:49], v14 offset:4096
    ds_read_b64_tr_b16 v[54:55], v22 offset:20480
    ds_read_b64_tr_b16 v[56:57], v22 offset:22528
    v_mfma_f32_32x32x16_bf16 v[92:107], v[66:69], v[58:61], v[92:107]
    v_mfma_f32_32x32x16_bf16 v[108:123], v[70:73], v[58:61], v[108:123]
    v_mfma_f32_32x32x16_bf16 v[124:139], v[66:69], v[62:65], v[124:139]
    v_mfma_f32_32x32x16_bf16 v[140:155], v[70:73], v[62:65], v[140:155]
    v_mfma_f32_32x32x16_bf16 v[92:107], v[82:85], v[74:77], v[92:107]
    v_mfma_f32_32x32x16_bf16 v[108:123], v[86:89], v[74:77], v[108:123]
    v_mfma_f32_32x32x16_bf16 v[124:139], v[82:85], v[78:81], v[124:139]
    v_mfma_f32_32x32x16_bf16 v[140:155], v[86:89], v[78:81], v[140:155]
    s_waitcnt lgkmcnt(9)
    v_mfma_f32_32x32x16_bf16 v[92:107], v[34:37], v[26:29], v[92:107]
    ds_read_b128 v[58:61], v15 offset:0
    ds_read_b64_tr_b16 v[66:67], v21 offset:24576
    s_waitcnt lgkmcnt(8)
    v_mfma_f32_32x32x16_bf16 v[108:123], v[38:41], v[26:29], v[108:123]
    ds_read_b64_tr_b16 v[68:69], v21 offset:26624
    ds_read_b128 v[62:65], v15 offset:4096
    v_mfma_f32_32x32x16_bf16 v[124:139], v[34:37], v[30:33], v[124:139]
    ds_read_b64_tr_b16 v[70:71], v22 offset:24576
    ds_read_b64_tr_b16 v[72:73], v22 offset:26624
    v_mfma_f32_32x32x16_bf16 v[140:155], v[38:41], v[30:33], v[140:155]
    ds_read_b128 v[74:77], v16 offset:0
    ds_read_b64_tr_b16 v[82:83], v21 offset:28672
    s_waitcnt lgkmcnt(11)
    v_mfma_f32_32x32x16_bf16 v[92:107], v[50:53], v[42:45], v[92:107]
    ds_read_b64_tr_b16 v[84:85], v21 offset:30720
    ds_read_b128 v[78:81], v16 offset:4096
    s_waitcnt lgkmcnt(10)
    v_mfma_f32_32x32x16_bf16 v[108:123], v[54:57], v[42:45], v[108:123]
    ds_read_b64_tr_b16 v[86:87], v22 offset:28672
    ds_read_b64_tr_b16 v[88:89], v22 offset:30720
    v_mfma_f32_32x32x16_bf16 v[124:139], v[50:53], v[46:49], v[124:139]
    v_mfma_f32_32x32x16_bf16 v[140:155], v[54:57], v[46:49], v[140:155]
    s_waitcnt lgkmcnt(9)
    v_mfma_f32_32x32x16_bf16 v[92:107], v[66:69], v[58:61], v[92:107]
    s_waitcnt lgkmcnt(6)
    v_mfma_f32_32x32x16_bf16 v[108:123], v[70:73], v[58:61], v[108:123]
    v_mfma_f32_32x32x16_bf16 v[124:139], v[66:69], v[62:65], v[124:139]
    v_mfma_f32_32x32x16_bf16 v[140:155], v[70:73], v[62:65], v[140:155]
    s_waitcnt lgkmcnt(3)
    v_mfma_f32_32x32x16_bf16 v[92:107], v[82:85], v[74:77], v[92:107]
    s_waitcnt lgkmcnt(0)
    v_mfma_f32_32x32x16_bf16 v[108:123], v[86:89], v[74:77], v[108:123]
    v_mfma_f32_32x32x16_bf16 v[124:139], v[82:85], v[78:81], v[124:139]
    v_mfma_f32_32x32x16_bf16 v[140:155], v[86:89], v[78:81], v[140:155]
    s_nop 15
    s_lshl_b32 s30, s25, 21
    s_lshl_b32 s31, s26, 17
    s_add_u32 s30, s30, s31
    s_lshl_b32 s31, s18, 16
    s_add_u32 s30, s30, s31
    s_lshl_b32 s31, s27, 8
    s_add_u32 s30, s30, s31
    s_lshl_b32 s31, s19, 7
    s_add_u32 s30, s30, s31
    s_add_u32 s31, s30, 32768
    s_lshl_b32 s28, s16, 13
    s_add_u32 s28, s28, 32768
    v_lshrrev_b32 v2, 5, v1
    v_and_b32 v3, 31, v1
    v_and_b32 v4, 7, v1
    v_xor_b32 v2, v2, v4
    v_lshlrev_b32 v2, 4, v2
    v_lshl_add_u32 v2, v3, 7, v2
    v_add_u32 v2, s28, v2
    v_xor_b32 v13, 0, v2
    v_xor_b32 v14, 32, v2
    v_xor_b32 v15, 64, v2
    v_xor_b32 v16, 96, v2
    v_lshrrev_b32 v3, 3, v1
    v_xor_b32 v2, v3, v4
    v_lshlrev_b32 v2, 4, v2
    v_lshl_add_u32 v2, v3, 7, v2
    v_add_u32 v2, s28, v2
    v_lshlrev_b32 v3, 10, v3
    v_lshl_add_u32 v3, v4, 4, v3
    v_cvt_pk_bf16_f32 v92, v92, v93
    v_cvt_pk_bf16_f32 v93, v94, v95
    v_cvt_pk_bf16_f32 v94, v96, v97
    v_cvt_pk_bf16_f32 v95, v98, v99
    v_cvt_pk_bf16_f32 v100, v100, v101
    v_cvt_pk_bf16_f32 v101, v102, v103
    v_cvt_pk_bf16_f32 v102, v104, v105
    v_cvt_pk_bf16_f32 v103, v106, v107
    v_cvt_pk_bf16_f32 v108, v108, v109
    v_cvt_pk_bf16_f32 v109, v110, v111
    v_cvt_pk_bf16_f32 v110, v112, v113
    v_cvt_pk_bf16_f32 v111, v114, v115
    v_cvt_pk_bf16_f32 v116, v116, v117
    v_cvt_pk_bf16_f32 v117, v118, v119
    v_cvt_pk_bf16_f32 v118, v120, v121
    v_cvt_pk_bf16_f32 v119, v122, v123
    s_nop 1
    v_permlane32_swap_b32 v92, v94
    v_permlane32_swap_b32 v93, v95
    v_permlane32_swap_b32 v100, v102
    v_permlane32_swap_b32 v101, v103
    v_permlane32_swap_b32 v108, v110
    v_permlane32_swap_b32 v109, v111
    v_permlane32_swap_b32 v116, v118
    v_permlane32_swap_b32 v117, v119
    s_nop 1
    ds_write_b128 v13, v[92:95] offset:0
    ds_write_b128 v14, v[100:103] offset:0
    ds_write_b128 v15, v[108:111] offset:0
    ds_write_b128 v16, v[116:119] offset:0
    ds_read_b128 v[96:99], v2 offset:0
    ds_read_b128 v[104:107], v2 offset:1024
    ds_read_b128 v[112:115], v2 offset:2048
    ds_read_b128 v[120:123], v2 offset:3072
    v_cvt_pk_bf16_f32 v124, v124, v125
    v_cvt_pk_bf16_f32 v125, v126, v127
    v_cvt_pk_bf16_f32 v126, v128, v129
    v_cvt_pk_bf16_f32 v127, v130, v131
    v_cvt_pk_bf16_f32 v132, v132, v133
    v_cvt_pk_bf16_f32 v133, v134, v135
    v_cvt_pk_bf16_f32 v134, v136, v137
    v_cvt_pk_bf16_f32 v135, v138, v139
    v_cvt_pk_bf16_f32 v140, v140, v141
    v_cvt_pk_bf16_f32 v141, v142, v143
    v_cvt_pk_bf16_f32 v142, v144, v145
    v_cvt_pk_bf16_f32 v143, v146, v147
    v_cvt_pk_bf16_f32 v148, v148, v149
    v_cvt_pk_bf16_f32 v149, v150, v151
    v_cvt_pk_bf16_f32 v150, v152, v153
    v_cvt_pk_bf16_f32 v151, v154, v155
    s_nop 1
    v_permlane32_swap_b32 v124, v126
    v_permlane32_swap_b32 v125, v127
    v_permlane32_swap_b32 v132, v134
    v_permlane32_swap_b32 v133, v135
    v_permlane32_swap_b32 v140, v142
    v_permlane32_swap_b32 v141, v143
    v_permlane32_swap_b32 v148, v150
    v_permlane32_swap_b32 v149, v151
    s_nop 1
    ds_write_b128 v13, v[124:127] offset:4096
    ds_write_b128 v14, v[132:135] offset:4096
    ds_write_b128 v15, v[140:143] offset:4096
    ds_write_b128 v16, v[148:151] offset:4096
    ds_read_b128 v[128:131], v2 offset:4096
    ds_read_b128 v[136:139], v2 offset:5120
    ds_read_b128 v[144:147], v2 offset:6144
    ds_read_b128 v[152:155], v2 offset:7168
    s_waitcnt lgkmcnt(8)
    buffer_store_dwordx4 v[96:99], v3, s[12:15], s30 offen sc1
    s_add_u32 s30, s30, 8192
    buffer_store_dwordx4 v[104:107], v3, s[12:15], s30 offen sc1
    s_add_u32 s30, s30, 8192
    buffer_store_dwordx4 v[112:115], v3, s[12:15], s30 offen sc1
    s_add_u32 s30, s30, 8192
    buffer_store_dwordx4 v[120:123], v3, s[12:15], s30 offen sc1
    s_add_u32 s30, s30, 8192
    s_waitcnt lgkmcnt(0)
    buffer_store_dwordx4 v[128:131], v3, s[12:15], s30 offen sc1
    s_add_u32 s30, s30, 8192
    buffer_store_dwordx4 v[136:139], v3, s[12:15], s30 offen sc1
    s_add_u32 s30, s30, 8192
    buffer_store_dwordx4 v[144:147], v3, s[12:15], s30 offen sc1
    s_add_u32 s30, s30, 8192
    buffer_store_dwordx4 v[152:155], v3, s[12:15], s30 offen sc1
    s_add_u32 s30, s30, 8192
    s_endpgm
.globl ln2_kernel
.p2align 8
.type ln2_kernel,@function
ln2_kernel:
    s_cmp_lt_u32 s2, 512
    s_cbranch_scc1 ln2_kernel_L1
    s_endpgm
ln2_kernel_L1:
    s_load_dwordx2 s[4:5], s[0:1], 0
    s_load_dwordx2 s[8:9], s[0:1], 112
    s_load_dwordx2 s[12:13], s[0:1], 112
    s_load_dwordx2 s[16:17], s[0:1], 112
    s_load_dwordx2 s[20:21], s[0:1], 112
    v_lshrrev_b32 v1, 6, v0
    s_nop 0
    v_readfirstlane_b32 s24, v1
    v_and_b32 v1, 63, v0
    s_waitcnt lgkmcnt(0)
    s_and_b32 s5, s5, 0xffff
    s_mov_b32 s6, 0x200000
    s_mov_b32 s7, 0x20000
    s_add_u32 s8, s8, 0x400000
    s_addc_u32 s9, s9, 0
    s_and_b32 s9, s9, 0xffff
    s_mov_b32 s10, 0x800000
    s_mov_b32 s11, 0x20000
    s_and_b32 s13, s13, 0xffff
    s_mov_b32 s14, 0x3000
    s_mov_b32 s15, 0x20000
    s_add_u32 s16, s16, 0x1400000
    s_addc_u32 s17, s17, 0
    s_and_b32 s17, s17, 0xffff
    s_mov_b32 s18, 0x200000
    s_mov_b32 s19, 0x20000
    s_add_u32 s20, s20, 0x1600000
    s_addc_u32 s21, s21, 0
    s_and_b32 s21, s21, 0xffff
    s_mov_b32 s22, 0x200000
    s_mov_b32 s23, 0x20000
    v_lshlrev_b32 v2, 4, v1
    v_lshlrev_b32 v3, 5, v1
    s_lshl_b32 s25, s2, 2
    s_add_u32 s25, s25, s24
    s_lshl_b32 s25, s25, 10
    s_mov_b32 s26, s25
    buffer_load_dwordx4 v[84:87], v2, s[8:11], s26 offen
    s_add_u32 s26, s26, 0x200000
    buffer_load_dwordx4 v[88:91], v2, s[8:11], s26 offen
    s_add_u32 s26, s26, 0x200000
    buffer_load_dwordx4 v[92:95], v2, s[8:11], s26 offen
    s_add_u32 s26, s26, 0x200000
    buffer_load_dwordx4 v[96:99], v2, s[8:11], s26 offen
    s_add_u32 s26, s26, 0x200000
    buffer_load_dwordx4 v[36:39], v2, s[4:7], s25 offen
    s_mov_b32 s27, 4096
    buffer_load_dwordx4 v[40:43], v3, s[12:15], s27 offen offset:0
    buffer_load_dwordx4 v[44:47], v3, s[12:15], s27 offen offset:16
    s_mov_b32 s27, 6144
    buffer_load_dwordx4 v[48:51], v3, s[12:15], s27 offen offset:0
    buffer_load_dwordx4 v[52:55], v3, s[12:15], s27 offen offset:16
    s_mov_b32 s27, 8192
    buffer_load_dwordx4 v[56:59], v3, s[12:15], s27 offen offset:0
    buffer_load_dwordx4 v[60:63], v3, s[12:15], s27 offen offset:16
    s_waitcnt vmcnt(4)
    v_lshlrev_b32 v4, 16, v84
    v_and_b32 v5, 0xffff0000, v84
    v_lshlrev_b32 v6, 16, v85
    v_and_b32 v7, 0xffff0000, v85
    v_lshlrev_b32 v8, 16, v86
    v_and_b32 v9, 0xffff0000, v86
    v_lshlrev_b32 v10, 16, v87
    v_and_b32 v11, 0xffff0000, v87
    v_lshlrev_b32 v12, 16, v88
    v_and_b32 v13, 0xffff0000, v88
    v_lshlrev_b32 v14, 16, v89
    v_and_b32 v15, 0xffff0000, v89
    v_lshlrev_b32 v16, 16, v90
    v_and_b32 v17, 0xffff0000, v90
    v_lshlrev_b32 v18, 16, v91
    v_and_b32 v19, 0xffff0000, v91
    v_lshlrev_b32 v20, 16, v92
    v_and_b32 v21, 0xffff0000, v92
    v_lshlrev_b32 v22, 16, v93
    v_and_b32 v23, 0xffff0000, v93
    v_lshlrev_b32 v24, 16, v94
    v_and_b32 v25, 0xffff0000, v94
    v_lshlrev_b32 v26, 16, v95
    v_and_b32 v27, 0xffff0000, v95
    v_lshlrev_b32 v28, 16, v96
    v_and_b32 v29, 0xffff0000, v96
    v_lshlrev_b32 v30, 16, v97
    v_and_b32 v31, 0xffff0000, v97
    v_lshlrev_b32 v32, 16, v98
    v_and_b32 v33, 0xffff0000, v98
    v_lshlrev_b32 v34, 16, v99
    v_and_b32 v35, 0xffff0000, v99
    v_add_f32 v4, v4, v12
    v_add_f32 v5, v5, v13
    v_add_f32 v6, v6, v14
    v_add_f32 v7, v7, v15
    v_add_f32 v8, v8, v16
    v_add_f32 v9, v9, v17
    v_add_f32 v10, v10, v18
    v_add_f32 v11, v11, v19
    v_add_f32 v4, v4, v20
    v_add_f32 v5, v5, v21
    v_add_f32 v6, v6, v22
    v_add_f32 v7, v7, v23
    v_add_f32 v8, v8, v24
    v_add_f32 v9, v9, v25
    v_add_f32 v10, v10, v26
    v_add_f32 v11, v11, v27
    v_add_f32 v4, v4, v28
    v_add_f32 v5, v5, v29
    v_add_f32 v6, v6, v30
    v_add_f32 v7, v7, v31
    v_add_f32 v8, v8, v32
    v_add_f32 v9, v9, v33
    v_add_f32 v10, v10, v34
    v_add_f32 v11, v11, v35
    v_cvt_pk_bf16_f32 v76, v4, v5
    v_cvt_pk_bf16_f32 v77, v6, v7
    v_cvt_pk_bf16_f32 v78, v8, v9
    v_cvt_pk_bf16_f32 v79, v10, v11
    v_lshlrev_b32 v4, 16, v76
    v_and_b32 v5, 0xffff0000, v76
    v_lshlrev_b32 v6, 16, v77
    v_and_b32 v7, 0xffff0000, v77
    v_lshlrev_b32 v8, 16, v78
    v_and_b32 v9, 0xffff0000, v78
    v_lshlrev_b32 v10, 16, v79
    v_and_b32 v11, 0xffff0000, v79
    v_lshlrev_b32 v64, 16, v36
    v_and_b32 v65, 0xffff0000, v36
    v_lshlrev_b32 v66, 16, v37
    v_and_b32 v67, 0xffff0000, v37
    v_lshlrev_b32 v68, 16, v38
    v_and_b32 v69, 0xffff0000, v38
    v_lshlrev_b32 v70, 16, v39
    v_and_b32 v71, 0xffff0000, v39
    v_mul_f32 v4, v4, v40
    v_mul_f32 v5, v5, v41
    v_mul_f32 v6, v6, v42
    v_mul_f32 v7, v7, v43
    v_mul_f32 v8, v8, v44
    v_mul_f32 v9, v9, v45
    v_mul_f32 v10, v10, v46
    v_mul_f32 v11, v11, v47
    v_cvt_pk_bf16_f32 v76, v4, v5
    v_cvt_pk_bf16_f32 v77, v6, v7
    v_cvt_pk_bf16_f32 v78, v8, v9
    v_cvt_pk_bf16_f32 v79, v10, v11
    v_lshlrev_b32 v4, 16, v76
    v_and_b32 v5, 0xffff0000, v76
    v_lshlrev_b32 v6, 16, v77
    v_and_b32 v7, 0xffff0000, v77
    v_lshlrev_b32 v8, 16, v78
    v_and_b32 v9, 0xffff0000, v78
    v_lshlrev_b32 v10, 16, v79
    v_and_b32 v11, 0xffff0000, v79
    v_add_f32 v64, v64, v4
    v_add_f32 v65, v65, v5
    v_add_f32 v66, v66, v6
    v_add_f32 v67, v67, v7
    v_add_f32 v68, v68, v8
    v_add_f32 v69, v69, v9
    v_add_f32 v70, v70, v10
    v_add_f32 v71, v71, v11
    v_cvt_pk_bf16_f32 v76, v64, v65
    v_cvt_pk_bf16_f32 v77, v66, v67
    v_cvt_pk_bf16_f32 v78, v68, v69
    v_cvt_pk_bf16_f32 v79, v70, v71
    v_lshlrev_b32 v64, 16, v76
    v_and_b32 v65, 0xffff0000, v76
    v_lshlrev_b32 v66, 16, v77
    v_and_b32 v67, 0xffff0000, v77
    v_lshlrev_b32 v68, 16, v78
    v_and_b32 v69, 0xffff0000, v78
    v_lshlrev_b32 v70, 16, v79
    v_and_b32 v71, 0xffff0000, v79
    buffer_store_dwordx4 v[76:79], v2, s[16:19], s25 offen sc1
    s_waitcnt vmcnt(1)
    s_waitcnt vmcnt(0)
    v_add_f32 v72, v64, v65
    v_add_f32 v72, v72, v66
    v_add_f32 v72, v72, v67
    v_add_f32 v72, v72, v68
    v_add_f32 v72, v72, v69
    v_add_f32 v72, v72, v70
    v_add_f32 v72, v72, v71
    s_nop 1
    v_add_f32_dpp v72, v72, v72 row_ror:8 row_mask:0xf bank_mask:0xf
    s_nop 1
    v_add_f32_dpp v72, v72, v72 row_ror:4 row_mask:0xf bank_mask:0xf
    s_nop 1
    v_add_f32_dpp v72, v72, v72 row_ror:2 row_mask:0xf bank_mask:0xf
    s_nop 1
    v_add_f32_dpp v72, v72, v72 row_ror:1 row_mask:0xf bank_mask:0xf
    v_mov_b32 v73, v72
    s_nop 1
    v_permlane16_swap_b32 v73, v72
    s_nop 1
    v_add_f32 v72, v72, v73
    v_mov_b32 v73, v72
    s_nop 1
    v_permlane32_swap_b32 v73, v72
    s_nop 1
    v_add_f32 v72, v72, v73
    v_mul_f32 v72, 0x3b000000, v72
    v_sub_f32 v64, v64, v72
    v_sub_f32 v65, v65, v72
    v_sub_f32 v66, v66, v72
    v_sub_f32 v67, v67, v72
    v_sub_f32 v68, v68, v72
    v_sub_f32 v69, v69, v72
    v_sub_f32 v70, v70, v72
    v_sub_f32 v71, v71, v72
    v_mul_f32 v72, v64, v64
    v_fmac_f32 v72, v65, v65
    v_fmac_f32 v72, v66, v66
    v_fmac_f32 v72, v67, v67
    v_fmac_f32 v72, v68, v68
    v_fmac_f32 v72, v69, v69
    v_fmac_f32 v72, v70, v70
    v_fmac_f32 v72, v71, v71
    s_nop 1
    v_add_f32_dpp v72, v72, v72 row_ror:8 row_mask:0xf bank_mask:0xf
    s_nop 1
    v_add_f32_dpp v72, v72, v72 row_ror:4 row_mask:0xf bank_mask:0xf
    s_nop 1
    v_add_f32_dpp v72, v72, v72 row_ror:2 row_mask:0xf bank_mask:0xf
    s_nop 1
    v_add_f32_dpp v72, v72, v72 row_ror:1 row_mask:0xf bank_mask:0xf
    v_mov_b32 v73, v72
    s_nop 1
    v_permlane16_swap_b32 v73, v72
    s_nop 1
    v_add_f32 v72, v72, v73
    v_mov_b32 v73, v72
    s_nop 1
    v_permlane32_swap_b32 v73, v72
    s_nop 1
    v_add_f32 v72, v72, v73
    v_mov_b32 v73, 0x3727c5ac
    v_fmac_f32 v73, 0x3b000000, v72
    v_rsq_f32 v72, v73
    s_nop 0
    v_mul_f32 v64, v64, v72
    v_add_f32 v56, 1.0, v56
    v_fma_f32 v64, v64, v56, v48
    v_mul_f32 v65, v65, v72
    v_add_f32 v57, 1.0, v57
    v_fma_f32 v65, v65, v57, v49
    v_mul_f32 v66, v66, v72
    v_add_f32 v58, 1.0, v58
    v_fma_f32 v66, v66, v58, v50
    v_mul_f32 v67, v67, v72
    v_add_f32 v59, 1.0, v59
    v_fma_f32 v67, v67, v59, v51
    v_mul_f32 v68, v68, v72
    v_add_f32 v60, 1.0, v60
    v_fma_f32 v68, v68, v60, v52
    v_mul_f32 v69, v69, v72
    v_add_f32 v61, 1.0, v61
    v_fma_f32 v69, v69, v61, v53
    v_mul_f32 v70, v70, v72
    v_add_f32 v62, 1.0, v62
    v_fma_f32 v70, v70, v62, v54
    v_mul_f32 v71, v71, v72
    v_add_f32 v63, 1.0, v63
    v_fma_f32 v71, v71, v63, v55
    v_cvt_pk_bf16_f32 v80, v64, v65
    v_cvt_pk_bf16_f32 v81, v66, v67
    v_cvt_pk_bf16_f32 v82, v68, v69
    v_cvt_pk_bf16_f32 v83, v70, v71
    buffer_store_dwordx4 v[80:83], v2, s[20:23], s25 offen sc1
    s_endpgm
.globl gu_kernel
.p2align 8
.type gu_kernel,@function
gu_kernel:
    s_cmp_lt_u32 s2, 224
    s_cbranch_scc1 gu_kernel_L1
    s_endpgm
gu_kernel_L1:
    s_load_dwordx2 s[4:5], s[0:1], 112
    s_load_dwordx2 s[8:9], s[0:1], 56
    s_load_dwordx2 s[12:13], s[0:1], 64
    s_load_dwordx2 s[16:17], s[0:1], 112
    v_lshrrev_b32 v1, 6, v0
    s_nop 0
    v_readfirstlane_b32 s20, v1
    v_and_b32 v1, 63, v0
    s_waitcnt lgkmcnt(0)
    s_add_u32 s4, s4, 0x1600000
    s_addc_u32 s5, s5, 0
    s_and_b32 s5, s5, 0xffff
    s_mov_b32 s6, 0x200000
    s_mov_b32 s7, 0x20000
    s_and_b32 s9, s9, 0xffff
    s_mov_b32 s10, 0x1c0000
    s_mov_b32 s11, 0x20000
    s_and_b32 s13, s13, 0xffff
    s_mov_b32 s14, 0x1c0000
    s_mov_b32 s15, 0x20000
    s_add_u32 s16, s16, 0x2400000
    s_addc_u32 s17, s17, 0
    s_and_b32 s17, s17, 0xffff
    s_mov_b32 s18, 0x700000
    s_mov_b32 s19, 0x20000
    s_lshl_b32 s21, s20, 10
    s_lshr_b32 s22, s20, 2
    s_and_b32 s23, s20, 3
    s_lshl_b32 s24, s20, 2
    v_lshrrev_b32 v2, 4, v1
    v_add_u32 v2, s24, v2
    v_xor_b32 v2, v2, v1
    v_and_b32 v2, 7, v2
    v_lshlrev_b32 v2, 4, v2
    s_lshl_b32 s24, s20, 3
    v_lshrrev_b32 v3, 3, v1
    v_add_u32 v3, s24, v3
    s_mov_b32 s24, 1024
    v_mul_lo_u32 v3, v3, s24
    v_add_u32 v5, v2, v3
    v_add_u32 v6, 65536, v5
    v_lshrrev_b32 v3, 4, v1
    v_lshlrev_b32 v2, 2, v3
    v_xor_b32 v2, v2, v1
    v_and_b32 v2, 15, v2
    v_lshlrev_b32 v2, 4, v2
    s_mul_i32 s24, s20, 4
    v_add_u32 v3, s24, v3
    s_mov_b32 s24, 3584
    v_mul_lo_u32 v3, v3, s24
    v_add_u32 v7, v2, v3
    v_add_u32 v10, 114688, v7
    v_add_u32 v9, 0, v7
    v_add_u32 v8, 114688, v7
    v_lshrrev_b32 v2, 5, v1
    v_bfe_u32 v3, v1, 1, 3
    v_xor_b32 v2, v2, v3
    v_lshlrev_b32 v2, 4, v2
    v_and_b32 v3, 31, v1
    v_lshl_add_u32 v2, v3, 7, v2
    s_mul_i32 s24, s22, 8192
    v_add_u32 v2, s24, v2
    v_xor_b32 v11, 0, v2
    v_xor_b32 v12, 32, v2
    v_xor_b32 v13, 64, v2
    v_xor_b32 v14, 96, v2
    v_xor_b32 v15, 0, v2
    v_add_u32 v15, 65536, v15
    v_xor_b32 v16, 32, v2
    v_add_u32 v16, 65536, v16
    v_xor_b32 v17, 64, v2
    v_add_u32 v17, 65536, v17
    v_xor_b32 v18, 96, v2
    v_add_u32 v18, 65536, v18
    v_xor_b32 v19, 0, v2
    v_add_u32 v19, 131072, v19
    v_xor_b32 v20, 32, v2
    v_add_u32 v20, 131072, v20
    v_xor_b32 v21, 64, v2
    v_add_u32 v21, 131072, v21
    v_xor_b32 v22, 96, v2
    v_add_u32 v22, 131072, v22
    v_lshrrev_b32 v2, 5, v1
    v_lshlrev_b32 v2, 3, v2
    v_bfe_u32 v3, v1, 2, 2
    v_add_u32 v2, v2, v3
    v_mul_u32_u24 v2, 256, v2
    v_bfe_u32 v4, v1, 4, 1
    v_lshl_add_u32 v2, v4, 5, v2
    v_and_b32 v4, 3, v1
    v_lshl_add_u32 v2, v4, 3, v2
    s_mul_i32 s24, s23, 1
    s_add_u32 s24, s24, 0
    s_and_b32 s25, s24, 3
    v_xor_b32 v4, s25, v3
    v_lshl_add_u32 v4, v4, 6, v2
    s_lshr_b32 s24, s24, 2
    s_mul_i32 s24, s24, 16384
    v_add_u32 v23, s24, v4
    v_add_u32 v25, s24, v4
    v_add_u32 v25, 65536, v25
    v_add_u32 v27, s24, v4
    v_add_u32 v27, 131072, v27
    s_mul_i32 s24, s23, 1
    s_add_u32 s24, s24, 4
    s_and_b32 s25, s24, 3
    v_xor_b32 v4, s25, v3
    v_lshl_add_u32 v4, v4, 6, v2
    s_lshr_b32 s24, s24, 2
    s_mul_i32 s24, s24, 16384
    v_add_u32 v24, s24, v4
    v_add_u32 v26, s24, v4
    v_add_u32 v26, 65536, v26
    v_add_u32 v28, s24, v4
    v_add_u32 v28, 131072, v28
    s_lshr_b32 s28, s2, 3
    s_mov_b32 s28, 0
    s_and_b32 s28, s28, 7
    s_and_b32 s29, s2, 15
    s_lshr_b32 s30, s2, 4
    s_lshl_b32 s31, s29, 17
    s_lshl_b32 s32, s30, 8
    s_lshl_b32 s26, s28, 7
    s_add_u32 s26, s26, s31
    s_add_u32 m0, s21, 0
    s_nop 0
    buffer_load_dwordx4 v5, s[4:7], s26 offen lds
    s_add_u32 m0, s21, 8192
    s_nop 0
    buffer_load_dwordx4 v6, s[4:7], s26 offen lds
    s_mul_i32 s27, s28, 229376
    s_add_u32 s27, s27, s32
    s_add_u32 s28, s28, 1
    s_cmp_eq_u32 s28, 8
    s_cselect_b32 s28, 0, s28
    s_add_u32 m0, s21, 16384
    s_nop 0
    buffer_load_dwordx4 v7, s[8:11], s27 offen lds
    s_add_u32 m0, s21, 24576
    s_nop 0
    buffer_load_dwordx4 v8, s[8:11], s27 offen lds
    s_add_u32 m0, s21, 32768
    s_nop 0
    buffer_load_dwordx4 v9, s[12:15], s27 offen lds
    s_add_u32 m0, s21, 40960
    s_nop 0
    buffer_load_dwordx4 v10, s[12:15], s27 offen lds
    s_lshl_b32 s26, s28, 7
    s_add_u32 s26, s26, s31
    s_add_u32 m0, s21, 49152
    s_nop 0
    buffer_load_dwordx4 v5, s[4:7], s26 offen lds
    s_add_u32 m0, s21, 57344
    s_nop 0
    buffer_load_dwordx4 v6, s[4:7], s26 offen lds
    s_mul_i32 s27, s28, 229376
    s_add_u32 s27, s27, s32
    s_add_u32 s28, s28, 1
    s_cmp_eq_u32 s28, 8
    s_cselect_b32 s28, 0, s28
    s_add_u32 m0, s21, 65536
    s_nop 0
    buffer_load_dwordx4 v7, s[8:11], s27 offen lds
    s_add_u32 m0, s21, 73728
    s_nop 0
    buffer_load_dwordx4 v8, s[8:11], s27 offen lds
    s_add_u32 m0, s21, 81920
    s_nop 0
    buffer_load_dwordx4 v9, s[12:15], s27 offen lds
    s_add_u32 m0, s21, 90112
    s_nop 0
    buffer_load_dwordx4 v10, s[12:15], s27 offen lds
    s_lshl_b32 s26, s28, 7
    s_add_u32 s26, s26, s31
    s_add_u32 m0, s21, 98304
    s_nop 0
    buffer_load_dwordx4 v5, s[4:7], s26 offen lds
    s_add_u32 m0, s21, 106496
    s_nop 0
    buffer_load_dwordx4 v6, s[4:7], s26 offen lds
    s_mul_i32 s27, s28, 229376
    s_add_u32 s27, s27, s32
    s_add_u32 s28, s28, 1
    s_cmp_eq_u32 s28, 8
    s_cselect_b32 s28, 0, s28
    s_add_u32 m0, s21, 114688
    s_nop 0
    buffer_load_dwordx4 v7, s[8:11], s27 offen lds
    s_add_u32 m0, s21, 122880
    s_nop 0
    buffer_load_dwordx4 v8, s[8:11], s27 offen lds
    s_add_u32 m0, s21, 131072
    s_nop 0
    buffer_load_dwordx4 v9, s[12:15], s27 offen lds
    s_add_u32 m0, s21, 139264
    s_nop 0
    buffer_load_dwordx4 v10, s[12:15], s27 offen lds
    s_waitcnt vmcnt(12)
    s_barrier
    ds_read_b128 v[30:33], v11 offset:0
    ds_read_b64_tr_b16 v[38:39], v23 offset:16384
    ds_read_b64_tr_b16 v[40:41], v23 offset:17408
    ds_read_b128 v[34:37], v11 offset:4096
    ds_read_b64_tr_b16 v[42:43], v24 offset:16384
    ds_read_b64_tr_b16 v[44:45], v24 offset:17408
    ds_read_b128 v[46:49], v12 offset:0
    ds_read_b64_tr_b16 v[54:55], v23 offset:20480
    ds_read_b64_tr_b16 v[56:57], v23 offset:21504
    ds_read_b128 v[50:53], v12 offset:4096
    ds_read_b64_tr_b16 v[58:59], v24 offset:20480
    ds_read_b64_tr_b16 v[60:61], v24 offset:21504
    s_waitcnt lgkmcnt(9)
    v_mfma_f32_32x32x16_bf16 v[96:111], v[38:41], v[30:33], 0
    ds_read_b128 v[62:65], v13 offset:0
    ds_read_b64_tr_b16 v[70:71], v23 offset:24576
    s_waitcnt lgkmcnt(8)
    v_mfma_f32_32x32x16_bf16 v[112:127], v[42:45], v[30:33], 0
    ds_read_b64_tr_b16 v[72:73], v23 offset:25600
    ds_read_b128 v[66:69], v13 offset:4096
    v_mfma_f32_32x32x16_bf16 v[128:143], v[38:41], v[34:37], 0
    ds_read_b64_tr_b16 v[74:75], v24 offset:24576
    ds_read_b64_tr_b16 v[76:77], v24 offset:25600
    v_mfma_f32_32x32x16_bf16 v[144:159], v[42:45], v[34:37], 0
    ds_read_b128 v[78:81], v14 offset:0
    ds_read_b64_tr_b16 v[86:87], v23 offset:28672
    s_waitcnt lgkmcnt(11)
    v_mfma_f32_32x32x16_bf16 v[96:111], v[54:57], v[46:49], v[96:111]
    ds_read_b64_tr_b16 v[88:89], v23 offset:29696
    ds_read_b128 v[82:85], v14 offset:4096
    s_waitcnt lgkmcnt(10)
    v_mfma_f32_32x32x16_bf16 v[112:127], v[58:61], v[46:49], v[112:127]
    ds_read_b64_tr_b16 v[90:91], v24 offset:28672
    ds_read_b64_tr_b16 v[92:93], v24 offset:29696
    v_mfma_f32_32x32x16_bf16 v[128:143], v[54:57], v[50:53], v[128:143]
    v_mfma_f32_32x32x16_bf16 v[144:159], v[58:61], v[50:53], v[144:159]
    s_waitcnt lgkmcnt(0)
    s_waitcnt vmcnt(6)
    s_barrier
    ds_read_b128 v[30:33], v11 offset:49152
    ds_read_b64_tr_b16 v[38:39], v25 offset:0
    ds_read_b64_tr_b16 v[40:41], v25 offset:1024
    ds_read_b128 v[34:37], v11 offset:53248
    ds_read_b64_tr_b16 v[42:43], v26 offset:0
    ds_read_b64_tr_b16 v[44:45], v26 offset:1024
    ds_read_b128 v[46:49], v12 offset:49152
    ds_read_b64_tr_b16 v[54:55], v25 offset:4096
    ds_read_b64_tr_b16 v[56:57], v25 offset:5120
    ds_read_b128 v[50:53], v12 offset:53248
    ds_read_b64_tr_b16 v[58:59], v26 offset:4096
    ds_read_b64_tr_b16 v[60:61], v26 offset:5120
    v_mfma_f32_32x32x16_bf16 v[96:111], v[70:73], v[62:65], v[96:111]
    s_lshl_b32 s26, s28, 7
    s_add_u32 s26, s26, s31
    s_add_u32 m0, s21, 0
    s_nop 0
    buffer_load_dwordx4 v5, s[4:7], s26 offen lds
    v_mfma_f32_32x32x16_bf16 v[112:127], v[74:77], v[62:65], v[112:127]
    s_add_u32 m0, s21, 8192
    s_nop 0
    buffer_load_dwordx4 v6, s[4:7], s26 offen lds
    v_mfma_f32_32x32x16_bf16 v[128:143], v[70:73], v[66:69], v[128:143]
    s_mul_i32 s27, s28, 229376
    s_add_u32 s27, s27, s32
    s_add_u32 s28, s28, 1
    s_cmp_eq_u32 s28, 8
    s_cselect_b32 s28, 0, s28
    s_add_u32 m0, s21, 16384
    s_nop 0
    buffer_load_dwordx4 v7, s[8:11], s27 offen lds
    v_mfma_f32_32x32x16_bf16 v[144:159], v[74:77], v[66:69], v[144:159]
    s_add_u32 m0, s21, 24576
    s_nop 0
    buffer_load_dwordx4 v8, s[8:11], s27 offen lds
    v_mfma_f32_32x32x16_bf16 v[96:111], v[86:89], v[78:81], v[96:111]
    s_add_u32 m0, s21, 32768
    s_nop 0
    buffer_load_dwordx4 v9, s[12:15], s27 offen lds
    v_mfma_f32_32x32x16_bf16 v[112:127], v[90:93], v[78:81], v[112:127]
    s_add_u32 m0, s21, 40960
    s_nop 0
    buffer_load_dwordx4 v10, s[12:15], s27 offen lds
    v_mfma_f32_32x32x16_bf16 v[128:143], v[86:89], v[82:85], v[128:143]
    v_mfma_f32_32x32x16_bf16 v[144:159], v[90:93], v[82:85], v[144:159]
    s_waitcnt lgkmcnt(9)
    v_mfma_f32_32x32x16_bf16 v[96:111], v[38:41], v[30:33], v[96:111]
    ds_read_b128 v[62:65], v13 offset:49152
    ds_read_b64_tr_b16 v[70:71], v25 offset:8192
    s_waitcnt lgkmcnt(8)
    v_mfma_f32_32x32x16_bf16 v[112:127], v[42:45], v[30:33], v[112:127]
    ds_read_b64_tr_b16 v[72:73], v25 offset:9216
    ds_read_b128 v[66:69], v13 offset:53248
    v_mfma_f32_32x32x16_bf16 v[128:143], v[38:41], v[34:37], v[128:143]
    ds_read_b64_tr_b16 v[74:75], v26 offset:8192
    ds_read_b64_tr_b16 v[76:77], v26 offset:9216
    v_mfma_f32_32x32x16_bf16 v[144:159], v[42:45], v[34:37], v[144:159]
    ds_read_b128 v[78:81], v14 offset:49152
    ds_read_b64_tr_b16 v[86:87], v25 offset:12288
    s_waitcnt lgkmcnt(11)
    v_mfma_f32_32x32x16_bf16 v[96:111], v[54:57], v[46:49], v[96:111]
    ds_read_b64_tr_b16 v[88:89], v25 offset:13312
    ds_read_b128 v[82:85], v14 offset:53248
    s_waitcnt lgkmcnt(10)
    v_mfma_f32_32x32x16_bf16 v[112:127], v[58:61], v[46:49], v[112:127]
    ds_read_b64_tr_b16 v[90:91], v26 offset:12288
    ds_read_b64_tr_b16 v[92:93], v26 offset:13312
    v_mfma_f32_32x32x16_bf16 v[128:143], v[54:57], v[50:53], v[128:143]
    v_mfma_f32_32x32x16_bf16 v[144:159], v[58:61], v[50:53], v[144:159]
    s_waitcnt lgkmcnt(0)
    s_waitcnt vmcnt(6)
    s_barrier
    ds_read_b128 v[30:33], v15 offset:32768
    ds_read_b64_tr_b16 v[38:39], v25 offset:49152
    ds_read_b64_tr_b16 v[40:41], v25 offset:50176
    ds_read_b128 v[34:37], v15 offset:36864
    ds_read_b64_tr_b16 v[42:43], v26 offset:49152
    ds_read_b64_tr_b16 v[44:45], v26 offset:50176
    ds_read_b128 v[46:49], v16 offset:32768
    ds_read_b64_tr_b16 v[54:55], v25 offset:53248
    ds_read_b64_tr_b16 v[56:57], v25 offset:54272
    ds_read_b128 v[50:53], v16 offset:36864
    ds_read_b64_tr_b16 v[58:59], v26 offset:53248
    ds_read_b64_tr_b16 v[60:61], v26 offset:54272
    v_mfma_f32_32x32x16_bf16 v[96:111], v[70:73], v[62:65], v[96:111]
    s_lshl_b32 s26, s28, 7
    s_add_u32 s26, s26, s31
    s_add_u32 m0, s21, 49152
    s_nop 0
    buffer_load_dwordx4 v5, s[4:7], s26 offen lds
    v_mfma_f32_32x32x16_bf16 v[112:127], v[74:77], v[62:65], v[112:127]
    s_add_u32 m0, s21, 57344
    s_nop 0
    buffer_load_dwordx4 v6, s[4:7], s26 offen lds
    v_mfma_f32_32x32x16_bf16 v[128:143], v[70:73], v[66:69], v[128:143]
    s_mul_i32 s27, s28, 229376
    s_add_u32 s27, s27, s32
    s_add_u32 s28, s28, 1
    s_cmp_eq_u32 s28, 8
    s_cselect_b32 s28, 0, s28
    s_add_u32 m0, s21, 65536
    s_nop 0
    buffer_load_dwordx4 v7, s[8:11], s27 offen lds
    v_mfma_f32_32x32x16_bf16 v[144:159], v[74:77], v[66:69], v[144:159]
    s_add_u32 m0, s21, 73728
    s_nop 0
    buffer_load_dwordx4 v8, s[8:11], s27 offen lds
    v_mfma_f32_32x32x16_bf16 v[96:111], v[86:89], v[78:81], v[96:111]
    s_add_u32 m0, s21, 81920
    s_nop 0
    buffer_load_dwordx4 v9, s[12:15], s27 offen lds
    v_mfma_f32_32x32x16_bf16 v[112:127], v[90:93], v[78:81], v[112:127]
    s_add_u32 m0, s21, 90112
    s_nop 0
    buffer_load_dwordx4 v10, s[12:15], s27 offen lds
    v_mfma_f32_32x32x16_bf16 v[128:143], v[86:89], v[82:85], v[128:143]
    v_mfma_f32_32x32x16_bf16 v[144:159], v[90:93], v[82:85], v[144:159]
    s_waitcnt lgkmcnt(9)
    v_mfma_f32_32x32x16_bf16 v[96:111], v[38:41], v[30:33], v[96:111]
    ds_read_b128 v[62:65], v17 offset:32768
    ds_read_b64_tr_b16 v[70:71], v25 offset:57344
    s_waitcnt lgkmcnt(8)
    v_mfma_f32_32x32x16_bf16 v[112:127], v[42:45], v[30:33], v[112:127]
    ds_read_b64_tr_b16 v[72:73], v25 offset:58368
    ds_read_b128 v[66:69], v17 offset:36864
    v_mfma_f32_32x32x16_bf16 v[128:143], v[38:41], v[34:37], v[128:143]
    ds_read_b64_tr_b16 v[74:75], v26 offset:57344
    ds_read_b64_tr_b16 v[76:77], v26 offset:58368
    v_mfma_f32_32x32x16_bf16 v[144:159], v[42:45], v[34:37], v[144:159]
    ds_read_b128 v[78:81], v18 offset:32768
    ds_read_b64_tr_b16 v[86:87], v25 offset:61440
    s_waitcnt lgkmcnt(11)
    v_mfma_f32_32x32x16_bf16 v[96:111], v[54:57], v[46:49], v[96:111]
    ds_read_b64_tr_b16 v[88:89], v25 offset:62464
    ds_read_b128 v[82:85], v18 offset:36864
    s_waitcnt lgkmcnt(10)
    v_mfma_f32_32x32x16_bf16 v[112:127], v[58:61], v[46:49], v[112:127]
    ds_read_b64_tr_b16 v[90:91], v26 offset:61440
    ds_read_b64_tr_b16 v[92:93], v26 offset:62464
    v_mfma_f32_32x32x16_bf16 v[128:143], v[54:57], v[50:53], v[128:143]
    v_mfma_f32_32x32x16_bf16 v[144:159], v[58:61], v[50:53], v[144:159]
    s_waitcnt lgkmcnt(0)
    s_waitcnt vmcnt(6)
    s_barrier
    ds_read_b128 v[30:33], v11 offset:0
    ds_read_b64_tr_b16 v[38:39], v23 offset:16384
    ds_read_b64_tr_b16 v[40:41], v23 offset:17408
    ds_read_b128 v[34:37], v11 offset:4096
    ds_read_b64_tr_b16 v[42:43], v24 offset:16384
    ds_read_b64_tr_b16 v[44:45], v24 offset:17408
    ds_read_b128 v[46:49], v12 offset:0
    ds_read_b64_tr_b16 v[54:55], v23 offset:20480
    ds_read_b64_tr_b16 v[56:57], v23 offset:21504
    ds_read_b128 v[50:53], v12 offset:4096
    ds_read_b64_tr_b16 v[58:59], v24 offset:20480
    ds_read_b64_tr_b16 v[60:61], v24 offset:21504
    v_mfma_f32_32x32x16_bf16 v[96:111], v[70:73], v[62:65], v[96:111]
    s_lshl_b32 s26, s28, 7
    s_add_u32 s26, s26, s31
    s_add_u32 m0, s21, 98304
    s_nop 0
    buffer_load_dwordx4 v5, s[4:7], s26 offen lds
    v_mfma_f32_32x32x16_bf16 v[112:127], v[74:77], v[62:65], v[112:127]
    s_add_u32 m0, s21, 106496
    s_nop 0
    buffer_load_dwordx4 v6, s[4:7], s26 offen lds
    v_mfma_f32_32x32x16_bf16 v[128:143], v[70:73], v[66:69], v[128:143]
    s_mul_i32 s27, s28, 229376
    s_add_u32 s27, s27, s32
    s_add_u32 s28, s28, 1
    s_cmp_eq_u32 s28, 8
    s_cselect_b32 s28, 0, s28
    s_add_u32 m0, s21, 114688
    s_nop 0
    buffer_load_dwordx4 v7, s[8:11], s27 offen lds
    v_mfma_f32_32x32x16_bf16 v[144:159], v[74:77], v[66:69], v[144:159]
    s_add_u32 m0, s21, 122880
    s_nop 0
    buffer_load_dwordx4 v8, s[8:11], s27 offen lds
    v_mfma_f32_32x32x16_bf16 v[96:111], v[86:89], v[78:81], v[96:111]
    s_add_u32 m0, s21, 131072
    s_nop 0
    buffer_load_dwordx4 v9, s[12:15], s27 offen lds
    v_mfma_f32_32x32x16_bf16 v[112:127], v[90:93], v[78:81], v[112:127]
    s_add_u32 m0, s21, 139264
    s_nop 0
    buffer_load_dwordx4 v10, s[12:15], s27 offen lds
    v_mfma_f32_32x32x16_bf16 v[128:143], v[86:89], v[82:85], v[128:143]
    v_mfma_f32_32x32x16_bf16 v[144:159], v[90:93], v[82:85], v[144:159]
    s_waitcnt lgkmcnt(9)
    v_mfma_f32_32x32x16_bf16 v[96:111], v[38:41], v[30:33], v[96:111]
    ds_read_b128 v[62:65], v13 offset:0
    ds_read_b64_tr_b16 v[70:71], v23 offset:24576
    s_waitcnt lgkmcnt(8)
    v_mfma_f32_32x32x16_bf16 v[112:127], v[42:45], v[30:33], v[112:127]
    ds_read_b64_tr_b16 v[72:73], v23 offset:25600
    ds_read_b128 v[66:69], v13 offset:4096
    v_mfma_f32_32x32x16_bf16 v[128:143], v[38:41], v[34:37], v[128:143]
    ds_read_b64_tr_b16 v[74:75], v24 offset:24576
    ds_read_b64_tr_b16 v[76:77], v24 offset:25600
    v_mfma_f32_32x32x16_bf16 v[144:159], v[42:45], v[34:37], v[144:159]
    ds_read_b128 v[78:81], v14 offset:0
    ds_read_b64_tr_b16 v[86:87], v23 offset:28672
    s_waitcnt lgkmcnt(11)
    v_mfma_f32_32x32x16_bf16 v[96:111], v[54:57], v[46:49], v[96:111]
    ds_read_b64_tr_b16 v[88:89], v23 offset:29696
    ds_read_b128 v[82:85], v14 offset:4096
    s_waitcnt lgkmcnt(10)
    v_mfma_f32_32x32x16_bf16 v[112:127], v[58:61], v[46:49], v[112:127]
    ds_read_b64_tr_b16 v[90:91], v24 offset:28672
    ds_read_b64_tr_b16 v[92:93], v24 offset:29696
    v_mfma_f32_32x32x16_bf16 v[128:143], v[54:57], v[50:53], v[128:143]
    v_mfma_f32_32x32x16_bf16 v[144:159], v[58:61], v[50:53], v[144:159]
    s_waitcnt lgkmcnt(0)
    s_waitcnt vmcnt(6)
    s_barrier
    ds_read_b128 v[30:33], v11 offset:49152
    ds_read_b64_tr_b16 v[38:39], v25 offset:0
    ds_read_b64_tr_b16 v[40:41], v25 offset:1024
    ds_read_b128 v[34:37], v11 offset:53248
    ds_read_b64_tr_b16 v[42:43], v26 offset:0
    ds_read_b64_tr_b16 v[44:45], v26 offset:1024
    ds_read_b128 v[46:49], v12 offset:49152
    ds_read_b64_tr_b16 v[54:55], v25 offset:4096
    ds_read_b64_tr_b16 v[56:57], v25 offset:5120
    ds_read_b128 v[50:53], v12 offset:53248
    ds_read_b64_tr_b16 v[58:59], v26 offset:4096
    ds_read_b64_tr_b16 v[60:61], v26 offset:5120
    v_mfma_f32_32x32x16_bf16 v[96:111], v[70:73], v[62:65], v[96:111]
    s_lshl_b32 s26, s28, 7
    s_add_u32 s26, s26, s31
    s_add_u32 m0, s21, 0
    s_nop 0
    buffer_load_dwordx4 v5, s[4:7], s26 offen lds
    v_mfma_f32_32x32x16_bf16 v[112:127], v[74:77], v[62:65], v[112:127]
    s_add_u32 m0, s21, 8192
    s_nop 0
    buffer_load_dwordx4 v6, s[4:7], s26 offen lds
    v_mfma_f32_32x32x16_bf16 v[128:143], v[70:73], v[66:69], v[128:143]
    s_mul_i32 s27, s28, 229376
    s_add_u32 s27, s27, s32
    s_add_u32 s28, s28, 1
    s_cmp_eq_u32 s28, 8
    s_cselect_b32 s28, 0, s28
    s_add_u32 m0, s21, 16384
    s_nop 0
    buffer_load_dwordx4 v7, s[8:11], s27 offen lds
    v_mfma_f32_32x32x16_bf16 v[144:159], v[74:77], v[66:69], v[144:159]
    s_add_u32 m0, s21, 24576
    s_nop 0
    buffer_load_dwordx4 v8, s[8:11], s27 offen lds
    v_mfma_f32_32x32x16_bf16 v[96:111], v[86:89], v[78:81], v[96:111]
    s_add_u32 m0, s21, 32768
    s_nop 0
    buffer_load_dwordx4 v9, s[12:15], s27 offen lds
    v_mfma_f32_32x32x16_bf16 v[112:127], v[90:93], v[78:81], v[112:127]
    s_add_u32 m0, s21, 40960
    s_nop 0
    buffer_load_dwordx4 v10, s[12:15], s27 offen lds
    v_mfma_f32_32x32x16_bf16 v[128:143], v[86:89], v[82:85], v[128:143]
    v_mfma_f32_32x32x16_bf16 v[144:159], v[90:93], v[82:85], v[144:159]
    s_waitcnt lgkmcnt(9)
    v_mfma_f32_32x32x16_bf16 v[96:111], v[38:41], v[30:33], v[96:111]
    ds_read_b128 v[62:65], v13 offset:49152
    ds_read_b64_tr_b16 v[70:71], v25 offset:8192
    s_waitcnt lgkmcnt(8)
    v_mfma_f32_32x32x16_bf16 v[112:127], v[42:45], v[30:33], v[112:127]
    ds_read_b64_tr_b16 v[72:73], v25 offset:9216
    ds_read_b128 v[66:69], v13 offset:53248
    v_mfma_f32_32x32x16_bf16 v[128:143], v[38:41], v[34:37], v[128:143]
    ds_read_b64_tr_b16 v[74:75], v26 offset:8192
    ds_read_b64_tr_b16 v[76:77], v26 offset:9216
    v_mfma_f32_32x32x16_bf16 v[144:159], v[42:45], v[34:37], v[144:159]
    ds_read_b128 v[78:81], v14 offset:49152
    ds_read_b64_tr_b16 v[86:87], v25 offset:12288
    s_waitcnt lgkmcnt(11)
    v_mfma_f32_32x32x16_bf16 v[96:111], v[54:57], v[46:49], v[96:111]
    ds_read_b64_tr_b16 v[88:89], v25 offset:13312
    ds_read_b128 v[82:85], v14 offset:53248
    s_waitcnt lgkmcnt(10)
    v_mfma_f32_32x32x16_bf16 v[112:127], v[58:61], v[46:49], v[112:127]
    ds_read_b64_tr_b16 v[90:91], v26 offset:12288
    ds_read_b64_tr_b16 v[92:93], v26 offset:13312
    v_mfma_f32_32x32x16_bf16 v[128:143], v[54:57], v[50:53], v[128:143]
    v_mfma_f32_32x32x16_bf16 v[144:159], v[58:61], v[50:53], v[144:159]
    s_waitcnt lgkmcnt(0)
    s_waitcnt vmcnt(6)
    s_barrier
    ds_read_b128 v[30:33], v15 offset:32768
    ds_read_b64_tr_b16 v[38:39], v25 offset:49152
    ds_read_b64_tr_b16 v[40:41], v25 offset:50176
    ds_read_b128 v[34:37], v15 offset:36864
    ds_read_b64_tr_b16 v[42:43], v26 offset:49152
    ds_read_b64_tr_b16 v[44:45], v26 offset:50176
    ds_read_b128 v[46:49], v16 offset:32768
    ds_read_b64_tr_b16 v[54:55], v25 offset:53248
    ds_read_b64_tr_b16 v[56:57], v25 offset:54272
    ds_read_b128 v[50:53], v16 offset:36864
    ds_read_b64_tr_b16 v[58:59], v26 offset:53248
    ds_read_b64_tr_b16 v[60:61], v26 offset:54272
    v_mfma_f32_32x32x16_bf16 v[96:111], v[70:73], v[62:65], v[96:111]
    s_lshl_b32 s26, s28, 7
    s_add_u32 s26, s26, s31
    s_add_u32 m0, s21, 49152
    s_nop 0
    buffer_load_dwordx4 v5, s[4:7], s26 offen lds
    v_mfma_f32_32x32x16_bf16 v[112:127], v[74:77], v[62:65], v[112:127]
    s_add_u32 m0, s21, 57344
    s_nop 0
    buffer_load_dwordx4 v6, s[4:7], s26 offen lds
    v_mfma_f32_32x32x16_bf16 v[128:143], v[70:73], v[66:69], v[128:143]
    s_mul_i32 s27, s28, 229376
    s_add_u32 s27, s27, s32
    s_add_u32 s28, s28, 1
    s_cmp_eq_u32 s28, 8
    s_cselect_b32 s28, 0, s28
    s_add_u32 m0, s21, 65536
    s_nop 0
    buffer_load_dwordx4 v7, s[8:11], s27 offen lds
    v_mfma_f32_32x32x16_bf16 v[144:159], v[74:77], v[66:69], v[144:159]
    s_add_u32 m0, s21, 73728
    s_nop 0
    buffer_load_dwordx4 v8, s[8:11], s27 offen lds
    v_mfma_f32_32x32x16_bf16 v[96:111], v[86:89], v[78:81], v[96:111]
    s_add_u32 m0, s21, 81920
    s_nop 0
    buffer_load_dwordx4 v9, s[12:15], s27 offen lds
    v_mfma_f32_32x32x16_bf16 v[112:127], v[90:93], v[78:81], v[112:127]
    s_add_u32 m0, s21, 90112
    s_nop 0
    buffer_load_dwordx4 v10, s[12:15], s27 offen lds
    v_mfma_f32_32x32x16_bf16 v[128:143], v[86:89], v[82:85], v[128:143]
    v_mfma_f32_32x32x16_bf16 v[144:159], v[90:93], v[82:85], v[144:159]
    s_waitcnt lgkmcnt(9)
    v_mfma_f32_32x32x16_bf16 v[96:111], v[38:41], v[30:33], v[96:111]
    ds_read_b128 v[62:65], v17 offset:32768
    ds_read_b64_tr_b16 v[70:71], v25 offset:57344
    s_waitcnt lgkmcnt(8)
    v_mfma_f32_32x32x16_bf16 v[112:127], v[42:45], v[30:33], v[112:127]
    ds_read_b64_tr_b16 v[72:73], v25 offset:58368
    ds_read_b128 v[66:69], v17 offset:36864
    v_mfma_f32_32x32x16_bf16 v[128:143], v[38:41], v[34:37], v[128:143]
    ds_read_b64_tr_b16 v[74:75], v26 offset:57344
    ds_read_b64_tr_b16 v[76:77], v26 offset:58368
    v_mfma_f32_32x32x16_bf16 v[144:159], v[42:45], v[34:37], v[144:159]
    ds_read_b128 v[78:81], v18 offset:32768
    ds_read_b64_tr_b16 v[86:87], v25 offset:61440
    s_waitcnt lgkmcnt(11)
    v_mfma_f32_32x32x16_bf16 v[96:111], v[54:57], v[46:49], v[96:111]
    ds_read_b64_tr_b16 v[88:89], v25 offset:62464
    ds_read_b128 v[82:85], v18 offset:36864
    s_waitcnt lgkmcnt(10)
    v_mfma_f32_32x32x16_bf16 v[112:127], v[58:61], v[46:49], v[112:127]
    ds_read_b64_tr_b16 v[90:91], v26 offset:61440
    ds_read_b64_tr_b16 v[92:93], v26 offset:62464
    v_mfma_f32_32x32x16_bf16 v[128:143], v[54:57], v[50:53], v[128:143]
    v_mfma_f32_32x32x16_bf16 v[144:159], v[58:61], v[50:53], v[144:159]
    s_waitcnt lgkmcnt(0)
    s_waitcnt vmcnt(6)
    s_barrier
    ds_read_b128 v[30:33], v11 offset:0
    ds_read_b64_tr_b16 v[38:39], v23 offset:16384
    ds_read_b64_tr_b16 v[40:41], v23 offset:17408
    ds_read_b128 v[34:37], v11 offset:4096
    ds_read_b64_tr_b16 v[42:43], v24 offset:16384
    ds_read_b64_tr_b16 v[44:45], v24 offset:17408
    ds_read_b128 v[46:49], v12 offset:0
    ds_read_b64_tr_b16 v[54:55], v23 offset:20480
    ds_read_b64_tr_b16 v[56:57], v23 offset:21504
    ds_read_b128 v[50:53], v12 offset:4096
    ds_read_b64_tr_b16 v[58:59], v24 offset:20480
    ds_read_b64_tr_b16 v[60:61], v24 offset:21504
    v_mfma_f32_32x32x16_bf16 v[96:111], v[70:73], v[62:65], v[96:111]
    v_mfma_f32_32x32x16_bf16 v[112:127], v[74:77], v[62:65], v[112:127]
    v_mfma_f32_32x32x16_bf16 v[128:143], v[70:73], v[66:69], v[128:143]
    v_mfma_f32_32x32x16_bf16 v[144:159], v[74:77], v[66:69], v[144:159]
    v_mfma_f32_32x32x16_bf16 v[96:111], v[86:89], v[78:81], v[96:111]
    v_mfma_f32_32x32x16_bf16 v[112:127], v[90:93], v[78:81], v[112:127]
    v_mfma_f32_32x32x16_bf16 v[128:143], v[86:89], v[82:85], v[128:143]
    v_mfma_f32_32x32x16_bf16 v[144:159], v[90:93], v[82:85], v[144:159]
    s_waitcnt lgkmcnt(9)
    v_mfma_f32_32x32x16_bf16 v[96:111], v[38:41], v[30:33], v[96:111]
    ds_read_b128 v[62:65], v13 offset:0
    ds_read_b64_tr_b16 v[70:71], v23 offset:24576
    s_waitcnt lgkmcnt(8)
    v_mfma_f32_32x32x16_bf16 v[112:127], v[42:45], v[30:33], v[112:127]
    ds_read_b64_tr_b16 v[72:73], v23 offset:25600
    ds_read_b128 v[66:69], v13 offset:4096
    v_mfma_f32_32x32x16_bf16 v[128:143], v[38:41], v[34:37], v[128:143]
    ds_read_b64_tr_b16 v[74:75], v24 offset:24576
    ds_read_b64_tr_b16 v[76:77], v24 offset:25600
    v_mfma_f32_32x32x16_bf16 v[144:159], v[42:45], v[34:37], v[144:159]
    ds_read_b128 v[78:81], v14 offset:0
    ds_read_b64_tr_b16 v[86:87], v23 offset:28672
    s_waitcnt lgkmcnt(11)
    v_mfma_f32_32x32x16_bf16 v[96:111], v[54:57], v[46:49], v[96:111]
    ds_read_b64_tr_b16 v[88:89], v23 offset:29696
    ds_read_b128 v[82:85], v14 offset:4096
    s_waitcnt lgkmcnt(10)
    v_mfma_f32_32x32x16_bf16 v[112:127], v[58:61], v[46:49], v[112:127]
    ds_read_b64_tr_b16 v[90:91], v24 offset:28672
    ds_read_b64_tr_b16 v[92:93], v24 offset:29696
    v_mfma_f32_32x32x16_bf16 v[128:143], v[54:57], v[50:53], v[128:143]
    v_mfma_f32_32x32x16_bf16 v[144:159], v[58:61], v[50:53], v[144:159]
    s_waitcnt lgkmcnt(0)
    s_waitcnt vmcnt(0)
    s_barrier
    ds_read_b128 v[30:33], v11 offset:49152
    ds_read_b64_tr_b16 v[38:39], v25 offset:0
    ds_read_b64_tr_b16 v[40:41], v25 offset:1024
    ds_read_b128 v[34:37], v11 offset:53248
    ds_read_b64_tr_b16 v[42:43], v26 offset:0
    ds_read_b64_tr_b16 v[44:45], v26 offset:1024
    ds_read_b128 v[46:49], v12 offset:49152
    ds_read_b64_tr_b16 v[54:55], v25 offset:4096
    ds_read_b64_tr_b16 v[56:57], v25 offset:5120
    ds_read_b128 v[50:53], v12 offset:53248
    ds_read_b64_tr_b16 v[58:59], v26 offset:4096
    ds_read_b64_tr_b16 v[60:61], v26 offset:5120
    v_mfma_f32_32x32x16_bf16 v[96:111], v[70:73], v[62:65], v[96:111]
    v_mfma_f32_32x32x16_bf16 v[112:127], v[74:77], v[62:65], v[112:127]
    v_mfma_f32_32x32x16_bf16 v[128:143], v[70:73], v[66:69], v[128:143]
    v_mfma_f32_32x32x16_bf16 v[144:159], v[74:77], v[66:69], v[144:159]
    v_mfma_f32_32x32x16_bf16 v[96:111], v[86:89], v[78:81], v[96:111]
    v_mfma_f32_32x32x16_bf16 v[112:127], v[90:93], v[78:81], v[112:127]
    v_mfma_f32_32x32x16_bf16 v[128:143], v[86:89], v[82:85], v[128:143]
    v_mfma_f32_32x32x16_bf16 v[144:159], v[90:93], v[82:85], v[144:159]
    s_waitcnt lgkmcnt(9)
    v_mfma_f32_32x32x16_bf16 v[96:111], v[38:41], v[30:33], v[96:111]
    ds_read_b128 v[62:65], v13 offset:49152
    ds_read_b64_tr_b16 v[70:71], v25 offset:8192
    s_waitcnt lgkmcnt(8)
    v_mfma_f32_32x32x16_bf16 v[112:127], v[42:45], v[30:33], v[112:127]
    ds_read_b64_tr_b16 v[72:73], v25 offset:9216
    ds_read_b128 v[66:69], v13 offset:53248
    v_mfma_f32_32x32x16_bf16 v[128:143], v[38:41], v[34:37], v[128:143]
    ds_read_b64_tr_b16 v[74:75], v26 offset:8192
    ds_read_b64_tr_b16 v[76:77], v26 offset:9216
    v_mfma_f32_32x32x16_bf16 v[144:159], v[42:45], v[34:37], v[144:159]
    ds_read_b128 v[78:81], v14 offset:49152
    ds_read_b64_tr_b16 v[86:87], v25 offset:12288
    s_waitcnt lgkmcnt(11)
    v_mfma_f32_32x32x16_bf16 v[96:111], v[54:57], v[46:49], v[96:111]
    ds_read_b64_tr_b16 v[88:89], v25 offset:13312
    ds_read_b128 v[82:85], v14 offset:53248
    s_waitcnt lgkmcnt(10)
    v_mfma_f32_32x32x16_bf16 v[112:127], v[58:61], v[46:49], v[112:127]
    ds_read_b64_tr_b16 v[90:91], v26 offset:12288
    ds_read_b64_tr_b16 v[92:93], v26 offset:13312
    v_mfma_f32_32x32x16_bf16 v[128:143], v[54:57], v[50:53], v[128:143]
    v_mfma_f32_32x32x16_bf16 v[144:159], v[58:61], v[50:53], v[144:159]
    s_waitcnt lgkmcnt(9)
    v_mfma_f32_32x32x16_bf16 v[96:111], v[70:73], v[62:65], v[96:111]
    s_waitcnt lgkmcnt(6)
    v_mfma_f32_32x32x16_bf16 v[112:127], v[74:77], v[62:65], v[112:127]
    v_mfma_f32_32x32x16_bf16 v[128:143], v[70:73], v[66:69], v[128:143]
    v_mfma_f32_32x32x16_bf16 v[144:159], v[74:77], v[66:69], v[144:159]
    s_waitcnt lgkmcnt(3)
    v_mfma_f32_32x32x16_bf16 v[96:111], v[86:89], v[78:81], v[96:111]
    s_waitcnt lgkmcnt(0)
    v_mfma_f32_32x32x16_bf16 v[112:127], v[90:93], v[78:81], v[112:127]
    v_mfma_f32_32x32x16_bf16 v[128:143], v[86:89], v[82:85], v[128:143]
    v_mfma_f32_32x32x16_bf16 v[144:159], v[90:93], v[82:85], v[144:159]
    s_nop 15
    s_lshl_b32 s33, s29, 1
    s_add_u32 s33, s33, s22
    s_mul_i32 s33, s33, 229376
    s_add_u32 s33, s33, s32
    s_lshl_b32 s34, s23, 6
    s_add_u32 s33, s33, s34
    s_add_u32 s34, s33, 114688
    v_lshrrev_b32 v2, 5, v1
    v_lshlrev_b32 v2, 4, v2
    v_and_b32 v3, 31, v1
    v_mul_u32_u24 v3, 3584, v3
    v_add_u32 v2, v2, v3
    v_cvt_pk_bf16_f32 v30, v96, v97
    v_cvt_pk_bf16_f32 v31, v98, v99
    v_cvt_pk_bf16_f32 v32, v100, v101
    v_cvt_pk_bf16_f32 v33, v102, v103
    v_lshlrev_b32 v96, 16, v30
    v_and_b32 v97, 0xffff0000, v30
    v_lshlrev_b32 v98, 16, v31
    v_and_b32 v99, 0xffff0000, v31
    v_lshlrev_b32 v100, 16, v32
    v_and_b32 v101, 0xffff0000, v32
    v_lshlrev_b32 v102, 16, v33
    v_and_b32 v103, 0xffff0000, v33
    v_cvt_pk_bf16_f32 v30, v112, v113
    v_cvt_pk_bf16_f32 v31, v114, v115
    v_cvt_pk_bf16_f32 v32, v116, v117
    v_cvt_pk_bf16_f32 v33, v118, v119
    v_lshlrev_b32 v112, 16, v30
    v_and_b32 v113, 0xffff0000, v30
    v_lshlrev_b32 v114, 16, v31
    v_and_b32 v115, 0xffff0000, v31
    v_lshlrev_b32 v116, 16, v32
    v_and_b32 v117, 0xffff0000, v32
    v_lshlrev_b32 v118, 16, v33
    v_and_b32 v119, 0xffff0000, v33
    v_mul_f32 v96, v96, v112
    v_mul_f32 v97, v97, v113
    v_mul_f32 v98, v98, v114
    v_mul_f32 v99, v99, v115
    v_mul_f32 v100, v100, v116
    v_mul_f32 v101, v101, v117
    v_mul_f32 v102, v102, v118
    v_mul_f32 v103, v103, v119
    v_cvt_pk_bf16_f32 v30, v96, v97
    v_cvt_pk_bf16_f32 v31, v98, v99
    v_cvt_pk_bf16_f32 v32, v100, v101
    v_cvt_pk_bf16_f32 v33, v102, v103
    buffer_store_dwordx4 v[30:33], v2, s[16:19], s33 offen offset:0
    v_cvt_pk_bf16_f32 v34, v104, v105
    v_cvt_pk_bf16_f32 v35, v106, v107
    v_cvt_pk_bf16_f32 v36, v108, v109
    v_cvt_pk_bf16_f32 v37, v110, v111
    v_lshlrev_b32 v104, 16, v34
    v_and_b32 v105, 0xffff0000, v34
    v_lshlrev_b32 v106, 16, v35
    v_and_b32 v107, 0xffff0000, v35
    v_lshlrev_b32 v108, 16, v36
    v_and_b32 v109, 0xffff0000, v36
    v_lshlrev_b32 v110, 16, v37
    v_and_b32 v111, 0xffff0000, v37
    v_cvt_pk_bf16_f32 v34, v120, v121
    v_cvt_pk_bf16_f32 v35, v122, v123
    v_cvt_pk_bf16_f32 v36, v124, v125
    v_cvt_pk_bf16_f32 v37, v126, v127
    v_lshlrev_b32 v120, 16, v34
    v_and_b32 v121, 0xffff0000, v34
    v_lshlrev_b32 v122, 16, v35
    v_and_b32 v123, 0xffff0000, v35
    v_lshlrev_b32 v124, 16, v36
    v_and_b32 v125, 0xffff0000, v36
    v_lshlrev_b32 v126, 16, v37
    v_and_b32 v127, 0xffff0000, v37
    v_mul_f32 v104, v104, v120
    v_mul_f32 v105, v105, v121
    v_mul_f32 v106, v106, v122
    v_mul_f32 v107, v107, v123
    v_mul_f32 v108, v108, v124
    v_mul_f32 v109, v109, v125
    v_mul_f32 v110, v110, v126
    v_mul_f32 v111, v111, v127
    v_cvt_pk_bf16_f32 v34, v104, v105
    v_cvt_pk_bf16_f32 v35, v106, v107
    v_cvt_pk_bf16_f32 v36, v108, v109
    v_cvt_pk_bf16_f32 v37, v110, v111
    buffer_store_dwordx4 v[34:37], v2, s[16:19], s33 offen offset:32
    v_cvt_pk_bf16_f32 v38, v128, v129
    v_cvt_pk_bf16_f32 v39, v130, v131
    v_cvt_pk_bf16_f32 v40, v132, v133
    v_cvt_pk_bf16_f32 v41, v134, v135
    v_lshlrev_b32 v128, 16, v38
    v_and_b32 v129, 0xffff0000, v38
    v_lshlrev_b32 v130, 16, v39
    v_and_b32 v131, 0xffff0000, v39
    v_lshlrev_b32 v132, 16, v40
    v_and_b32 v133, 0xffff0000, v40
    v_lshlrev_b32 v134, 16, v41
    v_and_b32 v135, 0xffff0000, v41
    v_cvt_pk_bf16_f32 v38, v144, v145
    v_cvt_pk_bf16_f32 v39, v146, v147
    v_cvt_pk_bf16_f32 v40, v148, v149
    v_cvt_pk_bf16_f32 v41, v150, v151
    v_lshlrev_b32 v144, 16, v38
    v_and_b32 v145, 0xffff0000, v38
    v_lshlrev_b32 v146, 16, v39
    v_and_b32 v147, 0xffff0000, v39
    v_lshlrev_b32 v148, 16, v40
    v_and_b32 v149, 0xffff0000, v40
    v_lshlrev_b32 v150, 16, v41
    v_and_b32 v151, 0xffff0000, v41
    v_mul_f32 v128, v128, v144
    v_mul_f32 v129, v129, v145
    v_mul_f32 v130, v130, v146
    v_mul_f32 v131, v131, v147
    v_mul_f32 v132, v132, v148
    v_mul_f32 v133, v133, v149
    v_mul_f32 v134, v134, v150
    v_mul_f32 v135, v135, v151
    v_cvt_pk_bf16_f32 v38, v128, v129
    v_cvt_pk_bf16_f32 v39, v130, v131
    v_cvt_pk_bf16_f32 v40, v132, v133
    v_cvt_pk_bf16_f32 v41, v134, v135
    buffer_store_dwordx4 v[38:41], v2, s[16:19], s34 offen offset:0
    v_cvt_pk_bf16_f32 v42, v136, v137
    v_cvt_pk_bf16_f32 v43, v138, v139
    v_cvt_pk_bf16_f32 v44, v140, v141
    v_cvt_pk_bf16_f32 v45, v142, v143
    v_lshlrev_b32 v136, 16, v42
    v_and_b32 v137, 0xffff0000, v42
    v_lshlrev_b32 v138, 16, v43
    v_and_b32 v139, 0xffff0000, v43
    v_lshlrev_b32 v140, 16, v44
    v_and_b32 v141, 0xffff0000, v44
    v_lshlrev_b32 v142, 16, v45
    v_and_b32 v143, 0xffff0000, v45
    v_cvt_pk_bf16_f32 v42, v152, v153
    v_cvt_pk_bf16_f32 v43, v154, v155
    v_cvt_pk_bf16_f32 v44, v156, v157
    v_cvt_pk_bf16_f32 v45, v158, v159
    v_lshlrev_b32 v152, 16, v42
    v_and_b32 v153, 0xffff0000, v42
    v_lshlrev_b32 v154, 16, v43
    v_and_b32 v155, 0xffff0000, v43
    v_lshlrev_b32 v156, 16, v44
    v_and_b32 v157, 0xffff0000, v44
    v_lshlrev_b32 v158, 16, v45
    v_and_b32 v159, 0xffff0000, v45
    v_mul_f32 v136, v136, v152
    v_mul_f32 v137, v137, v153
    v_mul_f32 v138, v138, v154
    v_mul_f32 v139, v139, v155
    v_mul_f32 v140, v140, v156
    v_mul_f32 v141, v141, v157
    v_mul_f32 v142, v142, v158
    v_mul_f32 v143, v143, v159
    v_cvt_pk_bf16_f32 v42, v136, v137
    v_cvt_pk_bf16_f32 v43, v138, v139
    v_cvt_pk_bf16_f32 v44, v140, v141
    v_cvt_pk_bf16_f32 v45, v142, v143
    buffer_store_dwordx4 v[42:45], v2, s[16:19], s34 offen offset:32
    s_endpgm
.globl dn_kernel
.p2align 8
.type dn_kernel,@function
dn_kernel:
    s_cmp_lt_u32 s2, 256
    s_cbranch_scc1 dn_kernel_L1
    s_endpgm
dn_kernel_L1:
    s_load_dwordx2 s[4:5], s[0:1], 112
    s_load_dwordx2 s[8:9], s[0:1], 72
    s_load_dwordx2 s[12:13], s[0:1], 112
    s_load_dwordx2 s[16:17], s[0:1], 112
    s_load_dwordx2 s[20:21], s[0:1], 96
    v_lshrrev_b32 v1, 6, v0
    s_nop 0
    v_readfirstlane_b32 s24, v1
    v_and_b32 v1, 63, v0
    s_waitcnt lgkmcnt(0)
    s_add_u32 s4, s4, 0x2400000
    s_addc_u32 s5, s5, 0
    s_and_b32 s5, s5, 0xffff
    s_mov_b32 s6, 0x700000
    s_mov_b32 s7, 0x20000
    s_and_b32 s9, s9, 0xffff
    s_mov_b32 s10, 0x1c0000
    s_mov_b32 s11, 0x20000
    s_add_u32 s12, s12, 0x1400000
    s_addc_u32 s13, s13, 0
    s_and_b32 s13, s13, 0xffff
    s_mov_b32 s14, 0x200000
    s_mov_b32 s15, 0x20000
    s_and_b32 s17, s17, 0xffff
    s_mov_b32 s18, 0x3000
    s_mov_b32 s19, 0x20000
    s_and_b32 s21, s21, 0xffff
    s_mov_b32 s22, 0x200000
    s_mov_b32 s23, 0x20000
    s_lshl_b32 s25, s24, 10
    s_lshr_b32 s26, s24, 1
    s_and_b32 s27, s24, 1
    s_lshl_b32 s28, s24, 2
    v_lshrrev_b32 v2, 4, v1
    v_add_u32 v2, s28, v2
    v_xor_b32 v2, v2, v1
    v_and_b32 v2, 7, v2
    v_lshlrev_b32 v2, 4, v2
    s_lshl_b32 s28, s24, 3
    v_lshrrev_b32 v3, 3, v1
    v_add_u32 v3, s28, v3
    s_mov_b32 s28, 3584
    v_mul_lo_u32 v3, v3, s28
    v_add_u32 v5, v2, v3
    v_add_u32 v6, 114688, v5
    v_lshrrev_b32 v3, 3, v1
    v_lshlrev_b32 v2, 1, v3
    v_and_b32 v2, 4, v2
    v_xor_b32 v2, v2, v1
    v_and_b32 v2, 7, v2
    v_lshlrev_b32 v2, 4, v2
    s_mul_i32 s28, s24, 8
    v_add_u32 v3, s28, v3
    s_mov_b32 s28, 1024
    v_mul_lo_u32 v3, v3, s28
    v_add_u32 v7, v2, v3
    v_add_u32 v8, 32768, v7
    v_lshrrev_b32 v2, 5, v1
    v_bfe_u32 v3, v1, 1, 3
    v_xor_b32 v2, v2, v3
    v_lshlrev_b32 v2, 4, v2
    v_and_b32 v3, 31, v1
    v_lshl_add_u32 v2, v3, 7, v2
    s_mul_i32 s28, s26, 4096
    v_add_u32 v2, s28, v2
    v_xor_b32 v9, 0, v2
    v_xor_b32 v10, 32, v2
    v_xor_b32 v11, 64, v2
    v_xor_b32 v12, 96, v2
    v_lshrrev_b32 v2, 5, v1
    v_lshlrev_b32 v2, 2, v2
    v_bfe_u32 v3, v1, 2, 2
    v_add_u32 v2, v2, v3
    v_mul_u32_u24 v2, 128, v2
    v_bfe_u32 v4, v1, 4, 1
    v_lshl_add_u32 v2, v4, 5, v2
    v_and_b32 v4, 3, v1
    v_lshl_add_u32 v2, v4, 3, v2
    v_lshrrev_b32 v3, 1, v3
    s_mul_i32 s28, s27, 1
    s_add_u32 s28, s28, 0
    s_and_b32 s29, s28, 1
    v_xor_b32 v4, s29, v3
    v_lshl_add_u32 v4, v4, 6, v2
    s_lshr_b32 s28, s28, 1
    s_mul_i32 s28, s28, 8192
    v_add_u32 v13, s28, v4
    s_lshr_b32 s32, s2, 3
    s_mov_b32 s32, 0
    s_min_u32 s32, s32, 27
    s_and_b32 s33, s2, 7
    s_lshl_b32 s33, s33, 2
    s_bfe_u32 s38, s2, 0x20003
    s_add_u32 s33, s33, s38
    s_lshr_b32 s34, s2, 5
    s_mul_i32 s35, s33, 229376
    s_lshl_b32 s36, s34, 7
    s_lshl_b32 s37, s33, 16
    s_lshl_b32 s38, s26, 15
    s_add_u32 s37, s37, s38
    s_lshl_b32 s38, s27, 6
    s_add_u32 s38, s38, s36
    s_add_u32 s37, s37, s38
    s_lshl_b32 s38, s38, 1
    s_add_u32 s38, s38, 10240
    v_lshrrev_b32 v129, 5, v1
    v_lshlrev_b32 v128, 4, v129
    v_lshlrev_b32 v129, 5, v129
    v_and_b32 v120, 31, v1
    v_lshl_add_u32 v128, v120, 10, v128
    buffer_load_dwordx4 v[96:99], v128, s[12:15], s37 offen offset:0
    buffer_load_dwordx4 v[104:107], v129, s[16:19], s38 offen offset:0
    buffer_load_dwordx4 v[108:111], v129, s[16:19], s38 offen offset:16
    buffer_load_dwordx4 v[100:103], v128, s[12:15], s37 offen offset:32
    buffer_load_dwordx4 v[112:115], v129, s[16:19], s38 offen offset:64
    buffer_load_dwordx4 v[116:119], v129, s[16:19], s38 offen offset:80
    s_lshl_b32 s30, s32, 7
    s_add_u32 s30, s30, s35
    s_add_u32 m0, s25, 0
    s_nop 0
    buffer_load_dwordx4 v5, s[4:7], s30 offen lds
    s_add_u32 m0, s25, 4096
    s_nop 0
    buffer_load_dwordx4 v6, s[4:7], s30 offen lds
    s_mul_i32 s31, s32, 65536
    s_add_u32 s31, s31, s36
    s_add_u32 s32, s32, 1
    s_cmp_eq_u32 s32, 28
    s_cselect_b32 s32, 0, s32
    s_add_u32 m0, s25, 8192
    s_nop 0
    buffer_load_dwordx4 v7, s[8:11], s31 offen lds
    s_add_u32 m0, s25, 12288
    s_nop 0
    buffer_load_dwordx4 v8, s[8:11], s31 offen lds
    s_lshl_b32 s30, s32, 7
    s_add_u32 s30, s30, s35
    s_add_u32 m0, s25, 16384
    s_nop 0
    buffer_load_dwordx4 v5, s[4:7], s30 offen lds
    s_add_u32 m0, s25, 20480
    s_nop 0
    buffer_load_dwordx4 v6, s[4:7], s30 offen lds
    s_mul_i32 s31, s32, 65536
    s_add_u32 s31, s31, s36
    s_add_u32 s32, s32, 1
    s_cmp_eq_u32 s32, 28
    s_cselect_b32 s32, 0, s32
    s_add_u32 m0, s25, 24576
    s_nop 0
    buffer_load_dwordx4 v7, s[8:11], s31 offen lds
    s_add_u32 m0, s25, 28672
    s_nop 0
    buffer_load_dwordx4 v8, s[8:11], s31 offen lds
    s_lshl_b32 s30, s32, 7
    s_add_u32 s30, s30, s35
    s_add_u32 m0, s25, 32768
    s_nop 0
    buffer_load_dwordx4 v5, s[4:7], s30 offen lds
    s_add_u32 m0, s25, 36864
    s_nop 0
    buffer_load_dwordx4 v6, s[4:7], s30 offen lds
    s_mul_i32 s31, s32, 65536
    s_add_u32 s31, s31, s36
    s_add_u32 s32, s32, 1
    s_cmp_eq_u32 s32, 28
    s_cselect_b32 s32, 0, s32
    s_add_u32 m0, s25, 40960
    s_nop 0
    buffer_load_dwordx4 v7, s[8:11], s31 offen lds
    s_add_u32 m0, s25, 45056
    s_nop 0
    buffer_load_dwordx4 v8, s[8:11], s31 offen lds
    s_lshl_b32 s30, s32, 7
    s_add_u32 s30, s30, s35
    s_add_u32 m0, s25, 49152
    s_nop 0
    buffer_load_dwordx4 v5, s[4:7], s30 offen lds
    s_add_u32 m0, s25, 53248
    s_nop 0
    buffer_load_dwordx4 v6, s[4:7], s30 offen lds
    s_mul_i32 s31, s32, 65536
    s_add_u32 s31, s31, s36
    s_add_u32 s32, s32, 1
    s_cmp_eq_u32 s32, 28
    s_cselect_b32 s32, 0, s32
    s_add_u32 m0, s25, 57344
    s_nop 0
    buffer_load_dwordx4 v7, s[8:11], s31 offen lds
    s_add_u32 m0, s25, 61440
    s_nop 0
    buffer_load_dwordx4 v8, s[8:11], s31 offen lds
    s_waitcnt vmcnt(12)
    s_barrier
    ds_read_b128 v[14:17], v9 offset:0
    ds_read_b64_tr_b16 v[18:19], v13 offset:8192
    ds_read_b64_tr_b16 v[20:21], v13 offset:9216
    ds_read_b128 v[22:25], v10 offset:0
    ds_read_b64_tr_b16 v[26:27], v13 offset:10240
    ds_read_b64_tr_b16 v[28:29], v13 offset:11264
    ds_read_b128 v[30:33], v11 offset:0
    ds_read_b64_tr_b16 v[34:35], v13 offset:12288
    ds_read_b64_tr_b16 v[36:37], v13 offset:13312
    ds_read_b128 v[38:41], v12 offset:0
    ds_read_b64_tr_b16 v[42:43], v13 offset:14336
    ds_read_b64_tr_b16 v[44:45], v13 offset:15360
    s_waitcnt lgkmcnt(0)
    s_waitcnt vmcnt(8)
    s_barrier
    ds_read_b128 v[46:49], v9 offset:16384
    ds_read_b64_tr_b16 v[50:51], v13 offset:24576
    ds_read_b64_tr_b16 v[52:53], v13 offset:25600
    ds_read_b128 v[54:57], v10 offset:16384
    ds_read_b64_tr_b16 v[58:59], v13 offset:26624
    ds_read_b64_tr_b16 v[60:61], v13 offset:27648
    ds_read_b128 v[62:65], v11 offset:16384
    ds_read_b64_tr_b16 v[66:67], v13 offset:28672
    ds_read_b64_tr_b16 v[68:69], v13 offset:29696
    ds_read_b128 v[70:73], v12 offset:16384
    ds_read_b64_tr_b16 v[74:75], v13 offset:30720
    ds_read_b64_tr_b16 v[76:77], v13 offset:31744
    v_mfma_f32_32x32x16_bf16 v[80:95], v[18:21], v[14:17], 0
    s_lshl_b32 s30, s32, 7
    s_add_u32 s30, s30, s35
    s_add_u32 m0, s25, 0
    s_nop 0
    buffer_load_dwordx4 v5, s[4:7], s30 offen lds
    v_mfma_f32_32x32x16_bf16 v[80:95], v[26:29], v[22:25], v[80:95]
    s_add_u32 m0, s25, 4096
    s_nop 0
    buffer_load_dwordx4 v6, s[4:7], s30 offen lds
    v_mfma_f32_32x32x16_bf16 v[80:95], v[34:37], v[30:33], v[80:95]
    s_mul_i32 s31, s32, 65536
    s_add_u32 s31, s31, s36
    s_add_u32 s32, s32, 1
    s_cmp_eq_u32 s32, 28
    s_cselect_b32 s32, 0, s32
    s_add_u32 m0, s25, 8192
    s_nop 0
    buffer_load_dwordx4 v7, s[8:11], s31 offen lds
    v_mfma_f32_32x32x16_bf16 v[80:95], v[42:45], v[38:41], v[80:95]
    s_add_u32 m0, s25, 12288
    s_nop 0
    buffer_load_dwordx4 v8, s[8:11], s31 offen lds
    s_waitcnt lgkmcnt(0)
    s_waitcnt vmcnt(8)
    s_barrier
    ds_read_b128 v[14:17], v9 offset:32768
    ds_read_b64_tr_b16 v[18:19], v13 offset:40960
    ds_read_b64_tr_b16 v[20:21], v13 offset:41984
    ds_read_b128 v[22:25], v10 offset:32768
    ds_read_b64_tr_b16 v[26:27], v13 offset:43008
    ds_read_b64_tr_b16 v[28:29], v13 offset:44032
    ds_read_b128 v[30:33], v11 offset:32768
    ds_read_b64_tr_b16 v[34:35], v13 offset:45056
    ds_read_b64_tr_b16 v[36:37], v13 offset:46080
    ds_read_b128 v[38:41], v12 offset:32768
    ds_read_b64_tr_b16 v[42:43], v13 offset:47104
    ds_read_b64_tr_b16 v[44:45], v13 offset:48128
    v_mfma_f32_32x32x16_bf16 v[80:95], v[50:53], v[46:49], v[80:95]
    s_lshl_b32 s30, s32, 7
    s_add_u32 s30, s30, s35
    s_add_u32 m0, s25, 16384
    s_nop 0
    buffer_load_dwordx4 v5, s[4:7], s30 offen lds
    v_mfma_f32_32x32x16_bf16 v[80:95], v[58:61], v[54:57], v[80:95]
    s_add_u32 m0, s25, 20480
    s_nop 0
    buffer_load_dwordx4 v6, s[4:7], s30 offen lds
    v_mfma_f32_32x32x16_bf16 v[80:95], v[66:69], v[62:65], v[80:95]
    s_mul_i32 s31, s32, 65536
    s_add_u32 s31, s31, s36
    s_add_u32 s32, s32, 1
    s_cmp_eq_u32 s32, 28
    s_cselect_b32 s32, 0, s32
    s_add_u32 m0, s25, 24576
    s_nop 0
    buffer_load_dwordx4 v7, s[8:11], s31 offen lds
    v_mfma_f32_32x32x16_bf16 v[80:95], v[74:77], v[70:73], v[80:95]
    s_add_u32 m0, s25, 28672
    s_nop 0
    buffer_load_dwordx4 v8, s[8:11], s31 offen lds
    s_waitcnt lgkmcnt(0)
    s_waitcnt vmcnt(8)
    s_barrier
    ds_read_b128 v[46:49], v9 offset:49152
    ds_read_b64_tr_b16 v[50:51], v13 offset:57344
    ds_read_b64_tr_b16 v[52:53], v13 offset:58368
    ds_read_b128 v[54:57], v10 offset:49152
    ds_read_b64_tr_b16 v[58:59], v13 offset:59392
    ds_read_b64_tr_b16 v[60:61], v13 offset:60416
    ds_read_b128 v[62:65], v11 offset:49152
    ds_read_b64_tr_b16 v[66:67], v13 offset:61440
    ds_read_b64_tr_b16 v[68:69], v13 offset:62464
    ds_read_b128 v[70:73], v12 offset:49152
    ds_read_b64_tr_b16 v[74:75], v13 offset:63488
    ds_read_b64_tr_b16 v[76:77], v13 offset:64512
    v_mfma_f32_32x32x16_bf16 v[80:95], v[18:21], v[14:17], v[80:95]
    s_lshl_b32 s30, s32, 7
    s_add_u32 s30, s30, s35
    s_add_u32 m0, s25, 32768
    s_nop 0
    buffer_load_dwordx4 v5, s[4:7], s30 offen lds
    v_mfma_f32_32x32x16_bf16 v[80:95], v[26:29], v[22:25], v[80:95]
    s_add_u32 m0, s25, 36864
    s_nop 0
    buffer_load_dwordx4 v6, s[4:7], s30 offen lds
    v_mfma_f32_32x32x16_bf16 v[80:95], v[34:37], v[30:33], v[80:95]
    s_mul_i32 s31, s32, 65536
    s_add_u32 s31, s31, s36
    s_add_u32 s32, s32, 1
    s_cmp_eq_u32 s32, 28
    s_cselect_b32 s32, 0, s32
    s_add_u32 m0, s25, 40960
    s_nop 0
    buffer_load_dwordx4 v7, s[8:11], s31 offen lds
    v_mfma_f32_32x32x16_bf16 v[80:95], v[42:45], v[38:41], v[80:95]
    s_add_u32 m0, s25, 45056
    s_nop 0
    buffer_load_dwordx4 v8, s[8:11], s31 offen lds
    s_waitcnt lgkmcnt(0)
    s_waitcnt vmcnt(8)
    s_barrier
    ds_read_b128 v[14:17], v9 offset:0
    ds_read_b64_tr_b16 v[18:19], v13 offset:8192
    ds_read_b64_tr_b16 v[20:21], v13 offset:9216
    ds_read_b128 v[22:25], v10 offset:0
    ds_read_b64_tr_b16 v[26:27], v13 offset:10240
    ds_read_b64_tr_b16 v[28:29], v13 offset:11264
    ds_read_b128 v[30:33], v11 offset:0
    ds_read_b64_tr_b16 v[34:35], v13 offset:12288
    ds_read_b64_tr_b16 v[36:37], v13 offset:13312
    ds_read_b128 v[38:41], v12 offset:0
    ds_read_b64_tr_b16 v[42:43], v13 offset:14336
    ds_read_b64_tr_b16 v[44:45], v13 offset:15360
    v_mfma_f32_32x32x16_bf16 v[80:95], v[50:53], v[46:49], v[80:95]
    s_lshl_b32 s30, s32, 7
    s_add_u32 s30, s30, s35
    s_add_u32 m0, s25, 49152
    s_nop 0
    buffer_load_dwordx4 v5, s[4:7], s30 offen lds
    v_mfma_f32_32x32x16_bf16 v[80:95], v[58:61], v[54:57], v[80:95]
    s_add_u32 m0, s25, 53248
    s_nop 0
    buffer_load_dwordx4 v6, s[4:7], s30 offen lds
    v_mfma_f32_32x32x16_bf16 v[80:95], v[66:69], v[62:65], v[80:95]
    s_mul_i32 s31, s32, 65536
    s_add_u32 s31, s31, s36
    s_add_u32 s32, s32, 1
    s_cmp_eq_u32 s32, 28
    s_cselect_b32 s32, 0, s32
    s_add_u32 m0, s25, 57344
    s_nop 0
    buffer_load_dwordx4 v7, s[8:11], s31 offen lds
    v_mfma_f32_32x32x16_bf16 v[80:95], v[74:77], v[70:73], v[80:95]
    s_add_u32 m0, s25, 61440
    s_nop 0
    buffer_load_dwordx4 v8, s[8:11], s31 offen lds
    s_waitcnt lgkmcnt(0)
    s_waitcnt vmcnt(8)
    s_barrier
    ds_read_b128 v[46:49], v9 offset:16384
    ds_read_b64_tr_b16 v[50:51], v13 offset:24576
    ds_read_b64_tr_b16 v[52:53], v13 offset:25600
    ds_read_b128 v[54:57], v10 offset:16384
    ds_read_b64_tr_b16 v[58:59], v13 offset:26624
    ds_read_b64_tr_b16 v[60:61], v13 offset:27648
    ds_read_b128 v[62:65], v11 offset:16384
    ds_read_b64_tr_b16 v[66:67], v13 offset:28672
    ds_read_b64_tr_b16 v[68:69], v13 offset:29696
    ds_read_b128 v[70:73], v12 offset:16384
    ds_read_b64_tr_b16 v[74:75], v13 offset:30720
    ds_read_b64_tr_b16 v[76:77], v13 offset:31744
    v_mfma_f32_32x32x16_bf16 v[80:95], v[18:21], v[14:17], v[80:95]
    s_lshl_b32 s30, s32, 7
    s_add_u32 s30, s30, s35
    s_add_u32 m0, s25, 0
    s_nop 0
    buffer_load_dwordx4 v5, s[4:7], s30 offen lds
    v_mfma_f32_32x32x16_bf16 v[80:95], v[26:29], v[22:25], v[80:95]
    s_add_u32 m0, s25, 4096
    s_nop 0
    buffer_load_dwordx4 v6, s[4:7], s30 offen lds
    v_mfma_f32_32x32x16_bf16 v[80:95], v[34:37], v[30:33], v[80:95]
    s_mul_i32 s31, s32, 65536
    s_add_u32 s31, s31, s36
    s_add_u32 s32, s32, 1
    s_cmp_eq_u32 s32, 28
    s_cselect_b32 s32, 0, s32
    s_add_u32 m0, s25, 8192
    s_nop 0
    buffer_load_dwordx4 v7, s[8:11], s31 offen lds
    v_mfma_f32_32x32x16_bf16 v[80:95], v[42:45], v[38:41], v[80:95]
    s_add_u32 m0, s25, 12288
    s_nop 0
    buffer_load_dwordx4 v8, s[8:11], s31 offen lds
    s_waitcnt lgkmcnt(0)
    s_waitcnt vmcnt(8)
    s_barrier
    ds_read_b128 v[14:17], v9 offset:32768
    ds_read_b64_tr_b16 v[18:19], v13 offset:40960
    ds_read_b64_tr_b16 v[20:21], v13 offset:41984
    ds_read_b128 v[22:25], v10 offset:32768
    ds_read_b64_tr_b16 v[26:27], v13 offset:43008
    ds_read_b64_tr_b16 v[28:29], v13 offset:44032
    ds_read_b128 v[30:33], v11 offset:32768
    ds_read_b64_tr_b16 v[34:35], v13 offset:45056
    ds_read_b64_tr_b16 v[36:37], v13 offset:46080
    ds_read_b128 v[38:41], v12 offset:32768
    ds_read_b64_tr_b16 v[42:43], v13 offset:47104
    ds_read_b64_tr_b16 v[44:45], v13 offset:48128
    v_mfma_f32_32x32x16_bf16 v[80:95], v[50:53], v[46:49], v[80:95]
    s_lshl_b32 s30, s32, 7
    s_add_u32 s30, s30, s35
    s_add_u32 m0, s25, 16384
    s_nop 0
    buffer_load_dwordx4 v5, s[4:7], s30 offen lds
    v_mfma_f32_32x32x16_bf16 v[80:95], v[58:61], v[54:57], v[80:95]
    s_add_u32 m0, s25, 20480
    s_nop 0
    buffer_load_dwordx4 v6, s[4:7], s30 offen lds
    v_mfma_f32_32x32x16_bf16 v[80:95], v[66:69], v[62:65], v[80:95]
    s_mul_i32 s31, s32, 65536
    s_add_u32 s31, s31, s36
    s_add_u32 s32, s32, 1
    s_cmp_eq_u32 s32, 28
    s_cselect_b32 s32, 0, s32
    s_add_u32 m0, s25, 24576
    s_nop 0
    buffer_load_dwordx4 v7, s[8:11], s31 offen lds
    v_mfma_f32_32x32x16_bf16 v[80:95], v[74:77], v[70:73], v[80:95]
    s_add_u32 m0, s25, 28672
    s_nop 0
    buffer_load_dwordx4 v8, s[8:11], s31 offen lds
    s_waitcnt lgkmcnt(0)
    s_waitcnt vmcnt(8)
    s_barrier
    ds_read_b128 v[46:49], v9 offset:49152
    ds_read_b64_tr_b16 v[50:51], v13 offset:57344
    ds_read_b64_tr_b16 v[52:53], v13 offset:58368
    ds_read_b128 v[54:57], v10 offset:49152
    ds_read_b64_tr_b16 v[58:59], v13 offset:59392
    ds_read_b64_tr_b16 v[60:61], v13 offset:60416
    ds_read_b128 v[62:65], v11 offset:49152
    ds_read_b64_tr_b16 v[66:67], v13 offset:61440
    ds_read_b64_tr_b16 v[68:69], v13 offset:62464
    ds_read_b128 v[70:73], v12 offset:49152
    ds_read_b64_tr_b16 v[74:75], v13 offset:63488
    ds_read_b64_tr_b16 v[76:77], v13 offset:64512
    v_mfma_f32_32x32x16_bf16 v[80:95], v[18:21], v[14:17], v[80:95]
    s_lshl_b32 s30, s32, 7
    s_add_u32 s30, s30, s35
    s_add_u32 m0, s25, 32768
    s_nop 0
    buffer_load_dwordx4 v5, s[4:7], s30 offen lds
    v_mfma_f32_32x32x16_bf16 v[80:95], v[26:29], v[22:25], v[80:95]
    s_add_u32 m0, s25, 36864
    s_nop 0
    buffer_load_dwordx4 v6, s[4:7], s30 offen lds
    v_mfma_f32_32x32x16_bf16 v[80:95], v[34:37], v[30:33], v[80:95]
    s_mul_i32 s31, s32, 65536
    s_add_u32 s31, s31, s36
    s_add_u32 s32, s32, 1
    s_cmp_eq_u32 s32, 28
    s_cselect_b32 s32, 0, s32
    s_add_u32 m0, s25, 40960
    s_nop 0
    buffer_load_dwordx4 v7, s[8:11], s31 offen lds
    v_mfma_f32_32x32x16_bf16 v[80:95], v[42:45], v[38:41], v[80:95]
    s_add_u32 m0, s25, 45056
    s_nop 0
    buffer_load_dwordx4 v8, s[8:11], s31 offen lds
    s_waitcnt lgkmcnt(0)
    s_waitcnt vmcnt(8)
    s_barrier
    ds_read_b128 v[14:17], v9 offset:0
    ds_read_b64_tr_b16 v[18:19], v13 offset:8192
    ds_read_b64_tr_b16 v[20:21], v13 offset:9216
    ds_read_b128 v[22:25], v10 offset:0
    ds_read_b64_tr_b16 v[26:27], v13 offset:10240
    ds_read_b64_tr_b16 v[28:29], v13 offset:11264
    ds_read_b128 v[30:33], v11 offset:0
    ds_read_b64_tr_b16 v[34:35], v13 offset:12288
    ds_read_b64_tr_b16 v[36:37], v13 offset:13312
    ds_read_b128 v[38:41], v12 offset:0
    ds_read_b64_tr_b16 v[42:43], v13 offset:14336
    ds_read_b64_tr_b16 v[44:45], v13 offset:15360
    v_mfma_f32_32x32x16_bf16 v[80:95], v[50:53], v[46:49], v[80:95]
    s_lshl_b32 s30, s32, 7
    s_add_u32 s30, s30, s35
    s_add_u32 m0, s25, 49152
    s_nop 0
    buffer_load_dwordx4 v5, s[4:7], s30 offen lds
    v_mfma_f32_32x32x16_bf16 v[80:95], v[58:61], v[54:57], v[80:95]
    s_add_u32 m0, s25, 53248
    s_nop 0
    buffer_load_dwordx4 v6, s[4:7], s30 offen lds
    v_mfma_f32_32x32x16_bf16 v[80:95], v[66:69], v[62:65], v[80:95]
    s_mul_i32 s31, s32, 65536
    s_add_u32 s31, s31, s36
    s_add_u32 s32, s32, 1
    s_cmp_eq_u32 s32, 28
    s_cselect_b32 s32, 0, s32
    s_add_u32 m0, s25, 57344
    s_nop 0
    buffer_load_dwordx4 v7, s[8:11], s31 offen lds
    v_mfma_f32_32x32x16_bf16 v[80:95], v[74:77], v[70:73], v[80:95]
    s_add_u32 m0, s25, 61440
    s_nop 0
    buffer_load_dwordx4 v8, s[8:11], s31 offen lds
    s_waitcnt lgkmcnt(0)
    s_waitcnt vmcnt(8)
    s_barrier
    ds_read_b128 v[46:49], v9 offset:16384
    ds_read_b64_tr_b16 v[50:51], v13 offset:24576
    ds_read_b64_tr_b16 v[52:53], v13 offset:25600
    ds_read_b128 v[54:57], v10 offset:16384
    ds_read_b64_tr_b16 v[58:59], v13 offset:26624
    ds_read_b64_tr_b16 v[60:61], v13 offset:27648
    ds_read_b128 v[62:65], v11 offset:16384
    ds_read_b64_tr_b16 v[66:67], v13 offset:28672
    ds_read_b64_tr_b16 v[68:69], v13 offset:29696
    ds_read_b128 v[70:73], v12 offset:16384
    ds_read_b64_tr_b16 v[74:75], v13 offset:30720
    ds_read_b64_tr_b16 v[76:77], v13 offset:31744
    v_mfma_f32_32x32x16_bf16 v[80:95], v[18:21], v[14:17], v[80:95]
    s_lshl_b32 s30, s32, 7
    s_add_u32 s30, s30, s35
    s_add_u32 m0, s25, 0
    s_nop 0
    buffer_load_dwordx4 v5, s[4:7], s30 offen lds
    v_mfma_f32_32x32x16_bf16 v[80:95], v[26:29], v[22:25], v[80:95]
    s_add_u32 m0, s25, 4096
    s_nop 0
    buffer_load_dwordx4 v6, s[4:7], s30 offen lds
    v_mfma_f32_32x32x16_bf16 v[80:95], v[34:37], v[30:33], v[80:95]
    s_mul_i32 s31, s32, 65536
    s_add_u32 s31, s31, s36
    s_add_u32 s32, s32, 1
    s_cmp_eq_u32 s32, 28
    s_cselect_b32 s32, 0, s32
    s_add_u32 m0, s25, 8192
    s_nop 0
    buffer_load_dwordx4 v7, s[8:11], s31 offen lds
    v_mfma_f32_32x32x16_bf16 v[80:95], v[42:45], v[38:41], v[80:95]
    s_add_u32 m0, s25, 12288
    s_nop 0
    buffer_load_dwordx4 v8, s[8:11], s31 offen lds
    s_waitcnt lgkmcnt(0)
    s_waitcnt vmcnt(8)
    s_barrier
    ds_read_b128 v[14:17], v9 offset:32768
    ds_read_b64_tr_b16 v[18:19], v13 offset:40960
    ds_read_b64_tr_b16 v[20:21], v13 offset:41984
    ds_read_b128 v[22:25], v10 offset:32768
    ds_read_b64_tr_b16 v[26:27], v13 offset:43008
    ds_read_b64_tr_b16 v[28:29], v13 offset:44032
    ds_read_b128 v[30:33], v11 offset:32768
    ds_read_b64_tr_b16 v[34:35], v13 offset:45056
    ds_read_b64_tr_b16 v[36:37], v13 offset:46080
    ds_read_b128 v[38:41], v12 offset:32768
    ds_read_b64_tr_b16 v[42:43], v13 offset:47104
    ds_read_b64_tr_b16 v[44:45], v13 offset:48128
    v_mfma_f32_32x32x16_bf16 v[80:95], v[50:53], v[46:49], v[80:95]
    s_lshl_b32 s30, s32, 7
    s_add_u32 s30, s30, s35
    s_add_u32 m0, s25, 16384
    s_nop 0
    buffer_load_dwordx4 v5, s[4:7], s30 offen lds
    v_mfma_f32_32x32x16_bf16 v[80:95], v[58:61], v[54:57], v[80:95]
    s_add_u32 m0, s25, 20480
    s_nop 0
    buffer_load_dwordx4 v6, s[4:7], s30 offen lds
    v_mfma_f32_32x32x16_bf16 v[80:95], v[66:69], v[62:65], v[80:95]
    s_mul_i32 s31, s32, 65536
    s_add_u32 s31, s31, s36
    s_add_u32 s32, s32, 1
    s_cmp_eq_u32 s32, 28
    s_cselect_b32 s32, 0, s32
    s_add_u32 m0, s25, 24576
    s_nop 0
    buffer_load_dwordx4 v7, s[8:11], s31 offen lds
    v_mfma_f32_32x32x16_bf16 v[80:95], v[74:77], v[70:73], v[80:95]
    s_add_u32 m0, s25, 28672
    s_nop 0
    buffer_load_dwordx4 v8, s[8:11], s31 offen lds
    s_waitcnt lgkmcnt(0)
    s_waitcnt vmcnt(8)
    s_barrier
    ds_read_b128 v[46:49], v9 offset:49152
    ds_read_b64_tr_b16 v[50:51], v13 offset:57344
    ds_read_b64_tr_b16 v[52:53], v13 offset:58368
    ds_read_b128 v[54:57], v10 offset:49152
    ds_read_b64_tr_b16 v[58:59], v13 offset:59392
    ds_read_b64_tr_b16 v[60:61], v13 offset:60416
    ds_read_b128 v[62:65], v11 offset:49152
    ds_read_b64_tr_b16 v[66:67], v13 offset:61440
    ds_read_b64_tr_b16 v[68:69], v13 offset:62464
    ds_read_b128 v[70:73], v12 offset:49152
    ds_read_b64_tr_b16 v[74:75], v13 offset:63488
    ds_read_b64_tr_b16 v[76:77], v13 offset:64512
    v_mfma_f32_32x32x16_bf16 v[80:95], v[18:21], v[14:17], v[80:95]
    s_lshl_b32 s30, s32, 7
    s_add_u32 s30, s30, s35
    s_add_u32 m0, s25, 32768
    s_nop 0
    buffer_load_dwordx4 v5, s[4:7], s30 offen lds
    v_mfma_f32_32x32x16_bf16 v[80:95], v[26:29], v[22:25], v[80:95]
    s_add_u32 m0, s25, 36864
    s_nop 0
    buffer_load_dwordx4 v6, s[4:7], s30 offen lds
    v_mfma_f32_32x32x16_bf16 v[80:95], v[34:37], v[30:33], v[80:95]
    s_mul_i32 s31, s32, 65536
    s_add_u32 s31, s31, s36
    s_add_u32 s32, s32, 1
    s_cmp_eq_u32 s32, 28
    s_cselect_b32 s32, 0, s32
    s_add_u32 m0, s25, 40960
    s_nop 0
    buffer_load_dwordx4 v7, s[8:11], s31 offen lds
    v_mfma_f32_32x32x16_bf16 v[80:95], v[42:45], v[38:41], v[80:95]
    s_add_u32 m0, s25, 45056
    s_nop 0
    buffer_load_dwordx4 v8, s[8:11], s31 offen lds
    s_waitcnt lgkmcnt(0)
    s_waitcnt vmcnt(8)
    s_barrier
    ds_read_b128 v[14:17], v9 offset:0
    ds_read_b64_tr_b16 v[18:19], v13 offset:8192
    ds_read_b64_tr_b16 v[20:21], v13 offset:9216
    ds_read_b128 v[22:25], v10 offset:0
    ds_read_b64_tr_b16 v[26:27], v13 offset:10240
    ds_read_b64_tr_b16 v[28:29], v13 offset:11264
    ds_read_b128 v[30:33], v11 offset:0
    ds_read_b64_tr_b16 v[34:35], v13 offset:12288
    ds_read_b64_tr_b16 v[36:37], v13 offset:13312
    ds_read_b128 v[38:41], v12 offset:0
    ds_read_b64_tr_b16 v[42:43], v13 offset:14336
    ds_read_b64_tr_b16 v[44:45], v13 offset:15360
    v_mfma_f32_32x32x16_bf16 v[80:95], v[50:53], v[46:49], v[80:95]
    s_lshl_b32 s30, s32, 7
    s_add_u32 s30, s30, s35
    s_add_u32 m0, s25, 49152
    s_nop 0
    buffer_load_dwordx4 v5, s[4:7], s30 offen lds
    v_mfma_f32_32x32x16_bf16 v[80:95], v[58:61], v[54:57], v[80:95]
    s_add_u32 m0, s25, 53248
    s_nop 0
    buffer_load_dwordx4 v6, s[4:7], s30 offen lds
    v_mfma_f32_32x32x16_bf16 v[80:95], v[66:69], v[62:65], v[80:95]
    s_mul_i32 s31, s32, 65536
    s_add_u32 s31, s31, s36
    s_add_u32 s32, s32, 1
    s_cmp_eq_u32 s32, 28
    s_cselect_b32 s32, 0, s32
    s_add_u32 m0, s25, 57344
    s_nop 0
    buffer_load_dwordx4 v7, s[8:11], s31 offen lds
    v_mfma_f32_32x32x16_bf16 v[80:95], v[74:77], v[70:73], v[80:95]
    s_add_u32 m0, s25, 61440
    s_nop 0
    buffer_load_dwordx4 v8, s[8:11], s31 offen lds
    s_waitcnt lgkmcnt(0)
    s_waitcnt vmcnt(8)
    s_barrier
    ds_read_b128 v[46:49], v9 offset:16384
    ds_read_b64_tr_b16 v[50:51], v13 offset:24576
    ds_read_b64_tr_b16 v[52:53], v13 offset:25600
    ds_read_b128 v[54:57], v10 offset:16384
    ds_read_b64_tr_b16 v[58:59], v13 offset:26624
    ds_read_b64_tr_b16 v[60:61], v13 offset:27648
    ds_read_b128 v[62:65], v11 offset:16384
    ds_read_b64_tr_b16 v[66:67], v13 offset:28672
    ds_read_b64_tr_b16 v[68:69], v13 offset:29696
    ds_read_b128 v[70:73], v12 offset:16384
    ds_read_b64_tr_b16 v[74:75], v13 offset:30720
    ds_read_b64_tr_b16 v[76:77], v13 offset:31744
    v_mfma_f32_32x32x16_bf16 v[80:95], v[18:21], v[14:17], v[80:95]
    s_lshl_b32 s30, s32, 7
    s_add_u32 s30, s30, s35
    s_add_u32 m0, s25, 0
    s_nop 0
    buffer_load_dwordx4 v5, s[4:7], s30 offen lds
    v_mfma_f32_32x32x16_bf16 v[80:95], v[26:29], v[22:25], v[80:95]
    s_add_u32 m0, s25, 4096
    s_nop 0
    buffer_load_dwordx4 v6, s[4:7], s30 offen lds
    v_mfma_f32_32x32x16_bf16 v[80:95], v[34:37], v[30:33], v[80:95]
    s_mul_i32 s31, s32, 65536
    s_add_u32 s31, s31, s36
    s_add_u32 s32, s32, 1
    s_cmp_eq_u32 s32, 28
    s_cselect_b32 s32, 0, s32
    s_add_u32 m0, s25, 8192
    s_nop 0
    buffer_load_dwordx4 v7, s[8:11], s31 offen lds
    v_mfma_f32_32x32x16_bf16 v[80:95], v[42:45], v[38:41], v[80:95]
    s_add_u32 m0, s25, 12288
    s_nop 0
    buffer_load_dwordx4 v8, s[8:11], s31 offen lds
    s_waitcnt lgkmcnt(0)
    s_waitcnt vmcnt(8)
    s_barrier
    ds_read_b128 v[14:17], v9 offset:32768
    ds_read_b64_tr_b16 v[18:19], v13 offset:40960
    ds_read_b64_tr_b16 v[20:21], v13 offset:41984
    ds_read_b128 v[22:25], v10 offset:32768
    ds_read_b64_tr_b16 v[26:27], v13 offset:43008
    ds_read_b64_tr_b16 v[28:29], v13 offset:44032
    ds_read_b128 v[30:33], v11 offset:32768
    ds_read_b64_tr_b16 v[34:35], v13 offset:45056
    ds_read_b64_tr_b16 v[36:37], v13 offset:46080
    ds_read_b128 v[38:41], v12 offset:32768
    ds_read_b64_tr_b16 v[42:43], v13 offset:47104
    ds_read_b64_tr_b16 v[44:45], v13 offset:48128
    v_mfma_f32_32x32x16_bf16 v[80:95], v[50:53], v[46:49], v[80:95]
    s_lshl_b32 s30, s32, 7
    s_add_u32 s30, s30, s35
    s_add_u32 m0, s25, 16384
    s_nop 0
    buffer_load_dwordx4 v5, s[4:7], s30 offen lds
    v_mfma_f32_32x32x16_bf16 v[80:95], v[58:61], v[54:57], v[80:95]
    s_add_u32 m0, s25, 20480
    s_nop 0
    buffer_load_dwordx4 v6, s[4:7], s30 offen lds
    v_mfma_f32_32x32x16_bf16 v[80:95], v[66:69], v[62:65], v[80:95]
    s_mul_i32 s31, s32, 65536
    s_add_u32 s31, s31, s36
    s_add_u32 s32, s32, 1
    s_cmp_eq_u32 s32, 28
    s_cselect_b32 s32, 0, s32
    s_add_u32 m0, s25, 24576
    s_nop 0
    buffer_load_dwordx4 v7, s[8:11], s31 offen lds
    v_mfma_f32_32x32x16_bf16 v[80:95], v[74:77], v[70:73], v[80:95]
    s_add_u32 m0, s25, 28672
    s_nop 0
    buffer_load_dwordx4 v8, s[8:11], s31 offen lds
    s_waitcnt lgkmcnt(0)
    s_waitcnt vmcnt(8)
    s_barrier
    ds_read_b128 v[46:49], v9 offset:49152
    ds_read_b64_tr_b16 v[50:51], v13 offset:57344
    ds_read_b64_tr_b16 v[52:53], v13 offset:58368
    ds_read_b128 v[54:57], v10 offset:49152
    ds_read_b64_tr_b16 v[58:59], v13 offset:59392
    ds_read_b64_tr_b16 v[60:61], v13 offset:60416
    ds_read_b128 v[62:65], v11 offset:49152
    ds_read_b64_tr_b16 v[66:67], v13 offset:61440
    ds_read_b64_tr_b16 v[68:69], v13 offset:62464
    ds_read_b128 v[70:73], v12 offset:49152
    ds_read_b64_tr_b16 v[74:75], v13 offset:63488
    ds_read_b64_tr_b16 v[76:77], v13 offset:64512
    v_mfma_f32_32x32x16_bf16 v[80:95], v[18:21], v[14:17], v[80:95]
    s_lshl_b32 s30, s32, 7
    s_add_u32 s30, s30, s35
    s_add_u32 m0, s25, 32768
    s_nop 0
    buffer_load_dwordx4 v5, s[4:7], s30 offen lds
    v_mfma_f32_32x32x16_bf16 v[80:95], v[26:29], v[22:25], v[80:95]
    s_add_u32 m0, s25, 36864
    s_nop 0
    buffer_load_dwordx4 v6, s[4:7], s30 offen lds
    v_mfma_f32_32x32x16_bf16 v[80:95], v[34:37], v[30:33], v[80:95]
    s_mul_i32 s31, s32, 65536
    s_add_u32 s31, s31, s36
    s_add_u32 s32, s32, 1
    s_cmp_eq_u32 s32, 28
    s_cselect_b32 s32, 0, s32
    s_add_u32 m0, s25, 40960
    s_nop 0
    buffer_load_dwordx4 v7, s[8:11], s31 offen lds
    v_mfma_f32_32x32x16_bf16 v[80:95], v[42:45], v[38:41], v[80:95]
    s_add_u32 m0, s25, 45056
    s_nop 0
    buffer_load_dwordx4 v8, s[8:11], s31 offen lds
    s_waitcnt lgkmcnt(0)
    s_waitcnt vmcnt(8)
    s_barrier
    ds_read_b128 v[14:17], v9 offset:0
    ds_read_b64_tr_b16 v[18:19], v13 offset:8192
    ds_read_b64_tr_b16 v[20:21], v13 offset:9216
    ds_read_b128 v[22:25], v10 offset:0
    ds_read_b64_tr_b16 v[26:27], v13 offset:10240
    ds_read_b64_tr_b16 v[28:29], v13 offset:11264
    ds_read_b128 v[30:33], v11 offset:0
    ds_read_b64_tr_b16 v[34:35], v13 offset:12288
    ds_read_b64_tr_b16 v[36:37], v13 offset:13312
    ds_read_b128 v[38:41], v12 offset:0
    ds_read_b64_tr_b16 v[42:43], v13 offset:14336
    ds_read_b64_tr_b16 v[44:45], v13 offset:15360
    v_mfma_f32_32x32x16_bf16 v[80:95], v[50:53], v[46:49], v[80:95]
    s_lshl_b32 s30, s32, 7
    s_add_u32 s30, s30, s35
    s_add_u32 m0, s25, 49152
    s_nop 0
    buffer_load_dwordx4 v5, s[4:7], s30 offen lds
    v_mfma_f32_32x32x16_bf16 v[80:95], v[58:61], v[54:57], v[80:95]
    s_add_u32 m0, s25, 53248
    s_nop 0
    buffer_load_dwordx4 v6, s[4:7], s30 offen lds
    v_mfma_f32_32x32x16_bf16 v[80:95], v[66:69], v[62:65], v[80:95]
    s_mul_i32 s31, s32, 65536
    s_add_u32 s31, s31, s36
    s_add_u32 s32, s32, 1
    s_cmp_eq_u32 s32, 28
    s_cselect_b32 s32, 0, s32
    s_add_u32 m0, s25, 57344
    s_nop 0
    buffer_load_dwordx4 v7, s[8:11], s31 offen lds
    v_mfma_f32_32x32x16_bf16 v[80:95], v[74:77], v[70:73], v[80:95]
    s_add_u32 m0, s25, 61440
    s_nop 0
    buffer_load_dwordx4 v8, s[8:11], s31 offen lds
    s_waitcnt lgkmcnt(0)
    s_waitcnt vmcnt(8)
    s_barrier
    ds_read_b128 v[46:49], v9 offset:16384
    ds_read_b64_tr_b16 v[50:51], v13 offset:24576
    ds_read_b64_tr_b16 v[52:53], v13 offset:25600
    ds_read_b128 v[54:57], v10 offset:16384
    ds_read_b64_tr_b16 v[58:59], v13 offset:26624
    ds_read_b64_tr_b16 v[60:61], v13 offset:27648
    ds_read_b128 v[62:65], v11 offset:16384
    ds_read_b64_tr_b16 v[66:67], v13 offset:28672
    ds_read_b64_tr_b16 v[68:69], v13 offset:29696
    ds_read_b128 v[70:73], v12 offset:16384
    ds_read_b64_tr_b16 v[74:75], v13 offset:30720
    ds_read_b64_tr_b16 v[76:77], v13 offset:31744
    v_mfma_f32_32x32x16_bf16 v[80:95], v[18:21], v[14:17], v[80:95]
    s_lshl_b32 s30, s32, 7
    s_add_u32 s30, s30, s35
    s_add_u32 m0, s25, 0
    s_nop 0
    buffer_load_dwordx4 v5, s[4:7], s30 offen lds
    v_mfma_f32_32x32x16_bf16 v[80:95], v[26:29], v[22:25], v[80:95]
    s_add_u32 m0, s25, 4096
    s_nop 0
    buffer_load_dwordx4 v6, s[4:7], s30 offen lds
    v_mfma_f32_32x32x16_bf16 v[80:95], v[34:37], v[30:33], v[80:95]
    s_mul_i32 s31, s32, 65536
    s_add_u32 s31, s31, s36
    s_add_u32 s32, s32, 1
    s_cmp_eq_u32 s32, 28
    s_cselect_b32 s32, 0, s32
    s_add_u32 m0, s25, 8192
    s_nop 0
    buffer_load_dwordx4 v7, s[8:11], s31 offen lds
    v_mfma_f32_32x32x16_bf16 v[80:95], v[42:45], v[38:41], v[80:95]
    s_add_u32 m0, s25, 12288
    s_nop 0
    buffer_load_dwordx4 v8, s[8:11], s31 offen lds
    s_waitcnt lgkmcnt(0)
    s_waitcnt vmcnt(8)
    s_barrier
    ds_read_b128 v[14:17], v9 offset:32768
    ds_read_b64_tr_b16 v[18:19], v13 offset:40960
    ds_read_b64_tr_b16 v[20:21], v13 offset:41984
    ds_read_b128 v[22:25], v10 offset:32768
    ds_read_b64_tr_b16 v[26:27], v13 offset:43008
    ds_read_b64_tr_b16 v[28:29], v13 offset:44032
    ds_read_b128 v[30:33], v11 offset:32768
    ds_read_b64_tr_b16 v[34:35], v13 offset:45056
    ds_read_b64_tr_b16 v[36:37], v13 offset:46080
    ds_read_b128 v[38:41], v12 offset:32768
    ds_read_b64_tr_b16 v[42:43], v13 offset:47104
    ds_read_b64_tr_b16 v[44:45], v13 offset:48128
    v_mfma_f32_32x32x16_bf16 v[80:95], v[50:53], v[46:49], v[80:95]
    s_lshl_b32 s30, s32, 7
    s_add_u32 s30, s30, s35
    s_add_u32 m0, s25, 16384
    s_nop 0
    buffer_load_dwordx4 v5, s[4:7], s30 offen lds
    v_mfma_f32_32x32x16_bf16 v[80:95], v[58:61], v[54:57], v[80:95]
    s_add_u32 m0, s25, 20480
    s_nop 0
    buffer_load_dwordx4 v6, s[4:7], s30 offen lds
    v_mfma_f32_32x32x16_bf16 v[80:95], v[66:69], v[62:65], v[80:95]
    s_mul_i32 s31, s32, 65536
    s_add_u32 s31, s31, s36
    s_add_u32 s32, s32, 1
    s_cmp_eq_u32 s32, 28
    s_cselect_b32 s32, 0, s32
    s_add_u32 m0, s25, 24576
    s_nop 0
    buffer_load_dwordx4 v7, s[8:11], s31 offen lds
    v_mfma_f32_32x32x16_bf16 v[80:95], v[74:77], v[70:73], v[80:95]
    s_add_u32 m0, s25, 28672
    s_nop 0
    buffer_load_dwordx4 v8, s[8:11], s31 offen lds
    s_waitcnt lgkmcnt(0)
    s_waitcnt vmcnt(8)
    s_barrier
    ds_read_b128 v[46:49], v9 offset:49152
    ds_read_b64_tr_b16 v[50:51], v13 offset:57344
    ds_read_b64_tr_b16 v[52:53], v13 offset:58368
    ds_read_b128 v[54:57], v10 offset:49152
    ds_read_b64_tr_b16 v[58:59], v13 offset:59392
    ds_read_b64_tr_b16 v[60:61], v13 offset:60416
    ds_read_b128 v[62:65], v11 offset:49152
    ds_read_b64_tr_b16 v[66:67], v13 offset:61440
    ds_read_b64_tr_b16 v[68:69], v13 offset:62464
    ds_read_b128 v[70:73], v12 offset:49152
    ds_read_b64_tr_b16 v[74:75], v13 offset:63488
    ds_read_b64_tr_b16 v[76:77], v13 offset:64512
    v_mfma_f32_32x32x16_bf16 v[80:95], v[18:21], v[14:17], v[80:95]
    s_lshl_b32 s30, s32, 7
    s_add_u32 s30, s30, s35
    s_add_u32 m0, s25, 32768
    s_nop 0
    buffer_load_dwordx4 v5, s[4:7], s30 offen lds
    v_mfma_f32_32x32x16_bf16 v[80:95], v[26:29], v[22:25], v[80:95]
    s_add_u32 m0, s25, 36864
    s_nop 0
    buffer_load_dwordx4 v6, s[4:7], s30 offen lds
    v_mfma_f32_32x32x16_bf16 v[80:95], v[34:37], v[30:33], v[80:95]
    s_mul_i32 s31, s32, 65536
    s_add_u32 s31, s31, s36
    s_add_u32 s32, s32, 1
    s_cmp_eq_u32 s32, 28
    s_cselect_b32 s32, 0, s32
    s_add_u32 m0, s25, 40960
    s_nop 0
    buffer_load_dwordx4 v7, s[8:11], s31 offen lds
    v_mfma_f32_32x32x16_bf16 v[80:95], v[42:45], v[38:41], v[80:95]
    s_add_u32 m0, s25, 45056
    s_nop 0
    buffer_load_dwordx4 v8, s[8:11], s31 offen lds
    s_waitcnt lgkmcnt(0)
    s_waitcnt vmcnt(8)
    s_barrier
    ds_read_b128 v[14:17], v9 offset:0
    ds_read_b64_tr_b16 v[18:19], v13 offset:8192
    ds_read_b64_tr_b16 v[20:21], v13 offset:9216
    ds_read_b128 v[22:25], v10 offset:0
    ds_read_b64_tr_b16 v[26:27], v13 offset:10240
    ds_read_b64_tr_b16 v[28:29], v13 offset:11264
    ds_read_b128 v[30:33], v11 offset:0
    ds_read_b64_tr_b16 v[34:35], v13 offset:12288
    ds_read_b64_tr_b16 v[36:37], v13 offset:13312
    ds_read_b128 v[38:41], v12 offset:0
    ds_read_b64_tr_b16 v[42:43], v13 offset:14336
    ds_read_b64_tr_b16 v[44:45], v13 offset:15360
    v_mfma_f32_32x32x16_bf16 v[80:95], v[50:53], v[46:49], v[80:95]
    s_lshl_b32 s30, s32, 7
    s_add_u32 s30, s30, s35
    s_add_u32 m0, s25, 49152
    s_nop 0
    buffer_load_dwordx4 v5, s[4:7], s30 offen lds
    v_mfma_f32_32x32x16_bf16 v[80:95], v[58:61], v[54:57], v[80:95]
    s_add_u32 m0, s25, 53248
    s_nop 0
    buffer_load_dwordx4 v6, s[4:7], s30 offen lds
    v_mfma_f32_32x32x16_bf16 v[80:95], v[66:69], v[62:65], v[80:95]
    s_mul_i32 s31, s32, 65536
    s_add_u32 s31, s31, s36
    s_add_u32 s32, s32, 1
    s_cmp_eq_u32 s32, 28
    s_cselect_b32 s32, 0, s32
    s_add_u32 m0, s25, 57344
    s_nop 0
    buffer_load_dwordx4 v7, s[8:11], s31 offen lds
    v_mfma_f32_32x32x16_bf16 v[80:95], v[74:77], v[70:73], v[80:95]
    s_add_u32 m0, s25, 61440
    s_nop 0
    buffer_load_dwordx4 v8, s[8:11], s31 offen lds
    s_waitcnt lgkmcnt(0)
    s_waitcnt vmcnt(8)
    s_barrier
    ds_read_b128 v[46:49], v9 offset:16384
    ds_read_b64_tr_b16 v[50:51], v13 offset:24576
    ds_read_b64_tr_b16 v[52:53], v13 offset:25600
    ds_read_b128 v[54:57], v10 offset:16384
    ds_read_b64_tr_b16 v[58:59], v13 offset:26624
    ds_read_b64_tr_b16 v[60:61], v13 offset:27648
    ds_read_b128 v[62:65], v11 offset:16384
    ds_read_b64_tr_b16 v[66:67], v13 offset:28672
    ds_read_b64_tr_b16 v[68:69], v13 offset:29696
    ds_read_b128 v[70:73], v12 offset:16384
    ds_read_b64_tr_b16 v[74:75], v13 offset:30720
    ds_read_b64_tr_b16 v[76:77], v13 offset:31744
    v_mfma_f32_32x32x16_bf16 v[80:95], v[18:21], v[14:17], v[80:95]
    s_lshl_b32 s30, s32, 7
    s_add_u32 s30, s30, s35
    s_add_u32 m0, s25, 0
    s_nop 0
    buffer_load_dwordx4 v5, s[4:7], s30 offen lds
    v_mfma_f32_32x32x16_bf16 v[80:95], v[26:29], v[22:25], v[80:95]
    s_add_u32 m0, s25, 4096
    s_nop 0
    buffer_load_dwordx4 v6, s[4:7], s30 offen lds
    v_mfma_f32_32x32x16_bf16 v[80:95], v[34:37], v[30:33], v[80:95]
    s_mul_i32 s31, s32, 65536
    s_add_u32 s31, s31, s36
    s_add_u32 s32, s32, 1
    s_cmp_eq_u32 s32, 28
    s_cselect_b32 s32, 0, s32
    s_add_u32 m0, s25, 8192
    s_nop 0
    buffer_load_dwordx4 v7, s[8:11], s31 offen lds
    v_mfma_f32_32x32x16_bf16 v[80:95], v[42:45], v[38:41], v[80:95]
    s_add_u32 m0, s25, 12288
    s_nop 0
    buffer_load_dwordx4 v8, s[8:11], s31 offen lds
    s_waitcnt lgkmcnt(0)
    s_waitcnt vmcnt(8)
    s_barrier
    ds_read_b128 v[14:17], v9 offset:32768
    ds_read_b64_tr_b16 v[18:19], v13 offset:40960
    ds_read_b64_tr_b16 v[20:21], v13 offset:41984
    ds_read_b128 v[22:25], v10 offset:32768
    ds_read_b64_tr_b16 v[26:27], v13 offset:43008
    ds_read_b64_tr_b16 v[28:29], v13 offset:44032
    ds_read_b128 v[30:33], v11 offset:32768
    ds_read_b64_tr_b16 v[34:35], v13 offset:45056
    ds_read_b64_tr_b16 v[36:37], v13 offset:46080
    ds_read_b128 v[38:41], v12 offset:32768
    ds_read_b64_tr_b16 v[42:43], v13 offset:47104
    ds_read_b64_tr_b16 v[44:45], v13 offset:48128
    v_mfma_f32_32x32x16_bf16 v[80:95], v[50:53], v[46:49], v[80:95]
    s_lshl_b32 s30, s32, 7
    s_add_u32 s30, s30, s35
    s_add_u32 m0, s25, 16384
    s_nop 0
    buffer_load_dwordx4 v5, s[4:7], s30 offen lds
    v_mfma_f32_32x32x16_bf16 v[80:95], v[58:61], v[54:57], v[80:95]
    s_add_u32 m0, s25, 20480
    s_nop 0
    buffer_load_dwordx4 v6, s[4:7], s30 offen lds
    v_mfma_f32_32x32x16_bf16 v[80:95], v[66:69], v[62:65], v[80:95]
    s_mul_i32 s31, s32, 65536
    s_add_u32 s31, s31, s36
    s_add_u32 s32, s32, 1
    s_cmp_eq_u32 s32, 28
    s_cselect_b32 s32, 0, s32
    s_add_u32 m0, s25, 24576
    s_nop 0
    buffer_load_dwordx4 v7, s[8:11], s31 offen lds
    v_mfma_f32_32x32x16_bf16 v[80:95], v[74:77], v[70:73], v[80:95]
    s_add_u32 m0, s25, 28672
    s_nop 0
    buffer_load_dwordx4 v8, s[8:11], s31 offen lds
    s_waitcnt lgkmcnt(0)
    s_waitcnt vmcnt(8)
    s_barrier
    ds_read_b128 v[46:49], v9 offset:49152
    ds_read_b64_tr_b16 v[50:51], v13 offset:57344
    ds_read_b64_tr_b16 v[52:53], v13 offset:58368
    ds_read_b128 v[54:57], v10 offset:49152
    ds_read_b64_tr_b16 v[58:59], v13 offset:59392
    ds_read_b64_tr_b16 v[60:61], v13 offset:60416
    ds_read_b128 v[62:65], v11 offset:49152
    ds_read_b64_tr_b16 v[66:67], v13 offset:61440
    ds_read_b64_tr_b16 v[68:69], v13 offset:62464
    ds_read_b128 v[70:73], v12 offset:49152
    ds_read_b64_tr_b16 v[74:75], v13 offset:63488
    ds_read_b64_tr_b16 v[76:77], v13 offset:64512
    v_mfma_f32_32x32x16_bf16 v[80:95], v[18:21], v[14:17], v[80:95]
    s_lshl_b32 s30, s32, 7
    s_add_u32 s30, s30, s35
    s_add_u32 m0, s25, 32768
    s_nop 0
    buffer_load_dwordx4 v5, s[4:7], s30 offen lds
    v_mfma_f32_32x32x16_bf16 v[80:95], v[26:29], v[22:25], v[80:95]
    s_add_u32 m0, s25, 36864
    s_nop 0
    buffer_load_dwordx4 v6, s[4:7], s30 offen lds
    v_mfma_f32_32x32x16_bf16 v[80:95], v[34:37], v[30:33], v[80:95]
    s_mul_i32 s31, s32, 65536
    s_add_u32 s31, s31, s36
    s_add_u32 s32, s32, 1
    s_cmp_eq_u32 s32, 28
    s_cselect_b32 s32, 0, s32
    s_add_u32 m0, s25, 40960
    s_nop 0
    buffer_load_dwordx4 v7, s[8:11], s31 offen lds
    v_mfma_f32_32x32x16_bf16 v[80:95], v[42:45], v[38:41], v[80:95]
    s_add_u32 m0, s25, 45056
    s_nop 0
    buffer_load_dwordx4 v8, s[8:11], s31 offen lds
    s_waitcnt lgkmcnt(0)
    s_waitcnt vmcnt(8)
    s_barrier
    ds_read_b128 v[14:17], v9 offset:0
    ds_read_b64_tr_b16 v[18:19], v13 offset:8192
    ds_read_b64_tr_b16 v[20:21], v13 offset:9216
    ds_read_b128 v[22:25], v10 offset:0
    ds_read_b64_tr_b16 v[26:27], v13 offset:10240
    ds_read_b64_tr_b16 v[28:29], v13 offset:11264
    ds_read_b128 v[30:33], v11 offset:0
    ds_read_b64_tr_b16 v[34:35], v13 offset:12288
    ds_read_b64_tr_b16 v[36:37], v13 offset:13312
    ds_read_b128 v[38:41], v12 offset:0
    ds_read_b64_tr_b16 v[42:43], v13 offset:14336
    ds_read_b64_tr_b16 v[44:45], v13 offset:15360
    v_mfma_f32_32x32x16_bf16 v[80:95], v[50:53], v[46:49], v[80:95]
    s_lshl_b32 s30, s32, 7
    s_add_u32 s30, s30, s35
    s_add_u32 m0, s25, 49152
    s_nop 0
    buffer_load_dwordx4 v5, s[4:7], s30 offen lds
    v_mfma_f32_32x32x16_bf16 v[80:95], v[58:61], v[54:57], v[80:95]
    s_add_u32 m0, s25, 53248
    s_nop 0
    buffer_load_dwordx4 v6, s[4:7], s30 offen lds
    v_mfma_f32_32x32x16_bf16 v[80:95], v[66:69], v[62:65], v[80:95]
    s_mul_i32 s31, s32, 65536
    s_add_u32 s31, s31, s36
    s_add_u32 s32, s32, 1
    s_cmp_eq_u32 s32, 28
    s_cselect_b32 s32, 0, s32
    s_add_u32 m0, s25, 57344
    s_nop 0
    buffer_load_dwordx4 v7, s[8:11], s31 offen lds
    v_mfma_f32_32x32x16_bf16 v[80:95], v[74:77], v[70:73], v[80:95]
    s_add_u32 m0, s25, 61440
    s_nop 0
    buffer_load_dwordx4 v8, s[8:11], s31 offen lds
    s_waitcnt lgkmcnt(0)
    s_waitcnt vmcnt(8)
    s_barrier
    ds_read_b128 v[46:49], v9 offset:16384
    ds_read_b64_tr_b16 v[50:51], v13 offset:24576
    ds_read_b64_tr_b16 v[52:53], v13 offset:25600
    ds_read_b128 v[54:57], v10 offset:16384
    ds_read_b64_tr_b16 v[58:59], v13 offset:26624
    ds_read_b64_tr_b16 v[60:61], v13 offset:27648
    ds_read_b128 v[62:65], v11 offset:16384
    ds_read_b64_tr_b16 v[66:67], v13 offset:28672
    ds_read_b64_tr_b16 v[68:69], v13 offset:29696
    ds_read_b128 v[70:73], v12 offset:16384
    ds_read_b64_tr_b16 v[74:75], v13 offset:30720
    ds_read_b64_tr_b16 v[76:77], v13 offset:31744
    v_mfma_f32_32x32x16_bf16 v[80:95], v[18:21], v[14:17], v[80:95]
    v_mfma_f32_32x32x16_bf16 v[80:95], v[26:29], v[22:25], v[80:95]
    v_mfma_f32_32x32x16_bf16 v[80:95], v[34:37], v[30:33], v[80:95]
    v_mfma_f32_32x32x16_bf16 v[80:95], v[42:45], v[38:41], v[80:95]
    s_waitcnt lgkmcnt(0)
    s_waitcnt vmcnt(4)
    s_barrier
    ds_read_b128 v[14:17], v9 offset:32768
    ds_read_b64_tr_b16 v[18:19], v13 offset:40960
    ds_read_b64_tr_b16 v[20:21], v13 offset:41984
    ds_read_b128 v[22:25], v10 offset:32768
    ds_read_b64_tr_b16 v[26:27], v13 offset:43008
    ds_read_b64_tr_b16 v[28:29], v13 offset:44032
    ds_read_b128 v[30:33], v11 offset:32768
    ds_read_b64_tr_b16 v[34:35], v13 offset:45056
    ds_read_b64_tr_b16 v[36:37], v13 offset:46080
    ds_read_b128 v[38:41], v12 offset:32768
    ds_read_b64_tr_b16 v[42:43], v13 offset:47104
    ds_read_b64_tr_b16 v[44:45], v13 offset:48128
    v_mfma_f32_32x32x16_bf16 v[80:95], v[50:53], v[46:49], v[80:95]
    v_mfma_f32_32x32x16_bf16 v[80:95], v[58:61], v[54:57], v[80:95]
    v_mfma_f32_32x32x16_bf16 v[80:95], v[66:69], v[62:65], v[80:95]
    v_mfma_f32_32x32x16_bf16 v[80:95], v[74:77], v[70:73], v[80:95]
    s_waitcnt lgkmcnt(0)
    s_waitcnt vmcnt(0)
    s_barrier
    ds_read_b128 v[46:49], v9 offset:49152
    ds_read_b64_tr_b16 v[50:51], v13 offset:57344
    ds_read_b64_tr_b16 v[52:53], v13 offset:58368
    ds_read_b128 v[54:57], v10 offset:49152
    ds_read_b64_tr_b16 v[58:59], v13 offset:59392
    ds_read_b64_tr_b16 v[60:61], v13 offset:60416
    ds_read_b128 v[62:65], v11 offset:49152
    ds_read_b64_tr_b16 v[66:67], v13 offset:61440
    ds_read_b64_tr_b16 v[68:69], v13 offset:62464
    ds_read_b128 v[70:73], v12 offset:49152
    ds_read_b64_tr_b16 v[74:75], v13 offset:63488
    ds_read_b64_tr_b16 v[76:77], v13 offset:64512
    v_mfma_f32_32x32x16_bf16 v[80:95], v[18:21], v[14:17], v[80:95]
    v_mfma_f32_32x32x16_bf16 v[80:95], v[26:29], v[22:25], v[80:95]
    v_mfma_f32_32x32x16_bf16 v[80:95], v[34:37], v[30:33], v[80:95]
    v_mfma_f32_32x32x16_bf16 v[80:95], v[42:45], v[38:41], v[80:95]
    s_waitcnt lgkmcnt(9)
    v_mfma_f32_32x32x16_bf16 v[80:95], v[50:53], v[46:49], v[80:95]
    s_waitcnt lgkmcnt(6)
    v_mfma_f32_32x32x16_bf16 v[80:95], v[58:61], v[54:57], v[80:95]
    s_waitcnt lgkmcnt(3)
    v_mfma_f32_32x32x16_bf16 v[80:95], v[66:69], v[62:65], v[80:95]
    s_waitcnt lgkmcnt(0)
    v_mfma_f32_32x32x16_bf16 v[80:95], v[74:77], v[70:73], v[80:95]
    s_nop 15
    v_permlane32_swap_b32 v80, v84
    v_permlane32_swap_b32 v81, v85
    v_permlane32_swap_b32 v82, v86
    v_permlane32_swap_b32 v83, v87
    s_nop 1
    v_cvt_pk_bf16_f32 v14, v80, v81
    v_cvt_pk_bf16_f32 v15, v82, v83
    v_cvt_pk_bf16_f32 v16, v84, v85
    v_cvt_pk_bf16_f32 v17, v86, v87
    v_lshlrev_b32 v80, 16, v14
    v_and_b32 v81, 0xffff0000, v14
    v_lshlrev_b32 v82, 16, v15
    v_and_b32 v83, 0xffff0000, v15
    v_lshlrev_b32 v84, 16, v16
    v_and_b32 v85, 0xffff0000, v16
    v_lshlrev_b32 v86, 16, v17
    v_and_b32 v87, 0xffff0000, v17
    v_mul_f32 v80, v80, v104
    v_mul_f32 v81, v81, v105
    v_mul_f32 v82, v82, v106
    v_mul_f32 v83, v83, v107
    v_mul_f32 v84, v84, v108
    v_mul_f32 v85, v85, v109
    v_mul_f32 v86, v86, v110
    v_mul_f32 v87, v87, v111
    v_cvt_pk_bf16_f32 v14, v80, v81
    v_cvt_pk_bf16_f32 v15, v82, v83
    v_cvt_pk_bf16_f32 v16, v84, v85
    v_cvt_pk_bf16_f32 v17, v86, v87
    v_lshlrev_b32 v80, 16, v14
    v_and_b32 v81, 0xffff0000, v14
    v_lshlrev_b32 v82, 16, v15
    v_and_b32 v83, 0xffff0000, v15
    v_lshlrev_b32 v84, 16, v16
    v_and_b32 v85, 0xffff0000, v16
    v_lshlrev_b32 v86, 16, v17
    v_and_b32 v87, 0xffff0000, v17
    v_lshlrev_b32 v120, 16, v96
    v_and_b32 v121, 0xffff0000, v96
    v_lshlrev_b32 v122, 16, v97
    v_and_b32 v123, 0xffff0000, v97
    v_lshlrev_b32 v124, 16, v98
    v_and_b32 v125, 0xffff0000, v98
    v_lshlrev_b32 v126, 16, v99
    v_and_b32 v127, 0xffff0000, v99
    v_add_f32 v80, v80, v120
    v_add_f32 v81, v81, v121
    v_add_f32 v82, v82, v122
    v_add_f32 v83, v83, v123
    v_add_f32 v84, v84, v124
    v_add_f32 v85, v85, v125
    v_add_f32 v86, v86, v126
    v_add_f32 v87, v87, v127
    v_cvt_pk_bf16_f32 v14, v80, v81
    v_cvt_pk_bf16_f32 v15, v82, v83
    v_cvt_pk_bf16_f32 v16, v84, v85
    v_cvt_pk_bf16_f32 v17, v86, v87
    buffer_store_dwordx4 v[14:17], v128, s[20:23], s37 offen offset:0
    v_permlane32_swap_b32 v88, v92
    v_permlane32_swap_b32 v89, v93
    v_permlane32_swap_b32 v90, v94
    v_permlane32_swap_b32 v91, v95
    s_nop 1
    v_cvt_pk_bf16_f32 v18, v88, v89
    v_cvt_pk_bf16_f32 v19, v90, v91
    v_cvt_pk_bf16_f32 v20, v92, v93
    v_cvt_pk_bf16_f32 v21, v94, v95
    v_lshlrev_b32 v88, 16, v18
    v_and_b32 v89, 0xffff0000, v18
    v_lshlrev_b32 v90, 16, v19
    v_and_b32 v91, 0xffff0000, v19
    v_lshlrev_b32 v92, 16, v20
    v_and_b32 v93, 0xffff0000, v20
    v_lshlrev_b32 v94, 16, v21
    v_and_b32 v95, 0xffff0000, v21
    v_mul_f32 v88, v88, v112
    v_mul_f32 v89, v89, v113
    v_mul_f32 v90, v90, v114
    v_mul_f32 v91, v91, v115
    v_mul_f32 v92, v92, v116
    v_mul_f32 v93, v93, v117
    v_mul_f32 v94, v94, v118
    v_mul_f32 v95, v95, v119
    v_cvt_pk_bf16_f32 v18, v88, v89
    v_cvt_pk_bf16_f32 v19, v90, v91
    v_cvt_pk_bf16_f32 v20, v92, v93
    v_cvt_pk_bf16_f32 v21, v94, v95
    v_lshlrev_b32 v88, 16, v18
    v_and_b32 v89, 0xffff0000, v18
    v_lshlrev_b32 v90, 16, v19
    v_and_b32 v91, 0xffff0000, v19
    v_lshlrev_b32 v92, 16, v20
    v_and_b32 v93, 0xffff0000, v20
    v_lshlrev_b32 v94, 16, v21
    v_and_b32 v95, 0xffff0000, v21
    v_lshlrev_b32 v120, 16, v100
    v_and_b32 v121, 0xffff0000, v100
    v_lshlrev_b32 v122, 16, v101
    v_and_b32 v123, 0xffff0000, v101
    v_lshlrev_b32 v124, 16, v102
    v_and_b32 v125, 0xffff0000, v102
    v_lshlrev_b32 v126, 16, v103
    v_and_b32 v127, 0xffff0000, v103
    v_add_f32 v88, v88, v120
    v_add_f32 v89, v89, v121
    v_add_f32 v90, v90, v122
    v_add_f32 v91, v91, v123
    v_add_f32 v92, v92, v124
    v_add_f32 v93, v93, v125
    v_add_f32 v94, v94, v126
    v_add_f32 v95, v95, v127
    v_cvt_pk_bf16_f32 v18, v88, v89
    v_cvt_pk_bf16_f32 v19, v90, v91
    v_cvt_pk_bf16_f32 v20, v92, v93
    v_cvt_pk_bf16_f32 v21, v94, v95
    buffer_store_dwordx4 v[18:21], v128, s[20:23], s37 offen offset:32
    s_endpgm
.section .rodata,"a"
.p2align 6
.amdhsa_kernel mod_kernel
  .amdhsa_next_free_vgpr 56
  .amdhsa_next_free_sgpr 100
  .amdhsa_accum_offset 56
  .amdhsa_group_segment_fixed_size 0
  .amdhsa_kernarg_size 120
  .amdhsa_user_sgpr_count 2
  .amdhsa_user_sgpr_kernarg_segment_ptr 1
  .amdhsa_system_sgpr_workgroup_id_x 1
.end_amdhsa_kernel
.p2align 6
.amdhsa_kernel kv_kernel
  .amdhsa_next_free_vgpr 240
  .amdhsa_next_free_sgpr 100
  .amdhsa_accum_offset 240
  .amdhsa_group_segment_fixed_size 0
  .amdhsa_kernarg_size 120
  .amdhsa_user_sgpr_count 2
  .amdhsa_user_sgpr_kernarg_segment_ptr 1
  .amdhsa_system_sgpr_workgroup_id_x 1
.end_amdhsa_kernel
.p2align 6
.amdhsa_kernel attn_kernel
  .amdhsa_next_free_vgpr 256
  .amdhsa_next_free_sgpr 100
  .amdhsa_accum_offset 256
  .amdhsa_group_segment_fixed_size 0
  .amdhsa_kernarg_size 120
  .amdhsa_user_sgpr_count 2
  .amdhsa_user_sgpr_kernarg_segment_ptr 1
  .amdhsa_system_sgpr_workgroup_id_x 1
.end_amdhsa_kernel
.p2align 6
.amdhsa_kernel op_kernel
  .amdhsa_next_free_vgpr 160
  .amdhsa_next_free_sgpr 100
  .amdhsa_accum_offset 160
  .amdhsa_group_segment_fixed_size 0
  .amdhsa_kernarg_size 120
  .amdhsa_user_sgpr_count 2
  .amdhsa_user_sgpr_kernarg_segment_ptr 1
  .amdhsa_system_sgpr_workgroup_id_x 1
.end_amdhsa_kernel
.p2align 6
.amdhsa_kernel ln2_kernel
  .amdhsa_next_free_vgpr 104
  .amdhsa_next_free_sgpr 100
  .amdhsa_accum_offset 104
  .amdhsa_group_segment_fixed_size 0
  .amdhsa_kernarg_size 120
  .amdhsa_user_sgpr_count 2
  .amdhsa_user_sgpr_kernarg_segment_ptr 1
  .amdhsa_system_sgpr_workgroup_id_x 1
.end_amdhsa_kernel
.p2align 6
.amdhsa_kernel gu_kernel
  .amdhsa_next_free_vgpr 160
  .amdhsa_next_free_sgpr 100
  .amdhsa_accum_offset 160
  .amdhsa_group_segment_fixed_size 0
  .amdhsa_kernarg_size 120
  .amdhsa_user_sgpr_count 2
  .amdhsa_user_sgpr_kernarg_segment_ptr 1
  .amdhsa_system_sgpr_workgroup_id_x 1
.end_amdhsa_kernel
.p2align 6
.amdhsa_kernel dn_kernel
  .amdhsa_next_free_vgpr 136
  .amdhsa_next_free_sgpr 100
  .amdhsa_accum_offset 136
  .amdhsa_group_segment_fixed_size 0
  .amdhsa_kernarg_size 120
  .amdhsa_user_sgpr_count 2
  .amdhsa_user_sgpr_kernarg_segment_ptr 1
  .amdhsa_system_sgpr_workgroup_id_x 1
.end_amdhsa_kernel
```
